```python
import torch

def _softmax(x, axis=-1):
    return torch.softmax(x, dim=axis)

def _gelu(x):
    return torch.nn.functional.gelu(x, approximate='tanh')

def _silu(x):
    return torch.nn.functional.silu(x)

def _sigmoid(x):
    return torch.sigmoid(x)

def _layernorm(x, axis=-1, eps=1e-05):
    m = x.mean(dim=axis, keepdim=True)
    v = x.var(dim=axis, keepdim=True, unbiased=False)
    return (x - m) / torch.sqrt(v + eps)

def _scatter_add(tgt, idx, src, axis=0):
    return tgt.clone().index_add_(axis, idx, src)

def _segment_sum(src, seg, n):
    out = torch.zeros((n,) + src.shape[1:], dtype=src.dtype)
    return out.index_add_(0, seg, src)

def _pad(x, pw):
    flat = tuple((v for pair in reversed(pw) for v in pair))
    return torch.nn.functional.pad(x, flat)
kernel_name = 'parallel_sum__memory_aug_recurrent_mem_tr__glu_gated_bilinear__prompt'

def setup_inputs():

    _w = lambda a: (lambda t: t.to(torch.bfloat16) if t.is_floating_point() else t)(torch.as_tensor(a))

    def _A_setup():
        B, S, Dm = (1, 2048, 512)
        H, Dh = (32, 128)
        M, seg = (8, 32)
        seg = min(seg, S)
        S = S // seg * seg
        return {'x': _w((lambda *s: torch.randn(*s, dtype=torch.bfloat16) * 0.05)(B, S, Dm)), 'mem0': _w((lambda *s: torch.randn(*s, dtype=torch.bfloat16) * 0.2)(B, M, Dm)), 'Wq': _w((lambda *s: torch.randn(*s, dtype=torch.bfloat16) * 1.6)(Dm, H, Dh) * Dm ** (-0.5)), 'Wk': _w((lambda *s: torch.randn(*s, dtype=torch.bfloat16) * 1.6)(Dm, H, Dh) * Dm ** (-0.5)), 'Wv': _w((lambda *s: torch.randn(*s, dtype=torch.bfloat16) * 0.2)(Dm, H, Dh) * Dm ** (-0.5)), 'Wo': _w((lambda *s: torch.randn(*s, dtype=torch.bfloat16) * 0.2)(H, Dh, Dm) * (H * Dh) ** (-0.5)), 'seg_len': seg}
    _A_in = _A_setup()

    def _B_setup():
        B, S, D, F = (1, 2048, 512, 1376)
        return {'x': _w((lambda *s: torch.randn(*s, dtype=torch.bfloat16) * 0.05)(B, S, D)), 'w_gate': _w((lambda *s: torch.randn(*s, dtype=torch.bfloat16) * 0.2)(D, F) * D ** (-0.5)), 'w_up': _w((lambda *s: torch.randn(*s, dtype=torch.bfloat16) * 0.2)(D, F) * D ** (-0.5)), 'w_down': _w((lambda *s: torch.randn(*s, dtype=torch.bfloat16) * 0.2)(F, D) * F ** (-0.5))}
    _B_in = _B_setup()
    return {'A_x': _A_in['x'], 'A_mem0': _A_in['mem0'], 'A_Wq': _A_in['Wq'], 'A_Wk': _A_in['Wk'], 'A_Wv': _A_in['Wv'], 'A_Wo': _A_in['Wo'], 'A_seg_len': _A_in['seg_len'], 'B_x': _B_in['x'], 'B_w_gate': _B_in['w_gate'], 'B_w_up': _B_in['w_up'], 'B_w_down': _B_in['w_down']}

def reference(A_x, A_mem0, A_Wq, A_Wk, A_Wv, A_Wo, A_seg_len, B_x, B_w_gate, B_w_up, B_w_down):

    def _A_ref(x, mem0, Wq, Wk, Wv, Wo, seg_len):
        B, S, Dm = x.shape
        H, Dh = (Wq.shape[1], Wq.shape[2])
        M = mem0.shape[1]
        scale = Dh ** (-0.5)
        n_seg = S // seg_len
        L = M + seg_len
        idx = torch.arange(L)
        mask = (idx[:, None] < M) | (idx[:, None] >= idx[None, :])
        mem = mem0
        outs = []
        for s in range(n_seg):
            xs = x[:, s * seg_len:(s + 1) * seg_len, :].clone()
            h = torch.concatenate([mem, xs], axis=1)
            q = torch.einsum('btd,dhe->bhte', h, Wq)
            k = torch.einsum('btd,dhe->bhte', h, Wk)
            v = torch.einsum('btd,dhe->bhte', h, Wv)
            scores = torch.einsum('bhqe,bhke->bhqk', q, k) * scale
            scores = torch.where(mask[None, None], scores, -1000000000.0)
            p = _softmax(scores, axis=-1)
            o = torch.einsum('bhqk,bhke->bhqe', p, v)
            o = torch.einsum('bhte,hed->btd', o, Wo)
            mem = o[:, :M, :].clone()
            outs.append(o[:, M:, :])
        return torch.concatenate(outs, axis=1)

    def _B_ref(x, w_gate, w_up, w_down):
        g = torch.einsum('bsd,df->bsf', x, w_gate)
        u = torch.einsum('bsd,df->bsf', x, w_up)
        h = g * u
        return torch.einsum('bsf,fd->bsd', h, w_down)
    x = A_x
    xn = _layernorm(x, axis=-1)
    return x + _A_ref(xn, A_mem0, A_Wq, A_Wk, A_Wv, A_Wo, A_seg_len) + _B_ref(xn, B_w_gate, B_w_up, B_w_down)
```

```asm
; @launch grid=(256,1,1) block=(256,1,1) lds=163840
.amdgcn_target "amdgcn-amd-amdhsa--gfx950"
.text
.globl parallel_sum__memory_aug_recurrent_mem_tr__glu_gated_bilinear__prompt_kernel
.p2align 8
.type parallel_sum__memory_aug_recurrent_mem_tr__glu_gated_bilinear__prompt_kernel,@function
parallel_sum__memory_aug_recurrent_mem_tr__glu_gated_bilinear__prompt_kernel:
s_cmp_ge_u32 s2, 256
s_cbranch_scc1 L_end
s_load_dwordx16 s[4:19], s[0:1], 0
s_load_dwordx8 s[20:27], s[0:1], 64
s_load_dwordx4 s[28:31], s[0:1], 96
s_getreg_b32 s33, hwreg(HW_REG_XCC_ID, 0, 4)
v_lshrrev_b32 v1, 6, v0
s_nop 0
v_readfirstlane_b32 s32, v1
s_waitcnt lgkmcnt(0)
s_cmp_eq_u32 s2, 0
s_cselect_b32 s36, s32, 0
s_cmp_eq_u32 s36, 1
s_cbranch_scc0 L_st_ni
v_and_b32 v10, 63, v0
v_lshlrev_b32 v5, 4, v10
v_mov_b32 v6, 0
v_mov_b32 v7, 0
v_mov_b32 v8, 0
v_mov_b32 v9, 0
global_store_dwordx4 v5, v[6:9], s[30:31] offset:0 sc1
global_store_dwordx4 v5, v[6:9], s[30:31] offset:1024 sc1
global_store_dwordx4 v5, v[6:9], s[30:31] offset:2048 sc1
global_store_dwordx4 v5, v[6:9], s[30:31] offset:3072 sc1
v_add_u32 v5, 4096, v5
global_store_dwordx4 v5, v[6:9], s[30:31] offset:0 sc1
global_store_dwordx4 v5, v[6:9], s[30:31] offset:1024 sc1
global_store_dwordx4 v5, v[6:9], s[30:31] offset:2048 sc1
global_store_dwordx4 v5, v[6:9], s[30:31] offset:3072 sc1
v_lshlrev_b32 v5, 7, v10
v_add_u32 v5, 8192, v5
global_store_dwordx4 v5, v[6:9], s[30:31] sc1
v_add_u32 v5, 8192, v5
global_store_dwordx4 v5, v[6:9], s[30:31] sc1
s_waitcnt vmcnt(0)
v_mov_b32 v5, 68
v_mov_b32 v6, 1
s_mov_b64 exec, 1
global_store_dword v5, v6, s[28:29] sc1
s_mov_b64 exec, -1
L_st_ni:
s_cmp_eq_u32 s33, 0
s_cbranch_scc0 L_st_nx0
s_cmp_lg_u32 s32, 0
s_cbranch_scc1 L_st_sp
s_mov_b64 exec, 1
v_mov_b32 v1, 0
v_mov_b32 v4, 1
global_atomic_add v2, v1, v4, s[28:29] sc0
v_mov_b32 v3, 163836
s_waitcnt vmcnt(0)
ds_write_b32 v3, v2
s_waitcnt lgkmcnt(0)
s_mov_b64 exec, -1
L_st_sp:
s_barrier
v_mov_b32 v84, 163836
ds_read_b32 v85, v84
s_waitcnt lgkmcnt(0)
v_readfirstlane_b32 s35, v85
s_cmp_lt_u32 s35, 32
s_cbranch_scc0 L_st_nsp
s_lshl_b32 s36, s35, 8
s_add_u32 s74, s8, s36
s_addc_u32 s75, s9, 0
s_add_u32 s76, s10, s36
s_addc_u32 s77, s11, 0
s_add_u32 s78, s12, s36
s_addc_u32 s79, s13, 0
v_and_b32 v88, 63, v0
v_lshrrev_b32 v89, 4, v88
v_and_b32 v90, 15, v0
s_lshr_b32 s36, s32, 1
s_lshl_b32 s36, s36, 2
v_or_b32 v91, s36, v89
v_lshlrev_b32 v91, 1, v91
v_xor_b32 v90, v90, v91
s_lshl_b32 s36, s32, 2
v_add_u32 v89, s36, v89
v_mul_u32_u24 v89, 8192, v89
v_lshl_add_u32 v85, v90, 4, v89
v_lshrrev_b32 v88, 4, v0
v_and_b32 v88, 3, v88
v_bfe_u32 v89, v0, 2, 2
v_lshl_add_u32 v90, v88, 3, v89
v_lshlrev_b32 v90, 8, v90
v_and_b32 v88, 1, v88
v_lshl_or_b32 v88, v88, 2, v89
v_and_b32 v89, 1, v0
v_lshl_add_u32 v90, v89, 3, v90
v_bfe_u32 v89, v0, 1, 1
v_lshl_add_u32 v90, v89, 4, v90
s_lshl_b32 s36, s32, 1
s_add_u32 s37, s36, 0
v_xor_b32 v89, s37, v88
v_lshl_add_u32 v86, v89, 5, v90
s_add_u32 s37, s36, 1
v_xor_b32 v89, s37, v88
v_lshl_add_u32 v87, v89, 5, v90
v_mov_b32 v84, v85
s_lshl_b32 s36, s32, 10
s_add_u32 m0, s36, 0
s_nop 0
global_load_lds_dwordx4 v84, s[74:75]
v_add_u32 v84, 131072, v84
s_add_u32 m0, s36, 4096
s_nop 0
global_load_lds_dwordx4 v84, s[74:75]
v_add_u32 v84, 131072, v84
s_add_u32 m0, s36, 8192
s_nop 0
global_load_lds_dwordx4 v84, s[74:75]
v_add_u32 v84, 131072, v84
s_add_u32 m0, s36, 12288
s_nop 0
global_load_lds_dwordx4 v84, s[74:75]
v_add_u32 v84, 131072, v84
s_add_u32 m0, s36, 16384
s_nop 0
global_load_lds_dwordx4 v84, s[74:75]
v_add_u32 v84, 131072, v84
s_add_u32 m0, s36, 20480
s_nop 0
global_load_lds_dwordx4 v84, s[74:75]
v_add_u32 v84, 131072, v84
s_add_u32 m0, s36, 24576
s_nop 0
global_load_lds_dwordx4 v84, s[74:75]
v_add_u32 v84, 131072, v84
s_add_u32 m0, s36, 28672
s_nop 0
global_load_lds_dwordx4 v84, s[74:75]
v_add_u32 v84, 131072, v84
s_add_u32 m0, s36, 32768
s_nop 0
global_load_lds_dwordx4 v84, s[74:75]
v_add_u32 v84, 131072, v84
s_add_u32 m0, s36, 36864
s_nop 0
global_load_lds_dwordx4 v84, s[74:75]
v_add_u32 v84, 131072, v84
s_add_u32 m0, s36, 40960
s_nop 0
global_load_lds_dwordx4 v84, s[74:75]
v_add_u32 v84, 131072, v84
s_add_u32 m0, s36, 45056
s_nop 0
global_load_lds_dwordx4 v84, s[74:75]
v_add_u32 v84, 131072, v84
s_add_u32 m0, s36, 49152
s_nop 0
global_load_lds_dwordx4 v84, s[74:75]
v_add_u32 v84, 131072, v84
s_add_u32 m0, s36, 53248
s_nop 0
global_load_lds_dwordx4 v84, s[74:75]
v_add_u32 v84, 131072, v84
s_add_u32 m0, s36, 57344
s_nop 0
global_load_lds_dwordx4 v84, s[74:75]
v_add_u32 v84, 131072, v84
s_add_u32 m0, s36, 61440
s_nop 0
global_load_lds_dwordx4 v84, s[74:75]
v_add_u32 v84, 131072, v84
s_lshl_b32 s36, s32, 10
s_add_u32 s36, s36, 65536
s_add_u32 m0, s36, 0
s_nop 0
global_load_lds_dwordx4 v84, s[74:75]
v_add_u32 v84, 131072, v84
s_add_u32 m0, s36, 4096
s_nop 0
global_load_lds_dwordx4 v84, s[74:75]
v_add_u32 v84, 131072, v84
s_add_u32 m0, s36, 8192
s_nop 0
global_load_lds_dwordx4 v84, s[74:75]
v_add_u32 v84, 131072, v84
s_add_u32 m0, s36, 12288
s_nop 0
global_load_lds_dwordx4 v84, s[74:75]
v_add_u32 v84, 131072, v84
s_add_u32 m0, s36, 16384
s_nop 0
global_load_lds_dwordx4 v84, s[74:75]
v_add_u32 v84, 131072, v84
s_add_u32 m0, s36, 20480
s_nop 0
global_load_lds_dwordx4 v84, s[74:75]
v_add_u32 v84, 131072, v84
s_add_u32 m0, s36, 24576
s_nop 0
global_load_lds_dwordx4 v84, s[74:75]
v_add_u32 v84, 131072, v84
s_add_u32 m0, s36, 28672
s_nop 0
global_load_lds_dwordx4 v84, s[74:75]
v_add_u32 v84, 131072, v84
s_add_u32 m0, s36, 32768
s_nop 0
global_load_lds_dwordx4 v84, s[74:75]
v_add_u32 v84, 131072, v84
s_add_u32 m0, s36, 36864
s_nop 0
global_load_lds_dwordx4 v84, s[74:75]
v_add_u32 v84, 131072, v84
s_add_u32 m0, s36, 40960
s_nop 0
global_load_lds_dwordx4 v84, s[74:75]
v_add_u32 v84, 131072, v84
s_add_u32 m0, s36, 45056
s_nop 0
global_load_lds_dwordx4 v84, s[74:75]
v_add_u32 v84, 131072, v84
s_add_u32 m0, s36, 49152
s_nop 0
global_load_lds_dwordx4 v84, s[74:75]
v_add_u32 v84, 131072, v84
s_add_u32 m0, s36, 53248
s_nop 0
global_load_lds_dwordx4 v84, s[74:75]
v_add_u32 v84, 131072, v84
s_add_u32 m0, s36, 57344
s_nop 0
global_load_lds_dwordx4 v84, s[74:75]
v_add_u32 v84, 131072, v84
s_add_u32 m0, s36, 61440
s_nop 0
global_load_lds_dwordx4 v84, s[74:75]
v_add_u32 v84, 131072, v84
L_st_nsp:
s_cmp_lg_u32 s32, 0
s_cbranch_scc1 L_st_wait
s_mov_b64 exec, 1
v_mov_b32 v1, 0
s_branch L_st_both
L_st_nx0:
s_cmp_lg_u32 s32, 0
s_cbranch_scc1 L_st_wait
s_mov_b64 exec, 1
v_mov_b32 v1, 0
s_mov_b32 s35, -1
s_mov_b32 s98, 0
L_st_p0:
global_load_dword v2, v1, s[28:29] sc1
s_waitcnt vmcnt(0)
v_readfirstlane_b32 s36, v2
s_cmp_ge_u32 s36, 32
s_cbranch_scc1 L_st_both
s_add_u32 s98, s98, 1
s_cmp_lt_u32 s98, 60
s_cbranch_scc1 L_st_p0
s_lshl_b32 s36, s33, 2
v_mov_b32 v3, s36
v_mov_b32 v4, 1
global_atomic_add v2, v3, v4, s[28:29] offset:4 sc0
s_waitcnt vmcnt(0)
v_readfirstlane_b32 s35, v2
s_cmp_lg_u32 s35, 31
s_cbranch_scc1 L_st_both
s_mov_b32 s98, 0
L_st_cl:
global_load_dword v2, v1, s[28:29] sc1
s_waitcnt vmcnt(0)
v_readfirstlane_b32 s36, v2
s_cmp_ge_u32 s36, 32
s_cbranch_scc1 L_st_both
s_add_u32 s37, s33, 1
s_lshl_b32 s37, s37, 16
s_or_b32 s37, s37, s36
v_mov_b32 v6, s37
v_mov_b32 v7, s36
global_atomic_cmpswap v2, v1, v[6:7], s[28:29] sc0
s_waitcnt vmcnt(0)
s_add_u32 s98, s98, 1
s_cmp_lt_u32 s98, 64
s_cbranch_scc1 L_st_cl
L_st_both:
s_mov_b32 s98, 0
L_st_p1:
global_load_dword v2, v1, s[28:29] sc1
global_load_dword v3, v1, s[28:29] offset:68 sc1
s_waitcnt vmcnt(0)
v_readfirstlane_b32 s36, v2
v_readfirstlane_b32 s37, v3
s_cmp_ge_u32 s36, 32
s_cselect_b32 s37, s37, 0
s_cmp_lg_u32 s37, 0
s_cbranch_scc1 L_st_el
s_add_u32 s98, s98, 1
s_cmp_lt_u32 s98, 200000
s_cbranch_scc1 L_st_p1
v_mov_b32 v2, 1
global_store_dword v1, v2, s[28:29] offset:240
s_mov_b32 s35, 0xffff
s_branch L_st_pub
L_st_el:
s_lshr_b32 s36, s36, 16
s_cmp_eq_u32 s36, 0
s_cselect_b32 s36, 1, s36
s_add_u32 s37, s33, 1
s_cmp_eq_u32 s36, s37
s_cselect_b32 s37, 1, 0
s_cmp_lt_u32 s35, 32
s_cselect_b32 s37, s37, 0
s_cmp_lg_u32 s37, 0
s_cbranch_scc0 L_st_gen
s_add_u32 s35, s35, 0x1000
s_branch L_st_pub
L_st_gen:
v_mov_b32 v4, 1
global_atomic_add v2, v1, v4, s[28:29] offset:128 sc0
s_waitcnt vmcnt(0)
v_readfirstlane_b32 s35, v2
L_st_pub:
s_nop 1
v_mov_b32 v2, s35
v_mov_b32 v3, 163832
ds_write_b32 v3, v2
s_waitcnt lgkmcnt(0)
s_mov_b64 exec, -1
L_st_wait:
s_barrier
v_mov_b32 v1, 0
v_mov_b32 v3, 163832
ds_read_b32 v2, v3
s_waitcnt lgkmcnt(0)
v_readfirstlane_b32 s34, v2
s_sub_u32 s36, s34, 0x1000
s_cmp_lt_u32 s36, 32
s_cbranch_scc1 L_st_rec
s_waitcnt vmcnt(0)
L_st_rec:
s_barrier
s_sub_u32 s36, s34, 0x1000
s_cmp_lt_u32 s36, 32
s_cbranch_scc1 L_rec
s_cmp_lt_u32 s34, 64
s_cbranch_scc1 L_kv
s_sub_u32 s34, s34, 64
s_cmp_lt_u32 s34, 22
s_cbranch_scc1 L_ffn
s_sub_u32 s34, s34, 22
s_cmp_lt_u32 s34, 64
s_cbranch_scc1 L_att
s_sub_u32 s34, s34, 64
s_cmp_lt_u32 s34, 64
s_cbranch_scc1 L_wo
s_sub_u32 s34, s34, 64
L_end:
s_endpgm
L_fail:
s_mov_b64 exec, 1
v_mov_b32 v1, s99
v_mov_b32 v2, 240
global_store_dword v2, v1, s[28:29]
v_mov_b32 v1, s2
global_store_dword v2, v1, s[28:29] offset:4
s_waitcnt vmcnt(0)
s_endpgm
L_kv:
s_and_b32 s41, s34, 31
s_lshr_b32 s42, s34, 5
s_xor_b32 s42, s42, 1
s_lshl_b32 s36, s41, 8
s_add_u32 s44, s10, s36
s_addc_u32 s45, s11, 0
s_add_u32 s46, s12, s36
s_addc_u32 s47, s13, 0
s_cmp_lt_u32 s34, 32
s_cbranch_scc0 L_kv_noln0
s_lshl_b32 s40, s34, 2
s_add_u32 s40, s40, s32
s_lshl_b32 s36, s40, 14
s_add_u32 s48, s4, s36
s_addc_u32 s49, s5, 0
v_and_b32 v2, 15, v0
v_bfe_u32 v3, v0, 4, 2
v_lshlrev_b32 v2, 10, v2
v_lshl_add_u32 v2, v3, 4, v2
global_load_dwordx4 v[64:67], v2, s[48:49] offset:0
global_load_dwordx4 v[68:71], v2, s[48:49] offset:64
global_load_dwordx4 v[72:75], v2, s[48:49] offset:128
global_load_dwordx4 v[76:79], v2, s[48:49] offset:192
global_load_dwordx4 v[80:83], v2, s[48:49] offset:256
global_load_dwordx4 v[84:87], v2, s[48:49] offset:320
global_load_dwordx4 v[88:91], v2, s[48:49] offset:384
global_load_dwordx4 v[92:95], v2, s[48:49] offset:448
global_load_dwordx4 v[96:99], v2, s[48:49] offset:512
global_load_dwordx4 v[100:103], v2, s[48:49] offset:576
global_load_dwordx4 v[104:107], v2, s[48:49] offset:640
global_load_dwordx4 v[108:111], v2, s[48:49] offset:704
global_load_dwordx4 v[112:115], v2, s[48:49] offset:768
global_load_dwordx4 v[116:119], v2, s[48:49] offset:832
global_load_dwordx4 v[120:123], v2, s[48:49] offset:896
global_load_dwordx4 v[124:127], v2, s[48:49] offset:960
L_kv_noln0:
s_cmp_lt_u32 s34, 32
s_cbranch_scc0 L_kv_noln1
s_waitcnt vmcnt(0)
v_lshlrev_b32 v128, 16, v64
v_and_b32 v129, 0xffff0000, v64
v_lshlrev_b32 v130, 16, v65
v_and_b32 v131, 0xffff0000, v65
v_lshlrev_b32 v132, 16, v66
v_and_b32 v133, 0xffff0000, v66
v_lshlrev_b32 v134, 16, v67
v_and_b32 v135, 0xffff0000, v67
v_lshlrev_b32 v136, 16, v68
v_and_b32 v137, 0xffff0000, v68
v_lshlrev_b32 v138, 16, v69
v_and_b32 v139, 0xffff0000, v69
v_lshlrev_b32 v140, 16, v70
v_and_b32 v141, 0xffff0000, v70
v_lshlrev_b32 v142, 16, v71
v_and_b32 v143, 0xffff0000, v71
v_lshlrev_b32 v144, 16, v72
v_and_b32 v145, 0xffff0000, v72
v_lshlrev_b32 v146, 16, v73
v_and_b32 v147, 0xffff0000, v73
v_lshlrev_b32 v148, 16, v74
v_and_b32 v149, 0xffff0000, v74
v_lshlrev_b32 v150, 16, v75
v_and_b32 v151, 0xffff0000, v75
v_lshlrev_b32 v152, 16, v76
v_and_b32 v153, 0xffff0000, v76
v_lshlrev_b32 v154, 16, v77
v_and_b32 v155, 0xffff0000, v77
v_lshlrev_b32 v156, 16, v78
v_and_b32 v157, 0xffff0000, v78
v_lshlrev_b32 v158, 16, v79
v_and_b32 v159, 0xffff0000, v79
v_lshlrev_b32 v160, 16, v80
v_and_b32 v161, 0xffff0000, v80
v_lshlrev_b32 v162, 16, v81
v_and_b32 v163, 0xffff0000, v81
v_lshlrev_b32 v164, 16, v82
v_and_b32 v165, 0xffff0000, v82
v_lshlrev_b32 v166, 16, v83
v_and_b32 v167, 0xffff0000, v83
v_lshlrev_b32 v168, 16, v84
v_and_b32 v169, 0xffff0000, v84
v_lshlrev_b32 v170, 16, v85
v_and_b32 v171, 0xffff0000, v85
v_lshlrev_b32 v172, 16, v86
v_and_b32 v173, 0xffff0000, v86
v_lshlrev_b32 v174, 16, v87
v_and_b32 v175, 0xffff0000, v87
v_lshlrev_b32 v176, 16, v88
v_and_b32 v177, 0xffff0000, v88
v_lshlrev_b32 v178, 16, v89
v_and_b32 v179, 0xffff0000, v89
v_lshlrev_b32 v180, 16, v90
v_and_b32 v181, 0xffff0000, v90
v_lshlrev_b32 v182, 16, v91
v_and_b32 v183, 0xffff0000, v91
v_lshlrev_b32 v184, 16, v92
v_and_b32 v185, 0xffff0000, v92
v_lshlrev_b32 v186, 16, v93
v_and_b32 v187, 0xffff0000, v93
v_lshlrev_b32 v188, 16, v94
v_and_b32 v189, 0xffff0000, v94
v_lshlrev_b32 v190, 16, v95
v_and_b32 v191, 0xffff0000, v95
v_lshlrev_b32 v192, 16, v96
v_and_b32 v193, 0xffff0000, v96
v_lshlrev_b32 v194, 16, v97
v_and_b32 v195, 0xffff0000, v97
v_lshlrev_b32 v196, 16, v98
v_and_b32 v197, 0xffff0000, v98
v_lshlrev_b32 v198, 16, v99
v_and_b32 v199, 0xffff0000, v99
v_lshlrev_b32 v200, 16, v100
v_and_b32 v201, 0xffff0000, v100
v_lshlrev_b32 v202, 16, v101
v_and_b32 v203, 0xffff0000, v101
v_lshlrev_b32 v204, 16, v102
v_and_b32 v205, 0xffff0000, v102
v_lshlrev_b32 v206, 16, v103
v_and_b32 v207, 0xffff0000, v103
v_lshlrev_b32 v208, 16, v104
v_and_b32 v209, 0xffff0000, v104
v_lshlrev_b32 v210, 16, v105
v_and_b32 v211, 0xffff0000, v105
v_lshlrev_b32 v212, 16, v106
v_and_b32 v213, 0xffff0000, v106
v_lshlrev_b32 v214, 16, v107
v_and_b32 v215, 0xffff0000, v107
v_lshlrev_b32 v216, 16, v108
v_and_b32 v217, 0xffff0000, v108
v_lshlrev_b32 v218, 16, v109
v_and_b32 v219, 0xffff0000, v109
v_lshlrev_b32 v220, 16, v110
v_and_b32 v221, 0xffff0000, v110
v_lshlrev_b32 v222, 16, v111
v_and_b32 v223, 0xffff0000, v111
v_lshlrev_b32 v224, 16, v112
v_and_b32 v225, 0xffff0000, v112
v_lshlrev_b32 v226, 16, v113
v_and_b32 v227, 0xffff0000, v113
v_lshlrev_b32 v228, 16, v114
v_and_b32 v229, 0xffff0000, v114
v_lshlrev_b32 v230, 16, v115
v_and_b32 v231, 0xffff0000, v115
v_lshlrev_b32 v232, 16, v116
v_and_b32 v233, 0xffff0000, v116
v_lshlrev_b32 v234, 16, v117
v_and_b32 v235, 0xffff0000, v117
v_lshlrev_b32 v236, 16, v118
v_and_b32 v237, 0xffff0000, v118
v_lshlrev_b32 v238, 16, v119
v_and_b32 v239, 0xffff0000, v119
v_lshlrev_b32 v240, 16, v120
v_and_b32 v241, 0xffff0000, v120
v_lshlrev_b32 v242, 16, v121
v_and_b32 v243, 0xffff0000, v121
v_lshlrev_b32 v244, 16, v122
v_and_b32 v245, 0xffff0000, v122
v_lshlrev_b32 v246, 16, v123
v_and_b32 v247, 0xffff0000, v123
v_lshlrev_b32 v248, 16, v124
v_and_b32 v249, 0xffff0000, v124
v_lshlrev_b32 v250, 16, v125
v_and_b32 v251, 0xffff0000, v125
v_lshlrev_b32 v252, 16, v126
v_and_b32 v253, 0xffff0000, v126
v_lshlrev_b32 v254, 16, v127
v_and_b32 v255, 0xffff0000, v127
v_pk_add_f32 v[2:3], v[128:129], v[130:131]
v_pk_add_f32 v[4:5], v[132:133], v[134:135]
v_pk_add_f32 v[2:3], v[2:3], v[136:137]
v_pk_add_f32 v[4:5], v[4:5], v[138:139]
v_pk_add_f32 v[2:3], v[2:3], v[140:141]
v_pk_add_f32 v[4:5], v[4:5], v[142:143]
v_pk_add_f32 v[2:3], v[2:3], v[144:145]
v_pk_add_f32 v[4:5], v[4:5], v[146:147]
v_pk_add_f32 v[2:3], v[2:3], v[148:149]
v_pk_add_f32 v[4:5], v[4:5], v[150:151]
v_pk_add_f32 v[2:3], v[2:3], v[152:153]
v_pk_add_f32 v[4:5], v[4:5], v[154:155]
v_pk_add_f32 v[2:3], v[2:3], v[156:157]
v_pk_add_f32 v[4:5], v[4:5], v[158:159]
v_pk_add_f32 v[2:3], v[2:3], v[160:161]
v_pk_add_f32 v[4:5], v[4:5], v[162:163]
v_pk_add_f32 v[2:3], v[2:3], v[164:165]
v_pk_add_f32 v[4:5], v[4:5], v[166:167]
v_pk_add_f32 v[2:3], v[2:3], v[168:169]
v_pk_add_f32 v[4:5], v[4:5], v[170:171]
v_pk_add_f32 v[2:3], v[2:3], v[172:173]
v_pk_add_f32 v[4:5], v[4:5], v[174:175]
v_pk_add_f32 v[2:3], v[2:3], v[176:177]
v_pk_add_f32 v[4:5], v[4:5], v[178:179]
v_pk_add_f32 v[2:3], v[2:3], v[180:181]
v_pk_add_f32 v[4:5], v[4:5], v[182:183]
v_pk_add_f32 v[2:3], v[2:3], v[184:185]
v_pk_add_f32 v[4:5], v[4:5], v[186:187]
v_pk_add_f32 v[2:3], v[2:3], v[188:189]
v_pk_add_f32 v[4:5], v[4:5], v[190:191]
v_pk_add_f32 v[2:3], v[2:3], v[192:193]
v_pk_add_f32 v[4:5], v[4:5], v[194:195]
v_pk_add_f32 v[2:3], v[2:3], v[196:197]
v_pk_add_f32 v[4:5], v[4:5], v[198:199]
v_pk_add_f32 v[2:3], v[2:3], v[200:201]
v_pk_add_f32 v[4:5], v[4:5], v[202:203]
v_pk_add_f32 v[2:3], v[2:3], v[204:205]
v_pk_add_f32 v[4:5], v[4:5], v[206:207]
v_pk_add_f32 v[2:3], v[2:3], v[208:209]
v_pk_add_f32 v[4:5], v[4:5], v[210:211]
v_pk_add_f32 v[2:3], v[2:3], v[212:213]
v_pk_add_f32 v[4:5], v[4:5], v[214:215]
v_pk_add_f32 v[2:3], v[2:3], v[216:217]
v_pk_add_f32 v[4:5], v[4:5], v[218:219]
v_pk_add_f32 v[2:3], v[2:3], v[220:221]
v_pk_add_f32 v[4:5], v[4:5], v[222:223]
v_pk_add_f32 v[2:3], v[2:3], v[224:225]
v_pk_add_f32 v[4:5], v[4:5], v[226:227]
v_pk_add_f32 v[2:3], v[2:3], v[228:229]
v_pk_add_f32 v[4:5], v[4:5], v[230:231]
v_pk_add_f32 v[2:3], v[2:3], v[232:233]
v_pk_add_f32 v[4:5], v[4:5], v[234:235]
v_pk_add_f32 v[2:3], v[2:3], v[236:237]
v_pk_add_f32 v[4:5], v[4:5], v[238:239]
v_pk_add_f32 v[2:3], v[2:3], v[240:241]
v_pk_add_f32 v[4:5], v[4:5], v[242:243]
v_pk_add_f32 v[2:3], v[2:3], v[244:245]
v_pk_add_f32 v[4:5], v[4:5], v[246:247]
v_pk_add_f32 v[2:3], v[2:3], v[248:249]
v_pk_add_f32 v[4:5], v[4:5], v[250:251]
v_pk_add_f32 v[2:3], v[2:3], v[252:253]
v_pk_add_f32 v[4:5], v[4:5], v[254:255]
v_pk_add_f32 v[2:3], v[2:3], v[4:5]
v_add_f32 v2, v2, v3
v_mov_b32 v3, v2
s_nop 1
v_permlane32_swap_b32 v2, v3
v_add_f32 v2, v2, v3
v_mov_b32 v3, v2
s_nop 1
v_permlane16_swap_b32 v2, v3
v_add_f32 v2, v2, v3
v_mul_f32 v2, 0x3b000000, v2
v_sub_f32 v6, 0, v2
v_mov_b32 v7, v6
v_mov_b32 v8, 0
v_mov_b32 v9, 0
v_mov_b32 v10, 0
v_mov_b32 v11, 0
v_pk_add_f32 v[12:13], v[128:129], v[6:7]
v_pk_add_f32 v[14:15], v[130:131], v[6:7]
v_pk_fma_f32 v[8:9], v[12:13], v[12:13], v[8:9]
v_pk_fma_f32 v[10:11], v[14:15], v[14:15], v[10:11]
v_pk_add_f32 v[12:13], v[132:133], v[6:7]
v_pk_add_f32 v[14:15], v[134:135], v[6:7]
v_pk_fma_f32 v[8:9], v[12:13], v[12:13], v[8:9]
v_pk_fma_f32 v[10:11], v[14:15], v[14:15], v[10:11]
v_pk_add_f32 v[12:13], v[136:137], v[6:7]
v_pk_add_f32 v[14:15], v[138:139], v[6:7]
v_pk_fma_f32 v[8:9], v[12:13], v[12:13], v[8:9]
v_pk_fma_f32 v[10:11], v[14:15], v[14:15], v[10:11]
v_pk_add_f32 v[12:13], v[140:141], v[6:7]
v_pk_add_f32 v[14:15], v[142:143], v[6:7]
v_pk_fma_f32 v[8:9], v[12:13], v[12:13], v[8:9]
v_pk_fma_f32 v[10:11], v[14:15], v[14:15], v[10:11]
v_pk_add_f32 v[12:13], v[144:145], v[6:7]
v_pk_add_f32 v[14:15], v[146:147], v[6:7]
v_pk_fma_f32 v[8:9], v[12:13], v[12:13], v[8:9]
v_pk_fma_f32 v[10:11], v[14:15], v[14:15], v[10:11]
v_pk_add_f32 v[12:13], v[148:149], v[6:7]
v_pk_add_f32 v[14:15], v[150:151], v[6:7]
v_pk_fma_f32 v[8:9], v[12:13], v[12:13], v[8:9]
v_pk_fma_f32 v[10:11], v[14:15], v[14:15], v[10:11]
v_pk_add_f32 v[12:13], v[152:153], v[6:7]
v_pk_add_f32 v[14:15], v[154:155], v[6:7]
v_pk_fma_f32 v[8:9], v[12:13], v[12:13], v[8:9]
v_pk_fma_f32 v[10:11], v[14:15], v[14:15], v[10:11]
v_pk_add_f32 v[12:13], v[156:157], v[6:7]
v_pk_add_f32 v[14:15], v[158:159], v[6:7]
v_pk_fma_f32 v[8:9], v[12:13], v[12:13], v[8:9]
v_pk_fma_f32 v[10:11], v[14:15], v[14:15], v[10:11]
v_pk_add_f32 v[12:13], v[160:161], v[6:7]
v_pk_add_f32 v[14:15], v[162:163], v[6:7]
v_pk_fma_f32 v[8:9], v[12:13], v[12:13], v[8:9]
v_pk_fma_f32 v[10:11], v[14:15], v[14:15], v[10:11]
v_pk_add_f32 v[12:13], v[164:165], v[6:7]
v_pk_add_f32 v[14:15], v[166:167], v[6:7]
v_pk_fma_f32 v[8:9], v[12:13], v[12:13], v[8:9]
v_pk_fma_f32 v[10:11], v[14:15], v[14:15], v[10:11]
v_pk_add_f32 v[12:13], v[168:169], v[6:7]
v_pk_add_f32 v[14:15], v[170:171], v[6:7]
v_pk_fma_f32 v[8:9], v[12:13], v[12:13], v[8:9]
v_pk_fma_f32 v[10:11], v[14:15], v[14:15], v[10:11]
v_pk_add_f32 v[12:13], v[172:173], v[6:7]
v_pk_add_f32 v[14:15], v[174:175], v[6:7]
v_pk_fma_f32 v[8:9], v[12:13], v[12:13], v[8:9]
v_pk_fma_f32 v[10:11], v[14:15], v[14:15], v[10:11]
v_pk_add_f32 v[12:13], v[176:177], v[6:7]
v_pk_add_f32 v[14:15], v[178:179], v[6:7]
v_pk_fma_f32 v[8:9], v[12:13], v[12:13], v[8:9]
v_pk_fma_f32 v[10:11], v[14:15], v[14:15], v[10:11]
v_pk_add_f32 v[12:13], v[180:181], v[6:7]
v_pk_add_f32 v[14:15], v[182:183], v[6:7]
v_pk_fma_f32 v[8:9], v[12:13], v[12:13], v[8:9]
v_pk_fma_f32 v[10:11], v[14:15], v[14:15], v[10:11]
v_pk_add_f32 v[12:13], v[184:185], v[6:7]
v_pk_add_f32 v[14:15], v[186:187], v[6:7]
v_pk_fma_f32 v[8:9], v[12:13], v[12:13], v[8:9]
v_pk_fma_f32 v[10:11], v[14:15], v[14:15], v[10:11]
v_pk_add_f32 v[12:13], v[188:189], v[6:7]
v_pk_add_f32 v[14:15], v[190:191], v[6:7]
v_pk_fma_f32 v[8:9], v[12:13], v[12:13], v[8:9]
v_pk_fma_f32 v[10:11], v[14:15], v[14:15], v[10:11]
v_pk_add_f32 v[12:13], v[192:193], v[6:7]
v_pk_add_f32 v[14:15], v[194:195], v[6:7]
v_pk_fma_f32 v[8:9], v[12:13], v[12:13], v[8:9]
v_pk_fma_f32 v[10:11], v[14:15], v[14:15], v[10:11]
v_pk_add_f32 v[12:13], v[196:197], v[6:7]
v_pk_add_f32 v[14:15], v[198:199], v[6:7]
v_pk_fma_f32 v[8:9], v[12:13], v[12:13], v[8:9]
v_pk_fma_f32 v[10:11], v[14:15], v[14:15], v[10:11]
v_pk_add_f32 v[12:13], v[200:201], v[6:7]
v_pk_add_f32 v[14:15], v[202:203], v[6:7]
v_pk_fma_f32 v[8:9], v[12:13], v[12:13], v[8:9]
v_pk_fma_f32 v[10:11], v[14:15], v[14:15], v[10:11]
v_pk_add_f32 v[12:13], v[204:205], v[6:7]
v_pk_add_f32 v[14:15], v[206:207], v[6:7]
v_pk_fma_f32 v[8:9], v[12:13], v[12:13], v[8:9]
v_pk_fma_f32 v[10:11], v[14:15], v[14:15], v[10:11]
v_pk_add_f32 v[12:13], v[208:209], v[6:7]
v_pk_add_f32 v[14:15], v[210:211], v[6:7]
v_pk_fma_f32 v[8:9], v[12:13], v[12:13], v[8:9]
v_pk_fma_f32 v[10:11], v[14:15], v[14:15], v[10:11]
v_pk_add_f32 v[12:13], v[212:213], v[6:7]
v_pk_add_f32 v[14:15], v[214:215], v[6:7]
v_pk_fma_f32 v[8:9], v[12:13], v[12:13], v[8:9]
v_pk_fma_f32 v[10:11], v[14:15], v[14:15], v[10:11]
v_pk_add_f32 v[12:13], v[216:217], v[6:7]
v_pk_add_f32 v[14:15], v[218:219], v[6:7]
v_pk_fma_f32 v[8:9], v[12:13], v[12:13], v[8:9]
v_pk_fma_f32 v[10:11], v[14:15], v[14:15], v[10:11]
v_pk_add_f32 v[12:13], v[220:221], v[6:7]
v_pk_add_f32 v[14:15], v[222:223], v[6:7]
v_pk_fma_f32 v[8:9], v[12:13], v[12:13], v[8:9]
v_pk_fma_f32 v[10:11], v[14:15], v[14:15], v[10:11]
v_pk_add_f32 v[12:13], v[224:225], v[6:7]
v_pk_add_f32 v[14:15], v[226:227], v[6:7]
v_pk_fma_f32 v[8:9], v[12:13], v[12:13], v[8:9]
v_pk_fma_f32 v[10:11], v[14:15], v[14:15], v[10:11]
v_pk_add_f32 v[12:13], v[228:229], v[6:7]
v_pk_add_f32 v[14:15], v[230:231], v[6:7]
v_pk_fma_f32 v[8:9], v[12:13], v[12:13], v[8:9]
v_pk_fma_f32 v[10:11], v[14:15], v[14:15], v[10:11]
v_pk_add_f32 v[12:13], v[232:233], v[6:7]
v_pk_add_f32 v[14:15], v[234:235], v[6:7]
v_pk_fma_f32 v[8:9], v[12:13], v[12:13], v[8:9]
v_pk_fma_f32 v[10:11], v[14:15], v[14:15], v[10:11]
v_pk_add_f32 v[12:13], v[236:237], v[6:7]
v_pk_add_f32 v[14:15], v[238:239], v[6:7]
v_pk_fma_f32 v[8:9], v[12:13], v[12:13], v[8:9]
v_pk_fma_f32 v[10:11], v[14:15], v[14:15], v[10:11]
v_pk_add_f32 v[12:13], v[240:241], v[6:7]
v_pk_add_f32 v[14:15], v[242:243], v[6:7]
v_pk_fma_f32 v[8:9], v[12:13], v[12:13], v[8:9]
v_pk_fma_f32 v[10:11], v[14:15], v[14:15], v[10:11]
v_pk_add_f32 v[12:13], v[244:245], v[6:7]
v_pk_add_f32 v[14:15], v[246:247], v[6:7]
v_pk_fma_f32 v[8:9], v[12:13], v[12:13], v[8:9]
v_pk_fma_f32 v[10:11], v[14:15], v[14:15], v[10:11]
v_pk_add_f32 v[12:13], v[248:249], v[6:7]
v_pk_add_f32 v[14:15], v[250:251], v[6:7]
v_pk_fma_f32 v[8:9], v[12:13], v[12:13], v[8:9]
v_pk_fma_f32 v[10:11], v[14:15], v[14:15], v[10:11]
v_pk_add_f32 v[12:13], v[252:253], v[6:7]
v_pk_add_f32 v[14:15], v[254:255], v[6:7]
v_pk_fma_f32 v[8:9], v[12:13], v[12:13], v[8:9]
v_pk_fma_f32 v[10:11], v[14:15], v[14:15], v[10:11]
v_pk_add_f32 v[8:9], v[8:9], v[10:11]
v_add_f32 v8, v8, v9
v_mov_b32 v9, v8
s_nop 1
v_permlane32_swap_b32 v8, v9
v_add_f32 v8, v8, v9
v_mov_b32 v9, v8
s_nop 1
v_permlane16_swap_b32 v8, v9
v_add_f32 v8, v8, v9
v_mul_f32 v8, 0x3b000000, v8
v_cvt_pk_bf16_f32 v2, v2, v8
v_and_b32 v8, 0xffff0000, v2
v_lshlrev_b32 v2, 16, v2
v_add_f32 v8, 0x3727c5ac, v8
v_cvt_pk_bf16_f32 v8, v8, v8
v_lshlrev_b32 v8, 16, v8
v_sqrt_f32 v8, v8
s_nop 0
v_cvt_pk_bf16_f32 v8, v8, v8
v_lshlrev_b32 v8, 16, v8
v_rcp_f32 v8, v8
v_sub_f32 v6, 0, v2
v_mov_b32 v7, v6
v_mov_b32 v9, v8
v_pk_add_f32 v[12:13], v[128:129], v[6:7]
v_cvt_pk_bf16_f32 v12, v12, v13
v_and_b32 v13, 0xffff0000, v12
v_lshlrev_b32 v12, 16, v12
v_pk_mul_f32 v[12:13], v[12:13], v[8:9]
v_cvt_pk_bf16_f32 v64, v12, v13
v_pk_add_f32 v[14:15], v[130:131], v[6:7]
v_cvt_pk_bf16_f32 v14, v14, v15
v_and_b32 v15, 0xffff0000, v14
v_lshlrev_b32 v14, 16, v14
v_pk_mul_f32 v[14:15], v[14:15], v[8:9]
v_cvt_pk_bf16_f32 v65, v14, v15
v_pk_add_f32 v[12:13], v[132:133], v[6:7]
v_cvt_pk_bf16_f32 v12, v12, v13
v_and_b32 v13, 0xffff0000, v12
v_lshlrev_b32 v12, 16, v12
v_pk_mul_f32 v[12:13], v[12:13], v[8:9]
v_cvt_pk_bf16_f32 v66, v12, v13
v_pk_add_f32 v[14:15], v[134:135], v[6:7]
v_cvt_pk_bf16_f32 v14, v14, v15
v_and_b32 v15, 0xffff0000, v14
v_lshlrev_b32 v14, 16, v14
v_pk_mul_f32 v[14:15], v[14:15], v[8:9]
v_cvt_pk_bf16_f32 v67, v14, v15
v_pk_add_f32 v[12:13], v[136:137], v[6:7]
v_cvt_pk_bf16_f32 v12, v12, v13
v_and_b32 v13, 0xffff0000, v12
v_lshlrev_b32 v12, 16, v12
v_pk_mul_f32 v[12:13], v[12:13], v[8:9]
v_cvt_pk_bf16_f32 v68, v12, v13
v_pk_add_f32 v[14:15], v[138:139], v[6:7]
v_cvt_pk_bf16_f32 v14, v14, v15
v_and_b32 v15, 0xffff0000, v14
v_lshlrev_b32 v14, 16, v14
v_pk_mul_f32 v[14:15], v[14:15], v[8:9]
v_cvt_pk_bf16_f32 v69, v14, v15
v_pk_add_f32 v[12:13], v[140:141], v[6:7]
v_cvt_pk_bf16_f32 v12, v12, v13
v_and_b32 v13, 0xffff0000, v12
v_lshlrev_b32 v12, 16, v12
v_pk_mul_f32 v[12:13], v[12:13], v[8:9]
v_cvt_pk_bf16_f32 v70, v12, v13
v_pk_add_f32 v[14:15], v[142:143], v[6:7]
v_cvt_pk_bf16_f32 v14, v14, v15
v_and_b32 v15, 0xffff0000, v14
v_lshlrev_b32 v14, 16, v14
v_pk_mul_f32 v[14:15], v[14:15], v[8:9]
v_cvt_pk_bf16_f32 v71, v14, v15
v_pk_add_f32 v[12:13], v[144:145], v[6:7]
v_cvt_pk_bf16_f32 v12, v12, v13
v_and_b32 v13, 0xffff0000, v12
v_lshlrev_b32 v12, 16, v12
v_pk_mul_f32 v[12:13], v[12:13], v[8:9]
v_cvt_pk_bf16_f32 v72, v12, v13
v_pk_add_f32 v[14:15], v[146:147], v[6:7]
v_cvt_pk_bf16_f32 v14, v14, v15
v_and_b32 v15, 0xffff0000, v14
v_lshlrev_b32 v14, 16, v14
v_pk_mul_f32 v[14:15], v[14:15], v[8:9]
v_cvt_pk_bf16_f32 v73, v14, v15
v_pk_add_f32 v[12:13], v[148:149], v[6:7]
v_cvt_pk_bf16_f32 v12, v12, v13
v_and_b32 v13, 0xffff0000, v12
v_lshlrev_b32 v12, 16, v12
v_pk_mul_f32 v[12:13], v[12:13], v[8:9]
v_cvt_pk_bf16_f32 v74, v12, v13
v_pk_add_f32 v[14:15], v[150:151], v[6:7]
v_cvt_pk_bf16_f32 v14, v14, v15
v_and_b32 v15, 0xffff0000, v14
v_lshlrev_b32 v14, 16, v14
v_pk_mul_f32 v[14:15], v[14:15], v[8:9]
v_cvt_pk_bf16_f32 v75, v14, v15
v_pk_add_f32 v[12:13], v[152:153], v[6:7]
v_cvt_pk_bf16_f32 v12, v12, v13
v_and_b32 v13, 0xffff0000, v12
v_lshlrev_b32 v12, 16, v12
v_pk_mul_f32 v[12:13], v[12:13], v[8:9]
v_cvt_pk_bf16_f32 v76, v12, v13
v_pk_add_f32 v[14:15], v[154:155], v[6:7]
v_cvt_pk_bf16_f32 v14, v14, v15
v_and_b32 v15, 0xffff0000, v14
v_lshlrev_b32 v14, 16, v14
v_pk_mul_f32 v[14:15], v[14:15], v[8:9]
v_cvt_pk_bf16_f32 v77, v14, v15
v_pk_add_f32 v[12:13], v[156:157], v[6:7]
v_cvt_pk_bf16_f32 v12, v12, v13
v_and_b32 v13, 0xffff0000, v12
v_lshlrev_b32 v12, 16, v12
v_pk_mul_f32 v[12:13], v[12:13], v[8:9]
v_cvt_pk_bf16_f32 v78, v12, v13
v_pk_add_f32 v[14:15], v[158:159], v[6:7]
v_cvt_pk_bf16_f32 v14, v14, v15
v_and_b32 v15, 0xffff0000, v14
v_lshlrev_b32 v14, 16, v14
v_pk_mul_f32 v[14:15], v[14:15], v[8:9]
v_cvt_pk_bf16_f32 v79, v14, v15
v_pk_add_f32 v[12:13], v[160:161], v[6:7]
v_cvt_pk_bf16_f32 v12, v12, v13
v_and_b32 v13, 0xffff0000, v12
v_lshlrev_b32 v12, 16, v12
v_pk_mul_f32 v[12:13], v[12:13], v[8:9]
v_cvt_pk_bf16_f32 v80, v12, v13
v_pk_add_f32 v[14:15], v[162:163], v[6:7]
v_cvt_pk_bf16_f32 v14, v14, v15
v_and_b32 v15, 0xffff0000, v14
v_lshlrev_b32 v14, 16, v14
v_pk_mul_f32 v[14:15], v[14:15], v[8:9]
v_cvt_pk_bf16_f32 v81, v14, v15
v_pk_add_f32 v[12:13], v[164:165], v[6:7]
v_cvt_pk_bf16_f32 v12, v12, v13
v_and_b32 v13, 0xffff0000, v12
v_lshlrev_b32 v12, 16, v12
v_pk_mul_f32 v[12:13], v[12:13], v[8:9]
v_cvt_pk_bf16_f32 v82, v12, v13
v_pk_add_f32 v[14:15], v[166:167], v[6:7]
v_cvt_pk_bf16_f32 v14, v14, v15
v_and_b32 v15, 0xffff0000, v14
v_lshlrev_b32 v14, 16, v14
v_pk_mul_f32 v[14:15], v[14:15], v[8:9]
v_cvt_pk_bf16_f32 v83, v14, v15
v_pk_add_f32 v[12:13], v[168:169], v[6:7]
v_cvt_pk_bf16_f32 v12, v12, v13
v_and_b32 v13, 0xffff0000, v12
v_lshlrev_b32 v12, 16, v12
v_pk_mul_f32 v[12:13], v[12:13], v[8:9]
v_cvt_pk_bf16_f32 v84, v12, v13
v_pk_add_f32 v[14:15], v[170:171], v[6:7]
v_cvt_pk_bf16_f32 v14, v14, v15
v_and_b32 v15, 0xffff0000, v14
v_lshlrev_b32 v14, 16, v14
v_pk_mul_f32 v[14:15], v[14:15], v[8:9]
v_cvt_pk_bf16_f32 v85, v14, v15
v_pk_add_f32 v[12:13], v[172:173], v[6:7]
v_cvt_pk_bf16_f32 v12, v12, v13
v_and_b32 v13, 0xffff0000, v12
v_lshlrev_b32 v12, 16, v12
v_pk_mul_f32 v[12:13], v[12:13], v[8:9]
v_cvt_pk_bf16_f32 v86, v12, v13
v_pk_add_f32 v[14:15], v[174:175], v[6:7]
v_cvt_pk_bf16_f32 v14, v14, v15
v_and_b32 v15, 0xffff0000, v14
v_lshlrev_b32 v14, 16, v14
v_pk_mul_f32 v[14:15], v[14:15], v[8:9]
v_cvt_pk_bf16_f32 v87, v14, v15
v_pk_add_f32 v[12:13], v[176:177], v[6:7]
v_cvt_pk_bf16_f32 v12, v12, v13
v_and_b32 v13, 0xffff0000, v12
v_lshlrev_b32 v12, 16, v12
v_pk_mul_f32 v[12:13], v[12:13], v[8:9]
v_cvt_pk_bf16_f32 v88, v12, v13
v_pk_add_f32 v[14:15], v[178:179], v[6:7]
v_cvt_pk_bf16_f32 v14, v14, v15
v_and_b32 v15, 0xffff0000, v14
v_lshlrev_b32 v14, 16, v14
v_pk_mul_f32 v[14:15], v[14:15], v[8:9]
v_cvt_pk_bf16_f32 v89, v14, v15
v_pk_add_f32 v[12:13], v[180:181], v[6:7]
v_cvt_pk_bf16_f32 v12, v12, v13
v_and_b32 v13, 0xffff0000, v12
v_lshlrev_b32 v12, 16, v12
v_pk_mul_f32 v[12:13], v[12:13], v[8:9]
v_cvt_pk_bf16_f32 v90, v12, v13
v_pk_add_f32 v[14:15], v[182:183], v[6:7]
v_cvt_pk_bf16_f32 v14, v14, v15
v_and_b32 v15, 0xffff0000, v14
v_lshlrev_b32 v14, 16, v14
v_pk_mul_f32 v[14:15], v[14:15], v[8:9]
v_cvt_pk_bf16_f32 v91, v14, v15
v_pk_add_f32 v[12:13], v[184:185], v[6:7]
v_cvt_pk_bf16_f32 v12, v12, v13
v_and_b32 v13, 0xffff0000, v12
v_lshlrev_b32 v12, 16, v12
v_pk_mul_f32 v[12:13], v[12:13], v[8:9]
v_cvt_pk_bf16_f32 v92, v12, v13
v_pk_add_f32 v[14:15], v[186:187], v[6:7]
v_cvt_pk_bf16_f32 v14, v14, v15
v_and_b32 v15, 0xffff0000, v14
v_lshlrev_b32 v14, 16, v14
v_pk_mul_f32 v[14:15], v[14:15], v[8:9]
v_cvt_pk_bf16_f32 v93, v14, v15
v_pk_add_f32 v[12:13], v[188:189], v[6:7]
v_cvt_pk_bf16_f32 v12, v12, v13
v_and_b32 v13, 0xffff0000, v12
v_lshlrev_b32 v12, 16, v12
v_pk_mul_f32 v[12:13], v[12:13], v[8:9]
v_cvt_pk_bf16_f32 v94, v12, v13
v_pk_add_f32 v[14:15], v[190:191], v[6:7]
v_cvt_pk_bf16_f32 v14, v14, v15
v_and_b32 v15, 0xffff0000, v14
v_lshlrev_b32 v14, 16, v14
v_pk_mul_f32 v[14:15], v[14:15], v[8:9]
v_cvt_pk_bf16_f32 v95, v14, v15
v_pk_add_f32 v[12:13], v[192:193], v[6:7]
v_cvt_pk_bf16_f32 v12, v12, v13
v_and_b32 v13, 0xffff0000, v12
v_lshlrev_b32 v12, 16, v12
v_pk_mul_f32 v[12:13], v[12:13], v[8:9]
v_cvt_pk_bf16_f32 v96, v12, v13
v_pk_add_f32 v[14:15], v[194:195], v[6:7]
v_cvt_pk_bf16_f32 v14, v14, v15
v_and_b32 v15, 0xffff0000, v14
v_lshlrev_b32 v14, 16, v14
v_pk_mul_f32 v[14:15], v[14:15], v[8:9]
v_cvt_pk_bf16_f32 v97, v14, v15
v_pk_add_f32 v[12:13], v[196:197], v[6:7]
v_cvt_pk_bf16_f32 v12, v12, v13
v_and_b32 v13, 0xffff0000, v12
v_lshlrev_b32 v12, 16, v12
v_pk_mul_f32 v[12:13], v[12:13], v[8:9]
v_cvt_pk_bf16_f32 v98, v12, v13
v_pk_add_f32 v[14:15], v[198:199], v[6:7]
v_cvt_pk_bf16_f32 v14, v14, v15
v_and_b32 v15, 0xffff0000, v14
v_lshlrev_b32 v14, 16, v14
v_pk_mul_f32 v[14:15], v[14:15], v[8:9]
v_cvt_pk_bf16_f32 v99, v14, v15
v_pk_add_f32 v[12:13], v[200:201], v[6:7]
v_cvt_pk_bf16_f32 v12, v12, v13
v_and_b32 v13, 0xffff0000, v12
v_lshlrev_b32 v12, 16, v12
v_pk_mul_f32 v[12:13], v[12:13], v[8:9]
v_cvt_pk_bf16_f32 v100, v12, v13
v_pk_add_f32 v[14:15], v[202:203], v[6:7]
v_cvt_pk_bf16_f32 v14, v14, v15
v_and_b32 v15, 0xffff0000, v14
v_lshlrev_b32 v14, 16, v14
v_pk_mul_f32 v[14:15], v[14:15], v[8:9]
v_cvt_pk_bf16_f32 v101, v14, v15
v_pk_add_f32 v[12:13], v[204:205], v[6:7]
v_cvt_pk_bf16_f32 v12, v12, v13
v_and_b32 v13, 0xffff0000, v12
v_lshlrev_b32 v12, 16, v12
v_pk_mul_f32 v[12:13], v[12:13], v[8:9]
v_cvt_pk_bf16_f32 v102, v12, v13
v_pk_add_f32 v[14:15], v[206:207], v[6:7]
v_cvt_pk_bf16_f32 v14, v14, v15
v_and_b32 v15, 0xffff0000, v14
v_lshlrev_b32 v14, 16, v14
v_pk_mul_f32 v[14:15], v[14:15], v[8:9]
v_cvt_pk_bf16_f32 v103, v14, v15
v_pk_add_f32 v[12:13], v[208:209], v[6:7]
v_cvt_pk_bf16_f32 v12, v12, v13
v_and_b32 v13, 0xffff0000, v12
v_lshlrev_b32 v12, 16, v12
v_pk_mul_f32 v[12:13], v[12:13], v[8:9]
v_cvt_pk_bf16_f32 v104, v12, v13
v_pk_add_f32 v[14:15], v[210:211], v[6:7]
v_cvt_pk_bf16_f32 v14, v14, v15
v_and_b32 v15, 0xffff0000, v14
v_lshlrev_b32 v14, 16, v14
v_pk_mul_f32 v[14:15], v[14:15], v[8:9]
v_cvt_pk_bf16_f32 v105, v14, v15
v_pk_add_f32 v[12:13], v[212:213], v[6:7]
v_cvt_pk_bf16_f32 v12, v12, v13
v_and_b32 v13, 0xffff0000, v12
v_lshlrev_b32 v12, 16, v12
v_pk_mul_f32 v[12:13], v[12:13], v[8:9]
v_cvt_pk_bf16_f32 v106, v12, v13
v_pk_add_f32 v[14:15], v[214:215], v[6:7]
v_cvt_pk_bf16_f32 v14, v14, v15
v_and_b32 v15, 0xffff0000, v14
v_lshlrev_b32 v14, 16, v14
v_pk_mul_f32 v[14:15], v[14:15], v[8:9]
v_cvt_pk_bf16_f32 v107, v14, v15
v_pk_add_f32 v[12:13], v[216:217], v[6:7]
v_cvt_pk_bf16_f32 v12, v12, v13
v_and_b32 v13, 0xffff0000, v12
v_lshlrev_b32 v12, 16, v12
v_pk_mul_f32 v[12:13], v[12:13], v[8:9]
v_cvt_pk_bf16_f32 v108, v12, v13
v_pk_add_f32 v[14:15], v[218:219], v[6:7]
v_cvt_pk_bf16_f32 v14, v14, v15
v_and_b32 v15, 0xffff0000, v14
v_lshlrev_b32 v14, 16, v14
v_pk_mul_f32 v[14:15], v[14:15], v[8:9]
v_cvt_pk_bf16_f32 v109, v14, v15
v_pk_add_f32 v[12:13], v[220:221], v[6:7]
v_cvt_pk_bf16_f32 v12, v12, v13
v_and_b32 v13, 0xffff0000, v12
v_lshlrev_b32 v12, 16, v12
v_pk_mul_f32 v[12:13], v[12:13], v[8:9]
v_cvt_pk_bf16_f32 v110, v12, v13
v_pk_add_f32 v[14:15], v[222:223], v[6:7]
v_cvt_pk_bf16_f32 v14, v14, v15
v_and_b32 v15, 0xffff0000, v14
v_lshlrev_b32 v14, 16, v14
v_pk_mul_f32 v[14:15], v[14:15], v[8:9]
v_cvt_pk_bf16_f32 v111, v14, v15
v_pk_add_f32 v[12:13], v[224:225], v[6:7]
v_cvt_pk_bf16_f32 v12, v12, v13
v_and_b32 v13, 0xffff0000, v12
v_lshlrev_b32 v12, 16, v12
v_pk_mul_f32 v[12:13], v[12:13], v[8:9]
v_cvt_pk_bf16_f32 v112, v12, v13
v_pk_add_f32 v[14:15], v[226:227], v[6:7]
v_cvt_pk_bf16_f32 v14, v14, v15
v_and_b32 v15, 0xffff0000, v14
v_lshlrev_b32 v14, 16, v14
v_pk_mul_f32 v[14:15], v[14:15], v[8:9]
v_cvt_pk_bf16_f32 v113, v14, v15
v_pk_add_f32 v[12:13], v[228:229], v[6:7]
v_cvt_pk_bf16_f32 v12, v12, v13
v_and_b32 v13, 0xffff0000, v12
v_lshlrev_b32 v12, 16, v12
v_pk_mul_f32 v[12:13], v[12:13], v[8:9]
v_cvt_pk_bf16_f32 v114, v12, v13
v_pk_add_f32 v[14:15], v[230:231], v[6:7]
v_cvt_pk_bf16_f32 v14, v14, v15
v_and_b32 v15, 0xffff0000, v14
v_lshlrev_b32 v14, 16, v14
v_pk_mul_f32 v[14:15], v[14:15], v[8:9]
v_cvt_pk_bf16_f32 v115, v14, v15
v_pk_add_f32 v[12:13], v[232:233], v[6:7]
v_cvt_pk_bf16_f32 v12, v12, v13
v_and_b32 v13, 0xffff0000, v12
v_lshlrev_b32 v12, 16, v12
v_pk_mul_f32 v[12:13], v[12:13], v[8:9]
v_cvt_pk_bf16_f32 v116, v12, v13
v_pk_add_f32 v[14:15], v[234:235], v[6:7]
v_cvt_pk_bf16_f32 v14, v14, v15
v_and_b32 v15, 0xffff0000, v14
v_lshlrev_b32 v14, 16, v14
v_pk_mul_f32 v[14:15], v[14:15], v[8:9]
v_cvt_pk_bf16_f32 v117, v14, v15
v_pk_add_f32 v[12:13], v[236:237], v[6:7]
v_cvt_pk_bf16_f32 v12, v12, v13
v_and_b32 v13, 0xffff0000, v12
v_lshlrev_b32 v12, 16, v12
v_pk_mul_f32 v[12:13], v[12:13], v[8:9]
v_cvt_pk_bf16_f32 v118, v12, v13
v_pk_add_f32 v[14:15], v[238:239], v[6:7]
v_cvt_pk_bf16_f32 v14, v14, v15
v_and_b32 v15, 0xffff0000, v14
v_lshlrev_b32 v14, 16, v14
v_pk_mul_f32 v[14:15], v[14:15], v[8:9]
v_cvt_pk_bf16_f32 v119, v14, v15
v_pk_add_f32 v[12:13], v[240:241], v[6:7]
v_cvt_pk_bf16_f32 v12, v12, v13
v_and_b32 v13, 0xffff0000, v12
v_lshlrev_b32 v12, 16, v12
v_pk_mul_f32 v[12:13], v[12:13], v[8:9]
v_cvt_pk_bf16_f32 v120, v12, v13
v_pk_add_f32 v[14:15], v[242:243], v[6:7]
v_cvt_pk_bf16_f32 v14, v14, v15
v_and_b32 v15, 0xffff0000, v14
v_lshlrev_b32 v14, 16, v14
v_pk_mul_f32 v[14:15], v[14:15], v[8:9]
v_cvt_pk_bf16_f32 v121, v14, v15
v_pk_add_f32 v[12:13], v[244:245], v[6:7]
v_cvt_pk_bf16_f32 v12, v12, v13
v_and_b32 v13, 0xffff0000, v12
v_lshlrev_b32 v12, 16, v12
v_pk_mul_f32 v[12:13], v[12:13], v[8:9]
v_cvt_pk_bf16_f32 v122, v12, v13
v_pk_add_f32 v[14:15], v[246:247], v[6:7]
v_cvt_pk_bf16_f32 v14, v14, v15
v_and_b32 v15, 0xffff0000, v14
v_lshlrev_b32 v14, 16, v14
v_pk_mul_f32 v[14:15], v[14:15], v[8:9]
v_cvt_pk_bf16_f32 v123, v14, v15
v_pk_add_f32 v[12:13], v[248:249], v[6:7]
v_cvt_pk_bf16_f32 v12, v12, v13
v_and_b32 v13, 0xffff0000, v12
v_lshlrev_b32 v12, 16, v12
v_pk_mul_f32 v[12:13], v[12:13], v[8:9]
v_cvt_pk_bf16_f32 v124, v12, v13
v_pk_add_f32 v[14:15], v[250:251], v[6:7]
v_cvt_pk_bf16_f32 v14, v14, v15
v_and_b32 v15, 0xffff0000, v14
v_lshlrev_b32 v14, 16, v14
v_pk_mul_f32 v[14:15], v[14:15], v[8:9]
v_cvt_pk_bf16_f32 v125, v14, v15
v_pk_add_f32 v[12:13], v[252:253], v[6:7]
v_cvt_pk_bf16_f32 v12, v12, v13
v_and_b32 v13, 0xffff0000, v12
v_lshlrev_b32 v12, 16, v12
v_pk_mul_f32 v[12:13], v[12:13], v[8:9]
v_cvt_pk_bf16_f32 v126, v12, v13
v_pk_add_f32 v[14:15], v[254:255], v[6:7]
v_cvt_pk_bf16_f32 v14, v14, v15
v_and_b32 v15, 0xffff0000, v14
v_lshlrev_b32 v14, 16, v14
v_pk_mul_f32 v[14:15], v[14:15], v[8:9]
v_cvt_pk_bf16_f32 v127, v14, v15
s_lshl_b32 s36, s40, 14
s_add_u32 s36, s36, 65536
s_add_u32 s48, s30, s36
s_addc_u32 s49, s31, 0
v_and_b32 v2, 63, v0
v_lshlrev_b32 v2, 4, v2
global_store_dwordx4 v2, v[64:67], s[48:49] offset:0 sc1
global_store_dwordx4 v2, v[68:71], s[48:49] offset:1024 sc1
global_store_dwordx4 v2, v[72:75], s[48:49] offset:2048 sc1
global_store_dwordx4 v2, v[76:79], s[48:49] offset:3072 sc1
v_add_u32 v2, 4096, v2
global_store_dwordx4 v2, v[80:83], s[48:49] offset:0 sc1
global_store_dwordx4 v2, v[84:87], s[48:49] offset:1024 sc1
global_store_dwordx4 v2, v[88:91], s[48:49] offset:2048 sc1
global_store_dwordx4 v2, v[92:95], s[48:49] offset:3072 sc1
v_add_u32 v2, 4096, v2
global_store_dwordx4 v2, v[96:99], s[48:49] offset:0 sc1
global_store_dwordx4 v2, v[100:103], s[48:49] offset:1024 sc1
global_store_dwordx4 v2, v[104:107], s[48:49] offset:2048 sc1
global_store_dwordx4 v2, v[108:111], s[48:49] offset:3072 sc1
v_add_u32 v2, 4096, v2
global_store_dwordx4 v2, v[112:115], s[48:49] offset:0 sc1
global_store_dwordx4 v2, v[116:119], s[48:49] offset:1024 sc1
global_store_dwordx4 v2, v[120:123], s[48:49] offset:2048 sc1
global_store_dwordx4 v2, v[124:127], s[48:49] offset:3072 sc1
s_waitcnt vmcnt(0)
s_barrier
s_cmp_eq_u32 s32, 0
s_cbranch_scc0 L_kv_noln1
v_and_b32 v2, 31, v0
v_lshlrev_b32 v2, 7, v2
s_lshl_b32 s36, s34, 2
v_add_u32 v2, s36, v2
v_mov_b32 v3, 1
global_store_dword v2, v3, s[30:31] offset:0 sc1
L_kv_noln1:
v_and_b32 v20, 63, v0
v_lshrrev_b32 v21, 4, v20
v_and_b32 v22, 15, v0
s_lshr_b32 s36, s32, 1
s_lshl_b32 s36, s36, 2
v_or_b32 v23, s36, v21
v_lshlrev_b32 v23, 1, v23
v_xor_b32 v22, v22, v23
s_lshl_b32 s36, s32, 2
v_add_u32 v21, s36, v21
v_mul_u32_u24 v21, 8192, v21
v_lshl_add_u32 v17, v22, 4, v21
v_lshrrev_b32 v20, 4, v0
v_and_b32 v20, 3, v20
v_bfe_u32 v21, v0, 2, 2
v_lshl_add_u32 v22, v20, 3, v21
v_lshlrev_b32 v22, 8, v22
v_and_b32 v20, 1, v20
v_lshl_or_b32 v20, v20, 2, v21
v_and_b32 v21, 1, v0
v_lshl_add_u32 v22, v21, 3, v22
v_bfe_u32 v21, v0, 1, 1
v_lshl_add_u32 v22, v21, 4, v22
s_lshl_b32 s36, s32, 1
s_add_u32 s37, s36, 0
v_xor_b32 v21, s37, v20
v_lshl_add_u32 v18, v21, 5, v22
s_add_u32 s37, s36, 1
v_xor_b32 v21, s37, v20
v_lshl_add_u32 v19, v21, 5, v22
v_mov_b32 v16, v17
s_lshl_b32 s36, s32, 10
s_add_u32 m0, s36, 0
s_nop 0
global_load_lds_dwordx4 v16, s[44:45]
v_add_u32 v16, 131072, v16
s_add_u32 m0, s36, 4096
s_nop 0
global_load_lds_dwordx4 v16, s[44:45]
v_add_u32 v16, 131072, v16
s_add_u32 m0, s36, 8192
s_nop 0
global_load_lds_dwordx4 v16, s[44:45]
v_add_u32 v16, 131072, v16
s_add_u32 m0, s36, 12288
s_nop 0
global_load_lds_dwordx4 v16, s[44:45]
v_add_u32 v16, 131072, v16
s_add_u32 m0, s36, 16384
s_nop 0
global_load_lds_dwordx4 v16, s[44:45]
v_add_u32 v16, 131072, v16
s_add_u32 m0, s36, 20480
s_nop 0
global_load_lds_dwordx4 v16, s[44:45]
v_add_u32 v16, 131072, v16
s_add_u32 m0, s36, 24576
s_nop 0
global_load_lds_dwordx4 v16, s[44:45]
v_add_u32 v16, 131072, v16
s_add_u32 m0, s36, 28672
s_nop 0
global_load_lds_dwordx4 v16, s[44:45]
v_add_u32 v16, 131072, v16
s_add_u32 m0, s36, 32768
s_nop 0
global_load_lds_dwordx4 v16, s[44:45]
v_add_u32 v16, 131072, v16
s_add_u32 m0, s36, 36864
s_nop 0
global_load_lds_dwordx4 v16, s[44:45]
v_add_u32 v16, 131072, v16
s_add_u32 m0, s36, 40960
s_nop 0
global_load_lds_dwordx4 v16, s[44:45]
v_add_u32 v16, 131072, v16
s_add_u32 m0, s36, 45056
s_nop 0
global_load_lds_dwordx4 v16, s[44:45]
v_add_u32 v16, 131072, v16
s_add_u32 m0, s36, 49152
s_nop 0
global_load_lds_dwordx4 v16, s[44:45]
v_add_u32 v16, 131072, v16
s_add_u32 m0, s36, 53248
s_nop 0
global_load_lds_dwordx4 v16, s[44:45]
v_add_u32 v16, 131072, v16
s_add_u32 m0, s36, 57344
s_nop 0
global_load_lds_dwordx4 v16, s[44:45]
v_add_u32 v16, 131072, v16
s_add_u32 m0, s36, 61440
s_nop 0
global_load_lds_dwordx4 v16, s[44:45]
v_add_u32 v16, 131072, v16
s_lshl_b32 s36, s32, 10
s_add_u32 s36, s36, 65536
s_add_u32 m0, s36, 0
s_nop 0
global_load_lds_dwordx4 v16, s[44:45]
v_add_u32 v16, 131072, v16
s_add_u32 m0, s36, 4096
s_nop 0
global_load_lds_dwordx4 v16, s[44:45]
v_add_u32 v16, 131072, v16
s_add_u32 m0, s36, 8192
s_nop 0
global_load_lds_dwordx4 v16, s[44:45]
v_add_u32 v16, 131072, v16
s_add_u32 m0, s36, 12288
s_nop 0
global_load_lds_dwordx4 v16, s[44:45]
v_add_u32 v16, 131072, v16
s_add_u32 m0, s36, 16384
s_nop 0
global_load_lds_dwordx4 v16, s[44:45]
v_add_u32 v16, 131072, v16
s_add_u32 m0, s36, 20480
s_nop 0
global_load_lds_dwordx4 v16, s[44:45]
v_add_u32 v16, 131072, v16
s_add_u32 m0, s36, 24576
s_nop 0
global_load_lds_dwordx4 v16, s[44:45]
v_add_u32 v16, 131072, v16
s_add_u32 m0, s36, 28672
s_nop 0
global_load_lds_dwordx4 v16, s[44:45]
v_add_u32 v16, 131072, v16
s_add_u32 m0, s36, 32768
s_nop 0
global_load_lds_dwordx4 v16, s[44:45]
v_add_u32 v16, 131072, v16
s_add_u32 m0, s36, 36864
s_nop 0
global_load_lds_dwordx4 v16, s[44:45]
v_add_u32 v16, 131072, v16
s_add_u32 m0, s36, 40960
s_nop 0
global_load_lds_dwordx4 v16, s[44:45]
v_add_u32 v16, 131072, v16
s_add_u32 m0, s36, 45056
s_nop 0
global_load_lds_dwordx4 v16, s[44:45]
v_add_u32 v16, 131072, v16
s_add_u32 m0, s36, 49152
s_nop 0
global_load_lds_dwordx4 v16, s[44:45]
v_add_u32 v16, 131072, v16
s_add_u32 m0, s36, 53248
s_nop 0
global_load_lds_dwordx4 v16, s[44:45]
v_add_u32 v16, 131072, v16
s_add_u32 m0, s36, 57344
s_nop 0
global_load_lds_dwordx4 v16, s[44:45]
v_add_u32 v16, 131072, v16
s_add_u32 m0, s36, 61440
s_nop 0
global_load_lds_dwordx4 v16, s[44:45]
v_add_u32 v16, 131072, v16
s_waitcnt vmcnt(16)
s_barrier
ds_read_b64_tr_b16 a[0:1], v18 offset:0
ds_read_b64_tr_b16 a[2:3], v18 offset:1024
ds_read_b64_tr_b16 a[4:5], v18 offset:8192
ds_read_b64_tr_b16 a[6:7], v18 offset:9216
ds_read_b64_tr_b16 a[8:9], v18 offset:16384
ds_read_b64_tr_b16 a[10:11], v18 offset:17408
ds_read_b64_tr_b16 a[12:13], v18 offset:24576
ds_read_b64_tr_b16 a[14:15], v18 offset:25600
ds_read_b64_tr_b16 a[16:17], v18 offset:32768
ds_read_b64_tr_b16 a[18:19], v18 offset:33792
ds_read_b64_tr_b16 a[20:21], v18 offset:40960
ds_read_b64_tr_b16 a[22:23], v18 offset:41984
ds_read_b64_tr_b16 a[24:25], v18 offset:49152
ds_read_b64_tr_b16 a[26:27], v18 offset:50176
ds_read_b64_tr_b16 a[28:29], v18 offset:57344
ds_read_b64_tr_b16 a[30:31], v18 offset:58368
ds_read_b64_tr_b16 a[64:65], v19 offset:0
ds_read_b64_tr_b16 a[66:67], v19 offset:1024
ds_read_b64_tr_b16 a[68:69], v19 offset:8192
ds_read_b64_tr_b16 a[70:71], v19 offset:9216
ds_read_b64_tr_b16 a[72:73], v19 offset:16384
ds_read_b64_tr_b16 a[74:75], v19 offset:17408
ds_read_b64_tr_b16 a[76:77], v19 offset:24576
ds_read_b64_tr_b16 a[78:79], v19 offset:25600
ds_read_b64_tr_b16 a[80:81], v19 offset:32768
ds_read_b64_tr_b16 a[82:83], v19 offset:33792
ds_read_b64_tr_b16 a[84:85], v19 offset:40960
ds_read_b64_tr_b16 a[86:87], v19 offset:41984
ds_read_b64_tr_b16 a[88:89], v19 offset:49152
ds_read_b64_tr_b16 a[90:91], v19 offset:50176
ds_read_b64_tr_b16 a[92:93], v19 offset:57344
ds_read_b64_tr_b16 a[94:95], v19 offset:58368
s_waitcnt lgkmcnt(0)
s_barrier
v_xor_b32 v18, 0x10000, v18
v_xor_b32 v19, 0x10000, v19
v_mov_b32 v16, v17
s_lshl_b32 s36, s32, 10
s_add_u32 m0, s36, 0
s_nop 0
global_load_lds_dwordx4 v16, s[46:47]
v_add_u32 v16, 131072, v16
s_add_u32 m0, s36, 4096
s_nop 0
global_load_lds_dwordx4 v16, s[46:47]
v_add_u32 v16, 131072, v16
s_add_u32 m0, s36, 8192
s_nop 0
global_load_lds_dwordx4 v16, s[46:47]
v_add_u32 v16, 131072, v16
s_add_u32 m0, s36, 12288
s_nop 0
global_load_lds_dwordx4 v16, s[46:47]
v_add_u32 v16, 131072, v16
s_add_u32 m0, s36, 16384
s_nop 0
global_load_lds_dwordx4 v16, s[46:47]
v_add_u32 v16, 131072, v16
s_add_u32 m0, s36, 20480
s_nop 0
global_load_lds_dwordx4 v16, s[46:47]
v_add_u32 v16, 131072, v16
s_add_u32 m0, s36, 24576
s_nop 0
global_load_lds_dwordx4 v16, s[46:47]
v_add_u32 v16, 131072, v16
s_add_u32 m0, s36, 28672
s_nop 0
global_load_lds_dwordx4 v16, s[46:47]
v_add_u32 v16, 131072, v16
s_add_u32 m0, s36, 32768
s_nop 0
global_load_lds_dwordx4 v16, s[46:47]
v_add_u32 v16, 131072, v16
s_add_u32 m0, s36, 36864
s_nop 0
global_load_lds_dwordx4 v16, s[46:47]
v_add_u32 v16, 131072, v16
s_add_u32 m0, s36, 40960
s_nop 0
global_load_lds_dwordx4 v16, s[46:47]
v_add_u32 v16, 131072, v16
s_add_u32 m0, s36, 45056
s_nop 0
global_load_lds_dwordx4 v16, s[46:47]
v_add_u32 v16, 131072, v16
s_add_u32 m0, s36, 49152
s_nop 0
global_load_lds_dwordx4 v16, s[46:47]
v_add_u32 v16, 131072, v16
s_add_u32 m0, s36, 53248
s_nop 0
global_load_lds_dwordx4 v16, s[46:47]
v_add_u32 v16, 131072, v16
s_add_u32 m0, s36, 57344
s_nop 0
global_load_lds_dwordx4 v16, s[46:47]
v_add_u32 v16, 131072, v16
s_add_u32 m0, s36, 61440
s_nop 0
global_load_lds_dwordx4 v16, s[46:47]
v_add_u32 v16, 131072, v16
s_waitcnt vmcnt(16)
s_barrier
ds_read_b64_tr_b16 a[32:33], v18 offset:0
ds_read_b64_tr_b16 a[34:35], v18 offset:1024
ds_read_b64_tr_b16 a[36:37], v18 offset:8192
ds_read_b64_tr_b16 a[38:39], v18 offset:9216
ds_read_b64_tr_b16 a[40:41], v18 offset:16384
ds_read_b64_tr_b16 a[42:43], v18 offset:17408
ds_read_b64_tr_b16 a[44:45], v18 offset:24576
ds_read_b64_tr_b16 a[46:47], v18 offset:25600
ds_read_b64_tr_b16 a[48:49], v18 offset:32768
ds_read_b64_tr_b16 a[50:51], v18 offset:33792
ds_read_b64_tr_b16 a[52:53], v18 offset:40960
ds_read_b64_tr_b16 a[54:55], v18 offset:41984
ds_read_b64_tr_b16 a[56:57], v18 offset:49152
ds_read_b64_tr_b16 a[58:59], v18 offset:50176
ds_read_b64_tr_b16 a[60:61], v18 offset:57344
ds_read_b64_tr_b16 a[62:63], v18 offset:58368
ds_read_b64_tr_b16 a[96:97], v19 offset:0
ds_read_b64_tr_b16 a[98:99], v19 offset:1024
ds_read_b64_tr_b16 a[100:101], v19 offset:8192
ds_read_b64_tr_b16 a[102:103], v19 offset:9216
ds_read_b64_tr_b16 a[104:105], v19 offset:16384
ds_read_b64_tr_b16 a[106:107], v19 offset:17408
ds_read_b64_tr_b16 a[108:109], v19 offset:24576
ds_read_b64_tr_b16 a[110:111], v19 offset:25600
ds_read_b64_tr_b16 a[112:113], v19 offset:32768
ds_read_b64_tr_b16 a[114:115], v19 offset:33792
ds_read_b64_tr_b16 a[116:117], v19 offset:40960
ds_read_b64_tr_b16 a[118:119], v19 offset:41984
ds_read_b64_tr_b16 a[120:121], v19 offset:49152
ds_read_b64_tr_b16 a[122:123], v19 offset:50176
ds_read_b64_tr_b16 a[124:125], v19 offset:57344
ds_read_b64_tr_b16 a[126:127], v19 offset:58368
s_waitcnt lgkmcnt(0)
s_barrier
v_xor_b32 v18, 0x10000, v18
v_xor_b32 v19, 0x10000, v19
s_lshl_b32 s36, s32, 10
s_add_u32 s36, s36, 65536
s_add_u32 m0, s36, 0
s_nop 0
global_load_lds_dwordx4 v16, s[46:47]
v_add_u32 v16, 131072, v16
s_add_u32 m0, s36, 4096
s_nop 0
global_load_lds_dwordx4 v16, s[46:47]
v_add_u32 v16, 131072, v16
s_add_u32 m0, s36, 8192
s_nop 0
global_load_lds_dwordx4 v16, s[46:47]
v_add_u32 v16, 131072, v16
s_add_u32 m0, s36, 12288
s_nop 0
global_load_lds_dwordx4 v16, s[46:47]
v_add_u32 v16, 131072, v16
s_add_u32 m0, s36, 16384
s_nop 0
global_load_lds_dwordx4 v16, s[46:47]
v_add_u32 v16, 131072, v16
s_add_u32 m0, s36, 20480
s_nop 0
global_load_lds_dwordx4 v16, s[46:47]
v_add_u32 v16, 131072, v16
s_add_u32 m0, s36, 24576
s_nop 0
global_load_lds_dwordx4 v16, s[46:47]
v_add_u32 v16, 131072, v16
s_add_u32 m0, s36, 28672
s_nop 0
global_load_lds_dwordx4 v16, s[46:47]
v_add_u32 v16, 131072, v16
s_add_u32 m0, s36, 32768
s_nop 0
global_load_lds_dwordx4 v16, s[46:47]
v_add_u32 v16, 131072, v16
s_add_u32 m0, s36, 36864
s_nop 0
global_load_lds_dwordx4 v16, s[46:47]
v_add_u32 v16, 131072, v16
s_add_u32 m0, s36, 40960
s_nop 0
global_load_lds_dwordx4 v16, s[46:47]
v_add_u32 v16, 131072, v16
s_add_u32 m0, s36, 45056
s_nop 0
global_load_lds_dwordx4 v16, s[46:47]
v_add_u32 v16, 131072, v16
s_add_u32 m0, s36, 49152
s_nop 0
global_load_lds_dwordx4 v16, s[46:47]
v_add_u32 v16, 131072, v16
s_add_u32 m0, s36, 53248
s_nop 0
global_load_lds_dwordx4 v16, s[46:47]
v_add_u32 v16, 131072, v16
s_add_u32 m0, s36, 57344
s_nop 0
global_load_lds_dwordx4 v16, s[46:47]
v_add_u32 v16, 131072, v16
s_add_u32 m0, s36, 61440
s_nop 0
global_load_lds_dwordx4 v16, s[46:47]
v_add_u32 v16, 131072, v16
s_waitcnt vmcnt(16)
s_barrier
ds_read_b64_tr_b16 a[128:129], v18 offset:0
ds_read_b64_tr_b16 a[130:131], v18 offset:1024
ds_read_b64_tr_b16 a[132:133], v18 offset:8192
ds_read_b64_tr_b16 a[134:135], v18 offset:9216
ds_read_b64_tr_b16 a[136:137], v18 offset:16384
ds_read_b64_tr_b16 a[138:139], v18 offset:17408
ds_read_b64_tr_b16 a[140:141], v18 offset:24576
ds_read_b64_tr_b16 a[142:143], v18 offset:25600
ds_read_b64_tr_b16 a[144:145], v18 offset:32768
ds_read_b64_tr_b16 a[146:147], v18 offset:33792
ds_read_b64_tr_b16 a[148:149], v18 offset:40960
ds_read_b64_tr_b16 a[150:151], v18 offset:41984
ds_read_b64_tr_b16 a[152:153], v18 offset:49152
ds_read_b64_tr_b16 a[154:155], v18 offset:50176
ds_read_b64_tr_b16 a[156:157], v18 offset:57344
ds_read_b64_tr_b16 a[158:159], v18 offset:58368
ds_read_b64_tr_b16 a[192:193], v19 offset:0
ds_read_b64_tr_b16 a[194:195], v19 offset:1024
ds_read_b64_tr_b16 a[196:197], v19 offset:8192
ds_read_b64_tr_b16 a[198:199], v19 offset:9216
ds_read_b64_tr_b16 a[200:201], v19 offset:16384
ds_read_b64_tr_b16 a[202:203], v19 offset:17408
ds_read_b64_tr_b16 a[204:205], v19 offset:24576
ds_read_b64_tr_b16 a[206:207], v19 offset:25600
ds_read_b64_tr_b16 a[208:209], v19 offset:32768
ds_read_b64_tr_b16 a[210:211], v19 offset:33792
ds_read_b64_tr_b16 a[212:213], v19 offset:40960
ds_read_b64_tr_b16 a[214:215], v19 offset:41984
ds_read_b64_tr_b16 a[216:217], v19 offset:49152
ds_read_b64_tr_b16 a[218:219], v19 offset:50176
ds_read_b64_tr_b16 a[220:221], v19 offset:57344
ds_read_b64_tr_b16 a[222:223], v19 offset:58368
s_waitcnt lgkmcnt(0)
s_barrier
v_xor_b32 v18, 0x10000, v18
v_xor_b32 v19, 0x10000, v19
s_waitcnt vmcnt(0)
s_barrier
ds_read_b64_tr_b16 a[160:161], v18 offset:0
ds_read_b64_tr_b16 a[162:163], v18 offset:1024
ds_read_b64_tr_b16 a[164:165], v18 offset:8192
ds_read_b64_tr_b16 a[166:167], v18 offset:9216
ds_read_b64_tr_b16 a[168:169], v18 offset:16384
ds_read_b64_tr_b16 a[170:171], v18 offset:17408
ds_read_b64_tr_b16 a[172:173], v18 offset:24576
ds_read_b64_tr_b16 a[174:175], v18 offset:25600
ds_read_b64_tr_b16 a[176:177], v18 offset:32768
ds_read_b64_tr_b16 a[178:179], v18 offset:33792
ds_read_b64_tr_b16 a[180:181], v18 offset:40960
ds_read_b64_tr_b16 a[182:183], v18 offset:41984
ds_read_b64_tr_b16 a[184:185], v18 offset:49152
ds_read_b64_tr_b16 a[186:187], v18 offset:50176
ds_read_b64_tr_b16 a[188:189], v18 offset:57344
ds_read_b64_tr_b16 a[190:191], v18 offset:58368
ds_read_b64_tr_b16 a[224:225], v19 offset:0
ds_read_b64_tr_b16 a[226:227], v19 offset:1024
ds_read_b64_tr_b16 a[228:229], v19 offset:8192
ds_read_b64_tr_b16 a[230:231], v19 offset:9216
ds_read_b64_tr_b16 a[232:233], v19 offset:16384
ds_read_b64_tr_b16 a[234:235], v19 offset:17408
ds_read_b64_tr_b16 a[236:237], v19 offset:24576
ds_read_b64_tr_b16 a[238:239], v19 offset:25600
ds_read_b64_tr_b16 a[240:241], v19 offset:32768
ds_read_b64_tr_b16 a[242:243], v19 offset:33792
ds_read_b64_tr_b16 a[244:245], v19 offset:40960
ds_read_b64_tr_b16 a[246:247], v19 offset:41984
ds_read_b64_tr_b16 a[248:249], v19 offset:49152
ds_read_b64_tr_b16 a[250:251], v19 offset:50176
ds_read_b64_tr_b16 a[252:253], v19 offset:57344
ds_read_b64_tr_b16 a[254:255], v19 offset:58368
s_waitcnt lgkmcnt(0)
s_barrier
v_xor_b32 v18, 0x10000, v18
v_xor_b32 v19, 0x10000, v19
s_cmp_eq_u32 s32, 0
s_cbranch_scc0 L_wgw_1
s_and_b32 s36, s34, 31
s_lshl_b32 s36, s36, 7
v_and_b32 v3, 31, v0
v_lshlrev_b32 v3, 2, v3
v_add_u32 v3, s36, v3
s_mov_b32 s98, 0
L_poll_2:
global_load_dword v4, v3, s[30:31] offset:0 sc1
s_waitcnt vmcnt(0)
v_cmp_gt_u32 vcc, 1, v4
s_cbranch_vccz L_polld_3
s_add_u32 s98, s98, 1
s_cmp_lt_u32 s98, 200000
s_cbranch_scc1 L_poll_2
s_mov_b32 s99, 10
s_branch L_fail
L_polld_3:
L_wgw_1:
s_barrier
v_and_b32 v2, 63, v0
v_lshlrev_b32 v2, 4, v2
s_lshl_b32 s36, s32, 13
v_add_u32 v3, s36, v2
v_add_u32 v4, 4096, v3
v_mov_b32 v5, v2
s_mov_b32 s50, s36
s_lshl_b32 s36, s42, 15
s_add_u32 s36, s36, 65536
s_add_u32 s52, s30, s36
s_addc_u32 s53, s31, 0
s_lshl_b32 s36, s42, 5
s_add_u32 s36, s36, s41
s_lshl_b32 s37, s36, 7
s_lshl_b32 s38, s32, 2
s_add_u32 s37, s37, s38
s_add_u32 s37, s37, 8192
s_lshl_b32 s36, s36, 2
s_add_u32 s36, s36, s32
s_lshl_b32 s36, s36, 12
s_add_u32 s36, s36, 4194304
s_add_u32 s54, s30, s36
s_addc_u32 s55, s31, 0
v_mov_b32 v6, s37
s_mov_b32 s56, 0
s_mov_b32 m0, s50
s_nop 0
global_load_lds_dwordx4 v3, s[52:53] offset:0 sc1
global_load_lds_dwordx4 v3, s[52:53] offset:1024 sc1
global_load_lds_dwordx4 v3, s[52:53] offset:2048 sc1
global_load_lds_dwordx4 v3, s[52:53] offset:3072 sc1
s_add_u32 m0, s50, 4096
s_nop 0
global_load_lds_dwordx4 v4, s[52:53] offset:0 sc1
global_load_lds_dwordx4 v4, s[52:53] offset:1024 sc1
global_load_lds_dwordx4 v4, s[52:53] offset:2048 sc1
global_load_lds_dwordx4 v4, s[52:53] offset:3072 sc1
s_waitcnt vmcnt(0)
L_seg_4:
s_waitcnt vmcnt(5)
s_barrier
s_xor_b32 s50, s50, 0x8000
s_add_u32 s52, s52, 65536
s_addc_u32 s53, s53, 0
s_cmp_lt_u32 s56, 31
s_cbranch_scc0 L_np_5_skip
s_mov_b32 m0, s50
s_nop 0
global_load_lds_dwordx4 v3, s[52:53] offset:0 sc1
global_load_lds_dwordx4 v3, s[52:53] offset:1024 sc1
global_load_lds_dwordx4 v3, s[52:53] offset:2048 sc1
global_load_lds_dwordx4 v3, s[52:53] offset:3072 sc1
s_add_u32 m0, s50, 4096
s_nop 0
global_load_lds_dwordx4 v4, s[52:53] offset:0 sc1
global_load_lds_dwordx4 v4, s[52:53] offset:1024 sc1
global_load_lds_dwordx4 v4, s[52:53] offset:2048 sc1
global_load_lds_dwordx4 v4, s[52:53] offset:3072 sc1
s_branch L_np_5
L_np_5_skip:
s_waitcnt vmcnt(0)
L_np_5:
ds_read_b128 v[64:67], v5 offset:0
ds_read_b128 v[68:71], v5 offset:1024
ds_read_b128 v[72:75], v5 offset:2048
ds_read_b128 v[76:79], v5 offset:3072
s_waitcnt lgkmcnt(3)
v_mfma_f32_16x16x32_bf16 v[32:35], a[0:3], v[64:67], 0
v_mfma_f32_16x16x32_bf16 v[48:51], v[64:67], a[128:131], 0
v_mfma_f32_16x16x32_bf16 v[36:39], a[64:67], v[64:67], 0
v_mfma_f32_16x16x32_bf16 v[52:55], v[64:67], a[192:195], 0
ds_read_b128 v[64:67], v5 offset:4096
s_waitcnt lgkmcnt(3)
v_mfma_f32_16x16x32_bf16 v[32:35], a[4:7], v[68:71], v[32:35]
v_mfma_f32_16x16x32_bf16 v[48:51], v[68:71], a[132:135], v[48:51]
v_mfma_f32_16x16x32_bf16 v[36:39], a[68:71], v[68:71], v[36:39]
v_mfma_f32_16x16x32_bf16 v[52:55], v[68:71], a[196:199], v[52:55]
ds_read_b128 v[68:71], v5 offset:5120
s_waitcnt lgkmcnt(3)
v_mfma_f32_16x16x32_bf16 v[32:35], a[8:11], v[72:75], v[32:35]
v_mfma_f32_16x16x32_bf16 v[48:51], v[72:75], a[136:139], v[48:51]
v_mfma_f32_16x16x32_bf16 v[36:39], a[72:75], v[72:75], v[36:39]
v_mfma_f32_16x16x32_bf16 v[52:55], v[72:75], a[200:203], v[52:55]
ds_read_b128 v[72:75], v5 offset:6144
s_waitcnt lgkmcnt(3)
v_mfma_f32_16x16x32_bf16 v[32:35], a[12:15], v[76:79], v[32:35]
v_mfma_f32_16x16x32_bf16 v[48:51], v[76:79], a[140:143], v[48:51]
v_mfma_f32_16x16x32_bf16 v[36:39], a[76:79], v[76:79], v[36:39]
v_mfma_f32_16x16x32_bf16 v[52:55], v[76:79], a[204:207], v[52:55]
ds_read_b128 v[76:79], v5 offset:7168
s_waitcnt lgkmcnt(3)
v_mfma_f32_16x16x32_bf16 v[32:35], a[16:19], v[64:67], v[32:35]
v_mfma_f32_16x16x32_bf16 v[48:51], v[64:67], a[144:147], v[48:51]
v_mfma_f32_16x16x32_bf16 v[36:39], a[80:83], v[64:67], v[36:39]
v_mfma_f32_16x16x32_bf16 v[52:55], v[64:67], a[208:211], v[52:55]
ds_read_b128 v[64:67], v5 offset:8192
s_waitcnt lgkmcnt(3)
v_mfma_f32_16x16x32_bf16 v[32:35], a[20:23], v[68:71], v[32:35]
v_mfma_f32_16x16x32_bf16 v[48:51], v[68:71], a[148:151], v[48:51]
v_mfma_f32_16x16x32_bf16 v[36:39], a[84:87], v[68:71], v[36:39]
v_mfma_f32_16x16x32_bf16 v[52:55], v[68:71], a[212:215], v[52:55]
ds_read_b128 v[68:71], v5 offset:9216
s_waitcnt lgkmcnt(3)
v_mfma_f32_16x16x32_bf16 v[32:35], a[24:27], v[72:75], v[32:35]
v_mfma_f32_16x16x32_bf16 v[48:51], v[72:75], a[152:155], v[48:51]
v_mfma_f32_16x16x32_bf16 v[36:39], a[88:91], v[72:75], v[36:39]
v_mfma_f32_16x16x32_bf16 v[52:55], v[72:75], a[216:219], v[52:55]
ds_read_b128 v[72:75], v5 offset:10240
s_waitcnt lgkmcnt(3)
v_mfma_f32_16x16x32_bf16 v[32:35], a[28:31], v[76:79], v[32:35]
v_mfma_f32_16x16x32_bf16 v[48:51], v[76:79], a[156:159], v[48:51]
v_mfma_f32_16x16x32_bf16 v[36:39], a[92:95], v[76:79], v[36:39]
v_mfma_f32_16x16x32_bf16 v[52:55], v[76:79], a[220:223], v[52:55]
ds_read_b128 v[76:79], v5 offset:11264
s_waitcnt lgkmcnt(3)
v_mfma_f32_16x16x32_bf16 v[32:35], a[32:35], v[64:67], v[32:35]
v_mfma_f32_16x16x32_bf16 v[48:51], v[64:67], a[160:163], v[48:51]
v_mfma_f32_16x16x32_bf16 v[36:39], a[96:99], v[64:67], v[36:39]
v_mfma_f32_16x16x32_bf16 v[52:55], v[64:67], a[224:227], v[52:55]
ds_read_b128 v[64:67], v5 offset:12288
s_waitcnt lgkmcnt(3)
v_mfma_f32_16x16x32_bf16 v[32:35], a[36:39], v[68:71], v[32:35]
v_mfma_f32_16x16x32_bf16 v[48:51], v[68:71], a[164:167], v[48:51]
v_mfma_f32_16x16x32_bf16 v[36:39], a[100:103], v[68:71], v[36:39]
v_mfma_f32_16x16x32_bf16 v[52:55], v[68:71], a[228:231], v[52:55]
ds_read_b128 v[68:71], v5 offset:13312
s_waitcnt lgkmcnt(3)
v_mfma_f32_16x16x32_bf16 v[32:35], a[40:43], v[72:75], v[32:35]
v_mfma_f32_16x16x32_bf16 v[48:51], v[72:75], a[168:171], v[48:51]
v_mfma_f32_16x16x32_bf16 v[36:39], a[104:107], v[72:75], v[36:39]
v_mfma_f32_16x16x32_bf16 v[52:55], v[72:75], a[232:235], v[52:55]
ds_read_b128 v[72:75], v5 offset:14336
s_waitcnt lgkmcnt(3)
v_mfma_f32_16x16x32_bf16 v[32:35], a[44:47], v[76:79], v[32:35]
v_mfma_f32_16x16x32_bf16 v[48:51], v[76:79], a[172:175], v[48:51]
v_mfma_f32_16x16x32_bf16 v[36:39], a[108:111], v[76:79], v[36:39]
v_mfma_f32_16x16x32_bf16 v[52:55], v[76:79], a[236:239], v[52:55]
ds_read_b128 v[76:79], v5 offset:15360
s_waitcnt lgkmcnt(3)
v_mfma_f32_16x16x32_bf16 v[32:35], a[48:51], v[64:67], v[32:35]
v_mfma_f32_16x16x32_bf16 v[48:51], v[64:67], a[176:179], v[48:51]
v_mfma_f32_16x16x32_bf16 v[36:39], a[112:115], v[64:67], v[36:39]
v_mfma_f32_16x16x32_bf16 v[52:55], v[64:67], a[240:243], v[52:55]
ds_read_b128 v[64:67], v5 offset:16384
s_waitcnt lgkmcnt(3)
v_mfma_f32_16x16x32_bf16 v[32:35], a[52:55], v[68:71], v[32:35]
v_mfma_f32_16x16x32_bf16 v[48:51], v[68:71], a[180:183], v[48:51]
v_mfma_f32_16x16x32_bf16 v[36:39], a[116:119], v[68:71], v[36:39]
v_mfma_f32_16x16x32_bf16 v[52:55], v[68:71], a[244:247], v[52:55]
ds_read_b128 v[68:71], v5 offset:17408
s_waitcnt lgkmcnt(3)
v_mfma_f32_16x16x32_bf16 v[32:35], a[56:59], v[72:75], v[32:35]
v_mfma_f32_16x16x32_bf16 v[48:51], v[72:75], a[184:187], v[48:51]
v_mfma_f32_16x16x32_bf16 v[36:39], a[120:123], v[72:75], v[36:39]
v_mfma_f32_16x16x32_bf16 v[52:55], v[72:75], a[248:251], v[52:55]
ds_read_b128 v[72:75], v5 offset:18432
s_waitcnt lgkmcnt(3)
v_mfma_f32_16x16x32_bf16 v[32:35], a[60:63], v[76:79], v[32:35]
v_mfma_f32_16x16x32_bf16 v[48:51], v[76:79], a[188:191], v[48:51]
v_mfma_f32_16x16x32_bf16 v[36:39], a[124:127], v[76:79], v[36:39]
v_mfma_f32_16x16x32_bf16 v[52:55], v[76:79], a[252:255], v[52:55]
s_waitcnt vmcnt(8)
v_mov_b32 v7, s56
s_mov_b64 exec, 1
global_store_dword v6, v7, s[30:31] sc1
s_mov_b64 exec, -1
ds_read_b128 v[76:79], v5 offset:19456
s_waitcnt lgkmcnt(3)
v_mfma_f32_16x16x32_bf16 v[40:43], a[0:3], v[64:67], 0
v_mfma_f32_16x16x32_bf16 v[56:59], v[64:67], a[128:131], 0
v_mfma_f32_16x16x32_bf16 v[44:47], a[64:67], v[64:67], 0
v_mfma_f32_16x16x32_bf16 v[60:63], v[64:67], a[192:195], 0
ds_read_b128 v[64:67], v5 offset:20480
s_waitcnt lgkmcnt(3)
v_mfma_f32_16x16x32_bf16 v[40:43], a[4:7], v[68:71], v[40:43]
v_mfma_f32_16x16x32_bf16 v[56:59], v[68:71], a[132:135], v[56:59]
v_mfma_f32_16x16x32_bf16 v[44:47], a[68:71], v[68:71], v[44:47]
v_mfma_f32_16x16x32_bf16 v[60:63], v[68:71], a[196:199], v[60:63]
ds_read_b128 v[68:71], v5 offset:21504
s_waitcnt lgkmcnt(3)
v_mfma_f32_16x16x32_bf16 v[40:43], a[8:11], v[72:75], v[40:43]
v_mfma_f32_16x16x32_bf16 v[56:59], v[72:75], a[136:139], v[56:59]
v_mfma_f32_16x16x32_bf16 v[44:47], a[72:75], v[72:75], v[44:47]
v_mfma_f32_16x16x32_bf16 v[60:63], v[72:75], a[200:203], v[60:63]
ds_read_b128 v[72:75], v5 offset:22528
s_waitcnt lgkmcnt(3)
v_mfma_f32_16x16x32_bf16 v[40:43], a[12:15], v[76:79], v[40:43]
v_mfma_f32_16x16x32_bf16 v[56:59], v[76:79], a[140:143], v[56:59]
v_mfma_f32_16x16x32_bf16 v[44:47], a[76:79], v[76:79], v[44:47]
v_mfma_f32_16x16x32_bf16 v[60:63], v[76:79], a[204:207], v[60:63]
ds_read_b128 v[76:79], v5 offset:23552
s_waitcnt lgkmcnt(3)
v_mfma_f32_16x16x32_bf16 v[40:43], a[16:19], v[64:67], v[40:43]
v_mfma_f32_16x16x32_bf16 v[56:59], v[64:67], a[144:147], v[56:59]
v_mfma_f32_16x16x32_bf16 v[44:47], a[80:83], v[64:67], v[44:47]
v_mfma_f32_16x16x32_bf16 v[60:63], v[64:67], a[208:211], v[60:63]
ds_read_b128 v[64:67], v5 offset:24576
s_waitcnt lgkmcnt(3)
v_mfma_f32_16x16x32_bf16 v[40:43], a[20:23], v[68:71], v[40:43]
v_mfma_f32_16x16x32_bf16 v[56:59], v[68:71], a[148:151], v[56:59]
v_mfma_f32_16x16x32_bf16 v[44:47], a[84:87], v[68:71], v[44:47]
v_mfma_f32_16x16x32_bf16 v[60:63], v[68:71], a[212:215], v[60:63]
ds_read_b128 v[68:71], v5 offset:25600
s_waitcnt lgkmcnt(3)
v_mfma_f32_16x16x32_bf16 v[40:43], a[24:27], v[72:75], v[40:43]
v_mfma_f32_16x16x32_bf16 v[56:59], v[72:75], a[152:155], v[56:59]
v_mfma_f32_16x16x32_bf16 v[44:47], a[88:91], v[72:75], v[44:47]
v_mfma_f32_16x16x32_bf16 v[60:63], v[72:75], a[216:219], v[60:63]
ds_read_b128 v[72:75], v5 offset:26624
s_waitcnt lgkmcnt(3)
v_mfma_f32_16x16x32_bf16 v[40:43], a[28:31], v[76:79], v[40:43]
v_mfma_f32_16x16x32_bf16 v[56:59], v[76:79], a[156:159], v[56:59]
v_mfma_f32_16x16x32_bf16 v[44:47], a[92:95], v[76:79], v[44:47]
v_mfma_f32_16x16x32_bf16 v[60:63], v[76:79], a[220:223], v[60:63]
ds_read_b128 v[76:79], v5 offset:27648
s_waitcnt lgkmcnt(3)
v_mfma_f32_16x16x32_bf16 v[40:43], a[32:35], v[64:67], v[40:43]
v_mfma_f32_16x16x32_bf16 v[56:59], v[64:67], a[160:163], v[56:59]
v_mfma_f32_16x16x32_bf16 v[44:47], a[96:99], v[64:67], v[44:47]
v_mfma_f32_16x16x32_bf16 v[60:63], v[64:67], a[224:227], v[60:63]
ds_read_b128 v[64:67], v5 offset:28672
s_waitcnt lgkmcnt(3)
v_mfma_f32_16x16x32_bf16 v[40:43], a[36:39], v[68:71], v[40:43]
v_mfma_f32_16x16x32_bf16 v[56:59], v[68:71], a[164:167], v[56:59]
v_mfma_f32_16x16x32_bf16 v[44:47], a[100:103], v[68:71], v[44:47]
v_mfma_f32_16x16x32_bf16 v[60:63], v[68:71], a[228:231], v[60:63]
ds_read_b128 v[68:71], v5 offset:29696
s_waitcnt lgkmcnt(3)
v_mfma_f32_16x16x32_bf16 v[40:43], a[40:43], v[72:75], v[40:43]
v_mfma_f32_16x16x32_bf16 v[56:59], v[72:75], a[168:171], v[56:59]
v_mfma_f32_16x16x32_bf16 v[44:47], a[104:107], v[72:75], v[44:47]
v_mfma_f32_16x16x32_bf16 v[60:63], v[72:75], a[232:235], v[60:63]
ds_read_b128 v[72:75], v5 offset:30720
s_waitcnt lgkmcnt(3)
v_mfma_f32_16x16x32_bf16 v[40:43], a[44:47], v[76:79], v[40:43]
v_mfma_f32_16x16x32_bf16 v[56:59], v[76:79], a[172:175], v[56:59]
v_mfma_f32_16x16x32_bf16 v[44:47], a[108:111], v[76:79], v[44:47]
v_mfma_f32_16x16x32_bf16 v[60:63], v[76:79], a[236:239], v[60:63]
ds_read_b128 v[76:79], v5 offset:31744
s_waitcnt lgkmcnt(3)
v_mfma_f32_16x16x32_bf16 v[40:43], a[48:51], v[64:67], v[40:43]
v_mfma_f32_16x16x32_bf16 v[56:59], v[64:67], a[176:179], v[56:59]
v_mfma_f32_16x16x32_bf16 v[44:47], a[112:115], v[64:67], v[44:47]
v_mfma_f32_16x16x32_bf16 v[60:63], v[64:67], a[240:243], v[60:63]
s_waitcnt lgkmcnt(2)
v_mfma_f32_16x16x32_bf16 v[40:43], a[52:55], v[68:71], v[40:43]
v_mfma_f32_16x16x32_bf16 v[56:59], v[68:71], a[180:183], v[56:59]
v_mfma_f32_16x16x32_bf16 v[44:47], a[116:119], v[68:71], v[44:47]
v_mfma_f32_16x16x32_bf16 v[60:63], v[68:71], a[244:247], v[60:63]
s_waitcnt lgkmcnt(1)
v_mfma_f32_16x16x32_bf16 v[40:43], a[56:59], v[72:75], v[40:43]
v_mfma_f32_16x16x32_bf16 v[56:59], v[72:75], a[184:187], v[56:59]
v_mfma_f32_16x16x32_bf16 v[44:47], a[120:123], v[72:75], v[44:47]
v_mfma_f32_16x16x32_bf16 v[60:63], v[72:75], a[248:251], v[60:63]
s_waitcnt lgkmcnt(0)
v_mfma_f32_16x16x32_bf16 v[40:43], a[60:63], v[76:79], v[40:43]
v_mfma_f32_16x16x32_bf16 v[56:59], v[76:79], a[188:191], v[56:59]
v_mfma_f32_16x16x32_bf16 v[44:47], a[124:127], v[76:79], v[44:47]
v_mfma_f32_16x16x32_bf16 v[60:63], v[76:79], a[252:255], v[60:63]
v_xor_b32 v5, 0x8000, v5
v_cvt_pk_bf16_f32 v96, v32, v33
v_cvt_pk_bf16_f32 v97, v34, v35
v_cvt_pk_bf16_f32 v98, v36, v37
v_cvt_pk_bf16_f32 v99, v38, v39
v_cvt_pk_bf16_f32 v100, v40, v41
v_cvt_pk_bf16_f32 v101, v42, v43
v_cvt_pk_bf16_f32 v102, v44, v45
v_cvt_pk_bf16_f32 v103, v46, v47
v_cvt_pk_bf16_f32 v104, v48, v49
v_cvt_pk_bf16_f32 v105, v50, v51
v_cvt_pk_bf16_f32 v106, v56, v57
v_cvt_pk_bf16_f32 v107, v58, v59
v_cvt_pk_bf16_f32 v108, v52, v53
v_cvt_pk_bf16_f32 v109, v54, v55
v_cvt_pk_bf16_f32 v110, v60, v61
v_cvt_pk_bf16_f32 v111, v62, v63
global_store_dwordx4 v2, v[96:99], s[54:55] offset:0 sc1
global_store_dwordx4 v2, v[100:103], s[54:55] offset:1024 sc1
global_store_dwordx4 v2, v[104:107], s[54:55] offset:2048 sc1
global_store_dwordx4 v2, v[108:111], s[54:55] offset:3072 sc1
s_add_u32 s54, s54, 1048576
s_addc_u32 s55, s55, 0
s_add_u32 s56, s56, 1
s_cmp_lt_u32 s56, 32
s_cbranch_scc1 L_seg_4
s_waitcnt vmcnt(0)
v_mov_b32 v7, 32
s_mov_b64 exec, 1
global_store_dword v6, v7, s[30:31] sc1
s_endpgm
L_ffn:
s_lshr_b32 s41, s34, 1
s_and_b32 s42, s34, 1
s_lshl_b32 s36, s41, 8
s_add_u32 s44, s20, s36
s_addc_u32 s45, s21, 0
s_add_u32 s46, s22, s36
s_addc_u32 s47, s23, 0
s_cmp_eq_u32 s32, 0
s_cbranch_scc0 L_wgw_6
s_and_b32 s36, s34, 31
s_lshl_b32 s36, s36, 7
v_and_b32 v3, 31, v0
v_lshlrev_b32 v3, 2, v3
v_add_u32 v3, s36, v3
s_mov_b32 s98, 0
L_poll_7:
global_load_dword v4, v3, s[30:31] offset:0 sc1
s_waitcnt vmcnt(0)
v_cmp_gt_u32 vcc, 1, v4
s_cbranch_vccz L_polld_8
s_add_u32 s98, s98, 1
s_cmp_lt_u32 s98, 200000
s_cbranch_scc1 L_poll_7
s_mov_b32 s99, 12
s_branch L_fail
L_polld_8:
L_wgw_6:
s_barrier
s_cmp_eq_u32 s41, 10
s_cselect_b32 s43, 11, 15
v_and_b32 v20, 63, v0
v_lshrrev_b32 v21, 4, v20
v_and_b32 v22, 15, v0
s_lshr_b32 s36, s32, 1
s_lshl_b32 s36, s36, 2
v_or_b32 v23, s36, v21
v_lshlrev_b32 v23, 1, v23
v_xor_b32 v22, v22, v23
v_min_u32 v22, s43, v22
s_lshl_b32 s36, s32, 2
v_add_u32 v21, s36, v21
v_mul_u32_u24 v21, 2752, v21
v_lshl_add_u32 v17, v22, 4, v21
v_lshrrev_b32 v20, 4, v0
v_and_b32 v20, 3, v20
v_bfe_u32 v21, v0, 2, 2
v_lshl_add_u32 v22, v20, 3, v21
v_lshlrev_b32 v22, 8, v22
v_and_b32 v20, 1, v20
v_lshl_or_b32 v20, v20, 2, v21
v_and_b32 v21, 1, v0
v_lshl_add_u32 v22, v21, 3, v22
v_bfe_u32 v21, v0, 1, 1
v_lshl_add_u32 v22, v21, 4, v22
s_lshl_b32 s36, s32, 1
s_add_u32 s37, s36, 0
v_xor_b32 v21, s37, v20
v_lshl_add_u32 v18, v21, 5, v22
s_add_u32 s37, s36, 1
v_xor_b32 v21, s37, v20
v_lshl_add_u32 v19, v21, 5, v22
v_mov_b32 v16, v17
s_lshl_b32 s36, s32, 10
s_add_u32 m0, s36, 0
s_nop 0
global_load_lds_dwordx4 v16, s[44:45]
v_add_u32 v16, 44032, v16
s_add_u32 m0, s36, 4096
s_nop 0
global_load_lds_dwordx4 v16, s[44:45]
v_add_u32 v16, 44032, v16
s_add_u32 m0, s36, 8192
s_nop 0
global_load_lds_dwordx4 v16, s[44:45]
v_add_u32 v16, 44032, v16
s_add_u32 m0, s36, 12288
s_nop 0
global_load_lds_dwordx4 v16, s[44:45]
v_add_u32 v16, 44032, v16
s_add_u32 m0, s36, 16384
s_nop 0
global_load_lds_dwordx4 v16, s[44:45]
v_add_u32 v16, 44032, v16
s_add_u32 m0, s36, 20480
s_nop 0
global_load_lds_dwordx4 v16, s[44:45]
v_add_u32 v16, 44032, v16
s_add_u32 m0, s36, 24576
s_nop 0
global_load_lds_dwordx4 v16, s[44:45]
v_add_u32 v16, 44032, v16
s_add_u32 m0, s36, 28672
s_nop 0
global_load_lds_dwordx4 v16, s[44:45]
v_add_u32 v16, 44032, v16
s_add_u32 m0, s36, 32768
s_nop 0
global_load_lds_dwordx4 v16, s[44:45]
v_add_u32 v16, 44032, v16
s_add_u32 m0, s36, 36864
s_nop 0
global_load_lds_dwordx4 v16, s[44:45]
v_add_u32 v16, 44032, v16
s_add_u32 m0, s36, 40960
s_nop 0
global_load_lds_dwordx4 v16, s[44:45]
v_add_u32 v16, 44032, v16
s_add_u32 m0, s36, 45056
s_nop 0
global_load_lds_dwordx4 v16, s[44:45]
v_add_u32 v16, 44032, v16
s_add_u32 m0, s36, 49152
s_nop 0
global_load_lds_dwordx4 v16, s[44:45]
v_add_u32 v16, 44032, v16
s_add_u32 m0, s36, 53248
s_nop 0
global_load_lds_dwordx4 v16, s[44:45]
v_add_u32 v16, 44032, v16
s_add_u32 m0, s36, 57344
s_nop 0
global_load_lds_dwordx4 v16, s[44:45]
v_add_u32 v16, 44032, v16
s_add_u32 m0, s36, 61440
s_nop 0
global_load_lds_dwordx4 v16, s[44:45]
v_add_u32 v16, 44032, v16
s_lshl_b32 s36, s32, 10
s_add_u32 s36, s36, 65536
s_add_u32 m0, s36, 0
s_nop 0
global_load_lds_dwordx4 v16, s[44:45]
v_add_u32 v16, 44032, v16
s_add_u32 m0, s36, 4096
s_nop 0
global_load_lds_dwordx4 v16, s[44:45]
v_add_u32 v16, 44032, v16
s_add_u32 m0, s36, 8192
s_nop 0
global_load_lds_dwordx4 v16, s[44:45]
v_add_u32 v16, 44032, v16
s_add_u32 m0, s36, 12288
s_nop 0
global_load_lds_dwordx4 v16, s[44:45]
v_add_u32 v16, 44032, v16
s_add_u32 m0, s36, 16384
s_nop 0
global_load_lds_dwordx4 v16, s[44:45]
v_add_u32 v16, 44032, v16
s_add_u32 m0, s36, 20480
s_nop 0
global_load_lds_dwordx4 v16, s[44:45]
v_add_u32 v16, 44032, v16
s_add_u32 m0, s36, 24576
s_nop 0
global_load_lds_dwordx4 v16, s[44:45]
v_add_u32 v16, 44032, v16
s_add_u32 m0, s36, 28672
s_nop 0
global_load_lds_dwordx4 v16, s[44:45]
v_add_u32 v16, 44032, v16
s_add_u32 m0, s36, 32768
s_nop 0
global_load_lds_dwordx4 v16, s[44:45]
v_add_u32 v16, 44032, v16
s_add_u32 m0, s36, 36864
s_nop 0
global_load_lds_dwordx4 v16, s[44:45]
v_add_u32 v16, 44032, v16
s_add_u32 m0, s36, 40960
s_nop 0
global_load_lds_dwordx4 v16, s[44:45]
v_add_u32 v16, 44032, v16
s_add_u32 m0, s36, 45056
s_nop 0
global_load_lds_dwordx4 v16, s[44:45]
v_add_u32 v16, 44032, v16
s_add_u32 m0, s36, 49152
s_nop 0
global_load_lds_dwordx4 v16, s[44:45]
v_add_u32 v16, 44032, v16
s_add_u32 m0, s36, 53248
s_nop 0
global_load_lds_dwordx4 v16, s[44:45]
v_add_u32 v16, 44032, v16
s_add_u32 m0, s36, 57344
s_nop 0
global_load_lds_dwordx4 v16, s[44:45]
v_add_u32 v16, 44032, v16
s_add_u32 m0, s36, 61440
s_nop 0
global_load_lds_dwordx4 v16, s[44:45]
v_add_u32 v16, 44032, v16
s_waitcnt vmcnt(16)
s_barrier
ds_read_b64_tr_b16 a[0:1], v18 offset:0
ds_read_b64_tr_b16 a[2:3], v18 offset:1024
ds_read_b64_tr_b16 a[4:5], v18 offset:8192
ds_read_b64_tr_b16 a[6:7], v18 offset:9216
ds_read_b64_tr_b16 a[8:9], v18 offset:16384
ds_read_b64_tr_b16 a[10:11], v18 offset:17408
ds_read_b64_tr_b16 a[12:13], v18 offset:24576
ds_read_b64_tr_b16 a[14:15], v18 offset:25600
ds_read_b64_tr_b16 a[16:17], v18 offset:32768
ds_read_b64_tr_b16 a[18:19], v18 offset:33792
ds_read_b64_tr_b16 a[20:21], v18 offset:40960
ds_read_b64_tr_b16 a[22:23], v18 offset:41984
ds_read_b64_tr_b16 a[24:25], v18 offset:49152
ds_read_b64_tr_b16 a[26:27], v18 offset:50176
ds_read_b64_tr_b16 a[28:29], v18 offset:57344
ds_read_b64_tr_b16 a[30:31], v18 offset:58368
ds_read_b64_tr_b16 a[64:65], v19 offset:0
ds_read_b64_tr_b16 a[66:67], v19 offset:1024
ds_read_b64_tr_b16 a[68:69], v19 offset:8192
ds_read_b64_tr_b16 a[70:71], v19 offset:9216
ds_read_b64_tr_b16 a[72:73], v19 offset:16384
ds_read_b64_tr_b16 a[74:75], v19 offset:17408
ds_read_b64_tr_b16 a[76:77], v19 offset:24576
ds_read_b64_tr_b16 a[78:79], v19 offset:25600
ds_read_b64_tr_b16 a[80:81], v19 offset:32768
ds_read_b64_tr_b16 a[82:83], v19 offset:33792
ds_read_b64_tr_b16 a[84:85], v19 offset:40960
ds_read_b64_tr_b16 a[86:87], v19 offset:41984
ds_read_b64_tr_b16 a[88:89], v19 offset:49152
ds_read_b64_tr_b16 a[90:91], v19 offset:50176
ds_read_b64_tr_b16 a[92:93], v19 offset:57344
ds_read_b64_tr_b16 a[94:95], v19 offset:58368
s_waitcnt lgkmcnt(0)
s_barrier
v_xor_b32 v18, 0x10000, v18
v_xor_b32 v19, 0x10000, v19
v_mov_b32 v16, v17
s_lshl_b32 s36, s32, 10
s_add_u32 m0, s36, 0
s_nop 0
global_load_lds_dwordx4 v16, s[46:47]
v_add_u32 v16, 44032, v16
s_add_u32 m0, s36, 4096
s_nop 0
global_load_lds_dwordx4 v16, s[46:47]
v_add_u32 v16, 44032, v16
s_add_u32 m0, s36, 8192
s_nop 0
global_load_lds_dwordx4 v16, s[46:47]
v_add_u32 v16, 44032, v16
s_add_u32 m0, s36, 12288
s_nop 0
global_load_lds_dwordx4 v16, s[46:47]
v_add_u32 v16, 44032, v16
s_add_u32 m0, s36, 16384
s_nop 0
global_load_lds_dwordx4 v16, s[46:47]
v_add_u32 v16, 44032, v16
s_add_u32 m0, s36, 20480
s_nop 0
global_load_lds_dwordx4 v16, s[46:47]
v_add_u32 v16, 44032, v16
s_add_u32 m0, s36, 24576
s_nop 0
global_load_lds_dwordx4 v16, s[46:47]
v_add_u32 v16, 44032, v16
s_add_u32 m0, s36, 28672
s_nop 0
global_load_lds_dwordx4 v16, s[46:47]
v_add_u32 v16, 44032, v16
s_add_u32 m0, s36, 32768
s_nop 0
global_load_lds_dwordx4 v16, s[46:47]
v_add_u32 v16, 44032, v16
s_add_u32 m0, s36, 36864
s_nop 0
global_load_lds_dwordx4 v16, s[46:47]
v_add_u32 v16, 44032, v16
s_add_u32 m0, s36, 40960
s_nop 0
global_load_lds_dwordx4 v16, s[46:47]
v_add_u32 v16, 44032, v16
s_add_u32 m0, s36, 45056
s_nop 0
global_load_lds_dwordx4 v16, s[46:47]
v_add_u32 v16, 44032, v16
s_add_u32 m0, s36, 49152
s_nop 0
global_load_lds_dwordx4 v16, s[46:47]
v_add_u32 v16, 44032, v16
s_add_u32 m0, s36, 53248
s_nop 0
global_load_lds_dwordx4 v16, s[46:47]
v_add_u32 v16, 44032, v16
s_add_u32 m0, s36, 57344
s_nop 0
global_load_lds_dwordx4 v16, s[46:47]
v_add_u32 v16, 44032, v16
s_add_u32 m0, s36, 61440
s_nop 0
global_load_lds_dwordx4 v16, s[46:47]
v_add_u32 v16, 44032, v16
s_waitcnt vmcnt(16)
s_barrier
ds_read_b64_tr_b16 a[32:33], v18 offset:0
ds_read_b64_tr_b16 a[34:35], v18 offset:1024
ds_read_b64_tr_b16 a[36:37], v18 offset:8192
ds_read_b64_tr_b16 a[38:39], v18 offset:9216
ds_read_b64_tr_b16 a[40:41], v18 offset:16384
ds_read_b64_tr_b16 a[42:43], v18 offset:17408
ds_read_b64_tr_b16 a[44:45], v18 offset:24576
ds_read_b64_tr_b16 a[46:47], v18 offset:25600
ds_read_b64_tr_b16 a[48:49], v18 offset:32768
ds_read_b64_tr_b16 a[50:51], v18 offset:33792
ds_read_b64_tr_b16 a[52:53], v18 offset:40960
ds_read_b64_tr_b16 a[54:55], v18 offset:41984
ds_read_b64_tr_b16 a[56:57], v18 offset:49152
ds_read_b64_tr_b16 a[58:59], v18 offset:50176
ds_read_b64_tr_b16 a[60:61], v18 offset:57344
ds_read_b64_tr_b16 a[62:63], v18 offset:58368
ds_read_b64_tr_b16 a[96:97], v19 offset:0
ds_read_b64_tr_b16 a[98:99], v19 offset:1024
ds_read_b64_tr_b16 a[100:101], v19 offset:8192
ds_read_b64_tr_b16 a[102:103], v19 offset:9216
ds_read_b64_tr_b16 a[104:105], v19 offset:16384
ds_read_b64_tr_b16 a[106:107], v19 offset:17408
ds_read_b64_tr_b16 a[108:109], v19 offset:24576
ds_read_b64_tr_b16 a[110:111], v19 offset:25600
ds_read_b64_tr_b16 a[112:113], v19 offset:32768
ds_read_b64_tr_b16 a[114:115], v19 offset:33792
ds_read_b64_tr_b16 a[116:117], v19 offset:40960
ds_read_b64_tr_b16 a[118:119], v19 offset:41984
ds_read_b64_tr_b16 a[120:121], v19 offset:49152
ds_read_b64_tr_b16 a[122:123], v19 offset:50176
ds_read_b64_tr_b16 a[124:125], v19 offset:57344
ds_read_b64_tr_b16 a[126:127], v19 offset:58368
s_waitcnt lgkmcnt(0)
s_barrier
v_xor_b32 v18, 0x10000, v18
v_xor_b32 v19, 0x10000, v19
s_lshl_b32 s36, s32, 10
s_add_u32 s36, s36, 65536
s_add_u32 m0, s36, 0
s_nop 0
global_load_lds_dwordx4 v16, s[46:47]
v_add_u32 v16, 44032, v16
s_add_u32 m0, s36, 4096
s_nop 0
global_load_lds_dwordx4 v16, s[46:47]
v_add_u32 v16, 44032, v16
s_add_u32 m0, s36, 8192
s_nop 0
global_load_lds_dwordx4 v16, s[46:47]
v_add_u32 v16, 44032, v16
s_add_u32 m0, s36, 12288
s_nop 0
global_load_lds_dwordx4 v16, s[46:47]
v_add_u32 v16, 44032, v16
s_add_u32 m0, s36, 16384
s_nop 0
global_load_lds_dwordx4 v16, s[46:47]
v_add_u32 v16, 44032, v16
s_add_u32 m0, s36, 20480
s_nop 0
global_load_lds_dwordx4 v16, s[46:47]
v_add_u32 v16, 44032, v16
s_add_u32 m0, s36, 24576
s_nop 0
global_load_lds_dwordx4 v16, s[46:47]
v_add_u32 v16, 44032, v16
s_add_u32 m0, s36, 28672
s_nop 0
global_load_lds_dwordx4 v16, s[46:47]
v_add_u32 v16, 44032, v16
s_add_u32 m0, s36, 32768
s_nop 0
global_load_lds_dwordx4 v16, s[46:47]
v_add_u32 v16, 44032, v16
s_add_u32 m0, s36, 36864
s_nop 0
global_load_lds_dwordx4 v16, s[46:47]
v_add_u32 v16, 44032, v16
s_add_u32 m0, s36, 40960
s_nop 0
global_load_lds_dwordx4 v16, s[46:47]
v_add_u32 v16, 44032, v16
s_add_u32 m0, s36, 45056
s_nop 0
global_load_lds_dwordx4 v16, s[46:47]
v_add_u32 v16, 44032, v16
s_add_u32 m0, s36, 49152
s_nop 0
global_load_lds_dwordx4 v16, s[46:47]
v_add_u32 v16, 44032, v16
s_add_u32 m0, s36, 53248
s_nop 0
global_load_lds_dwordx4 v16, s[46:47]
v_add_u32 v16, 44032, v16
s_add_u32 m0, s36, 57344
s_nop 0
global_load_lds_dwordx4 v16, s[46:47]
v_add_u32 v16, 44032, v16
s_add_u32 m0, s36, 61440
s_nop 0
global_load_lds_dwordx4 v16, s[46:47]
v_add_u32 v16, 44032, v16
s_waitcnt vmcnt(16)
s_barrier
ds_read_b64_tr_b16 a[128:129], v18 offset:0
ds_read_b64_tr_b16 a[130:131], v18 offset:1024
ds_read_b64_tr_b16 a[132:133], v18 offset:8192
ds_read_b64_tr_b16 a[134:135], v18 offset:9216
ds_read_b64_tr_b16 a[136:137], v18 offset:16384
ds_read_b64_tr_b16 a[138:139], v18 offset:17408
ds_read_b64_tr_b16 a[140:141], v18 offset:24576
ds_read_b64_tr_b16 a[142:143], v18 offset:25600
ds_read_b64_tr_b16 a[144:145], v18 offset:32768
ds_read_b64_tr_b16 a[146:147], v18 offset:33792
ds_read_b64_tr_b16 a[148:149], v18 offset:40960
ds_read_b64_tr_b16 a[150:151], v18 offset:41984
ds_read_b64_tr_b16 a[152:153], v18 offset:49152
ds_read_b64_tr_b16 a[154:155], v18 offset:50176
ds_read_b64_tr_b16 a[156:157], v18 offset:57344
ds_read_b64_tr_b16 a[158:159], v18 offset:58368
ds_read_b64_tr_b16 a[192:193], v19 offset:0
ds_read_b64_tr_b16 a[194:195], v19 offset:1024
ds_read_b64_tr_b16 a[196:197], v19 offset:8192
ds_read_b64_tr_b16 a[198:199], v19 offset:9216
ds_read_b64_tr_b16 a[200:201], v19 offset:16384
ds_read_b64_tr_b16 a[202:203], v19 offset:17408
ds_read_b64_tr_b16 a[204:205], v19 offset:24576
ds_read_b64_tr_b16 a[206:207], v19 offset:25600
ds_read_b64_tr_b16 a[208:209], v19 offset:32768
ds_read_b64_tr_b16 a[210:211], v19 offset:33792
ds_read_b64_tr_b16 a[212:213], v19 offset:40960
ds_read_b64_tr_b16 a[214:215], v19 offset:41984
ds_read_b64_tr_b16 a[216:217], v19 offset:49152
ds_read_b64_tr_b16 a[218:219], v19 offset:50176
ds_read_b64_tr_b16 a[220:221], v19 offset:57344
ds_read_b64_tr_b16 a[222:223], v19 offset:58368
s_waitcnt lgkmcnt(0)
s_barrier
v_xor_b32 v18, 0x10000, v18
v_xor_b32 v19, 0x10000, v19
s_waitcnt vmcnt(0)
s_barrier
ds_read_b64_tr_b16 a[160:161], v18 offset:0
ds_read_b64_tr_b16 a[162:163], v18 offset:1024
ds_read_b64_tr_b16 a[164:165], v18 offset:8192
ds_read_b64_tr_b16 a[166:167], v18 offset:9216
ds_read_b64_tr_b16 a[168:169], v18 offset:16384
ds_read_b64_tr_b16 a[170:171], v18 offset:17408
ds_read_b64_tr_b16 a[172:173], v18 offset:24576
ds_read_b64_tr_b16 a[174:175], v18 offset:25600
ds_read_b64_tr_b16 a[176:177], v18 offset:32768
ds_read_b64_tr_b16 a[178:179], v18 offset:33792
ds_read_b64_tr_b16 a[180:181], v18 offset:40960
ds_read_b64_tr_b16 a[182:183], v18 offset:41984
ds_read_b64_tr_b16 a[184:185], v18 offset:49152
ds_read_b64_tr_b16 a[186:187], v18 offset:50176
ds_read_b64_tr_b16 a[188:189], v18 offset:57344
ds_read_b64_tr_b16 a[190:191], v18 offset:58368
ds_read_b64_tr_b16 a[224:225], v19 offset:0
ds_read_b64_tr_b16 a[226:227], v19 offset:1024
ds_read_b64_tr_b16 a[228:229], v19 offset:8192
ds_read_b64_tr_b16 a[230:231], v19 offset:9216
ds_read_b64_tr_b16 a[232:233], v19 offset:16384
ds_read_b64_tr_b16 a[234:235], v19 offset:17408
ds_read_b64_tr_b16 a[236:237], v19 offset:24576
ds_read_b64_tr_b16 a[238:239], v19 offset:25600
ds_read_b64_tr_b16 a[240:241], v19 offset:32768
ds_read_b64_tr_b16 a[242:243], v19 offset:33792
ds_read_b64_tr_b16 a[244:245], v19 offset:40960
ds_read_b64_tr_b16 a[246:247], v19 offset:41984
ds_read_b64_tr_b16 a[248:249], v19 offset:49152
ds_read_b64_tr_b16 a[250:251], v19 offset:50176
ds_read_b64_tr_b16 a[252:253], v19 offset:57344
ds_read_b64_tr_b16 a[254:255], v19 offset:58368
s_waitcnt lgkmcnt(0)
s_barrier
v_xor_b32 v18, 0x10000, v18
v_xor_b32 v19, 0x10000, v19
v_and_b32 v2, 63, v0
v_lshlrev_b32 v2, 4, v2
s_lshl_b32 s36, s32, 13
v_add_u32 v3, s36, v2
v_add_u32 v4, 4096, v3
v_mov_b32 v5, v2
s_mov_b32 s50, s36
s_lshl_b32 s36, s42, 15
s_add_u32 s36, s36, 65536
s_add_u32 s52, s30, s36
s_addc_u32 s53, s31, 0
s_lshl_b32 s37, s41, 2
s_add_u32 s37, s37, s32
s_mul_i32 s36, s42, 88
s_add_u32 s36, s36, s37
s_lshl_b32 s36, s36, 10
s_add_u32 s36, s36, 71303168
s_lshl_b32 s37, s37, 2
s_lshl_b32 s38, s42, 10
s_add_u32 s37, s37, s38
s_add_u32 s37, s37, 6144
s_add_u32 s54, s30, s36
s_addc_u32 s55, s31, 0
v_mov_b32 v6, s37
v_and_b32 v8, 3, v0
v_lshl_add_u32 v6, v8, 8, v6
s_mov_b32 s56, 0
s_mov_b32 m0, s50
s_nop 0
global_load_lds_dwordx4 v3, s[52:53] offset:0 sc1
global_load_lds_dwordx4 v3, s[52:53] offset:1024 sc1
global_load_lds_dwordx4 v3, s[52:53] offset:2048 sc1
global_load_lds_dwordx4 v3, s[52:53] offset:3072 sc1
s_add_u32 m0, s50, 4096
s_nop 0
global_load_lds_dwordx4 v4, s[52:53] offset:0 sc1
global_load_lds_dwordx4 v4, s[52:53] offset:1024 sc1
global_load_lds_dwordx4 v4, s[52:53] offset:2048 sc1
global_load_lds_dwordx4 v4, s[52:53] offset:3072 sc1
s_waitcnt vmcnt(0)
L_seg_9:
s_waitcnt vmcnt(3)
s_barrier
s_xor_b32 s50, s50, 0x8000
s_add_u32 s52, s52, 65536
s_addc_u32 s53, s53, 0
s_cmp_lt_u32 s56, 31
s_cbranch_scc0 L_np_10_skip
s_mov_b32 m0, s50
s_nop 0
global_load_lds_dwordx4 v3, s[52:53] offset:0 sc1
global_load_lds_dwordx4 v3, s[52:53] offset:1024 sc1
global_load_lds_dwordx4 v3, s[52:53] offset:2048 sc1
global_load_lds_dwordx4 v3, s[52:53] offset:3072 sc1
s_add_u32 m0, s50, 4096
s_nop 0
global_load_lds_dwordx4 v4, s[52:53] offset:0 sc1
global_load_lds_dwordx4 v4, s[52:53] offset:1024 sc1
global_load_lds_dwordx4 v4, s[52:53] offset:2048 sc1
global_load_lds_dwordx4 v4, s[52:53] offset:3072 sc1
s_branch L_np_10
L_np_10_skip:
s_waitcnt vmcnt(0)
L_np_10:
ds_read_b128 v[64:67], v5 offset:0
ds_read_b128 v[68:71], v5 offset:1024
ds_read_b128 v[72:75], v5 offset:2048
ds_read_b128 v[76:79], v5 offset:3072
s_waitcnt lgkmcnt(3)
v_mfma_f32_16x16x32_bf16 v[32:35], a[0:3], v[64:67], 0
v_mfma_f32_16x16x32_bf16 v[48:51], a[128:131], v[64:67], 0
v_mfma_f32_16x16x32_bf16 v[36:39], a[64:67], v[64:67], 0
v_mfma_f32_16x16x32_bf16 v[52:55], a[192:195], v[64:67], 0
ds_read_b128 v[64:67], v5 offset:4096
s_waitcnt lgkmcnt(3)
v_mfma_f32_16x16x32_bf16 v[32:35], a[4:7], v[68:71], v[32:35]
v_mfma_f32_16x16x32_bf16 v[48:51], a[132:135], v[68:71], v[48:51]
v_mfma_f32_16x16x32_bf16 v[36:39], a[68:71], v[68:71], v[36:39]
v_mfma_f32_16x16x32_bf16 v[52:55], a[196:199], v[68:71], v[52:55]
ds_read_b128 v[68:71], v5 offset:5120
s_waitcnt lgkmcnt(3)
v_mfma_f32_16x16x32_bf16 v[32:35], a[8:11], v[72:75], v[32:35]
v_mfma_f32_16x16x32_bf16 v[48:51], a[136:139], v[72:75], v[48:51]
v_mfma_f32_16x16x32_bf16 v[36:39], a[72:75], v[72:75], v[36:39]
v_mfma_f32_16x16x32_bf16 v[52:55], a[200:203], v[72:75], v[52:55]
ds_read_b128 v[72:75], v5 offset:6144
s_waitcnt lgkmcnt(3)
v_mfma_f32_16x16x32_bf16 v[32:35], a[12:15], v[76:79], v[32:35]
v_mfma_f32_16x16x32_bf16 v[48:51], a[140:143], v[76:79], v[48:51]
v_mfma_f32_16x16x32_bf16 v[36:39], a[76:79], v[76:79], v[36:39]
v_mfma_f32_16x16x32_bf16 v[52:55], a[204:207], v[76:79], v[52:55]
ds_read_b128 v[76:79], v5 offset:7168
s_waitcnt lgkmcnt(3)
v_mfma_f32_16x16x32_bf16 v[32:35], a[16:19], v[64:67], v[32:35]
v_mfma_f32_16x16x32_bf16 v[48:51], a[144:147], v[64:67], v[48:51]
v_mfma_f32_16x16x32_bf16 v[36:39], a[80:83], v[64:67], v[36:39]
v_mfma_f32_16x16x32_bf16 v[52:55], a[208:211], v[64:67], v[52:55]
ds_read_b128 v[64:67], v5 offset:8192
s_waitcnt lgkmcnt(3)
v_mfma_f32_16x16x32_bf16 v[32:35], a[20:23], v[68:71], v[32:35]
v_mfma_f32_16x16x32_bf16 v[48:51], a[148:151], v[68:71], v[48:51]
v_mfma_f32_16x16x32_bf16 v[36:39], a[84:87], v[68:71], v[36:39]
v_mfma_f32_16x16x32_bf16 v[52:55], a[212:215], v[68:71], v[52:55]
ds_read_b128 v[68:71], v5 offset:9216
s_waitcnt lgkmcnt(3)
v_mfma_f32_16x16x32_bf16 v[32:35], a[24:27], v[72:75], v[32:35]
v_mfma_f32_16x16x32_bf16 v[48:51], a[152:155], v[72:75], v[48:51]
v_mfma_f32_16x16x32_bf16 v[36:39], a[88:91], v[72:75], v[36:39]
v_mfma_f32_16x16x32_bf16 v[52:55], a[216:219], v[72:75], v[52:55]
ds_read_b128 v[72:75], v5 offset:10240
s_waitcnt lgkmcnt(3)
v_mfma_f32_16x16x32_bf16 v[32:35], a[28:31], v[76:79], v[32:35]
v_mfma_f32_16x16x32_bf16 v[48:51], a[156:159], v[76:79], v[48:51]
v_mfma_f32_16x16x32_bf16 v[36:39], a[92:95], v[76:79], v[36:39]
v_mfma_f32_16x16x32_bf16 v[52:55], a[220:223], v[76:79], v[52:55]
ds_read_b128 v[76:79], v5 offset:11264
s_waitcnt lgkmcnt(3)
v_mfma_f32_16x16x32_bf16 v[32:35], a[32:35], v[64:67], v[32:35]
v_mfma_f32_16x16x32_bf16 v[48:51], a[160:163], v[64:67], v[48:51]
v_mfma_f32_16x16x32_bf16 v[36:39], a[96:99], v[64:67], v[36:39]
v_mfma_f32_16x16x32_bf16 v[52:55], a[224:227], v[64:67], v[52:55]
ds_read_b128 v[64:67], v5 offset:12288
s_waitcnt lgkmcnt(3)
v_mfma_f32_16x16x32_bf16 v[32:35], a[36:39], v[68:71], v[32:35]
v_mfma_f32_16x16x32_bf16 v[48:51], a[164:167], v[68:71], v[48:51]
v_mfma_f32_16x16x32_bf16 v[36:39], a[100:103], v[68:71], v[36:39]
v_mfma_f32_16x16x32_bf16 v[52:55], a[228:231], v[68:71], v[52:55]
ds_read_b128 v[68:71], v5 offset:13312
s_waitcnt lgkmcnt(3)
v_mfma_f32_16x16x32_bf16 v[32:35], a[40:43], v[72:75], v[32:35]
v_mfma_f32_16x16x32_bf16 v[48:51], a[168:171], v[72:75], v[48:51]
v_mfma_f32_16x16x32_bf16 v[36:39], a[104:107], v[72:75], v[36:39]
v_mfma_f32_16x16x32_bf16 v[52:55], a[232:235], v[72:75], v[52:55]
ds_read_b128 v[72:75], v5 offset:14336
s_waitcnt lgkmcnt(3)
v_mfma_f32_16x16x32_bf16 v[32:35], a[44:47], v[76:79], v[32:35]
v_mfma_f32_16x16x32_bf16 v[48:51], a[172:175], v[76:79], v[48:51]
v_mfma_f32_16x16x32_bf16 v[36:39], a[108:111], v[76:79], v[36:39]
v_mfma_f32_16x16x32_bf16 v[52:55], a[236:239], v[76:79], v[52:55]
ds_read_b128 v[76:79], v5 offset:15360
s_waitcnt lgkmcnt(3)
v_mfma_f32_16x16x32_bf16 v[32:35], a[48:51], v[64:67], v[32:35]
v_mfma_f32_16x16x32_bf16 v[48:51], a[176:179], v[64:67], v[48:51]
v_mfma_f32_16x16x32_bf16 v[36:39], a[112:115], v[64:67], v[36:39]
v_mfma_f32_16x16x32_bf16 v[52:55], a[240:243], v[64:67], v[52:55]
ds_read_b128 v[64:67], v5 offset:16384
s_waitcnt lgkmcnt(3)
v_mfma_f32_16x16x32_bf16 v[32:35], a[52:55], v[68:71], v[32:35]
v_mfma_f32_16x16x32_bf16 v[48:51], a[180:183], v[68:71], v[48:51]
v_mfma_f32_16x16x32_bf16 v[36:39], a[116:119], v[68:71], v[36:39]
v_mfma_f32_16x16x32_bf16 v[52:55], a[244:247], v[68:71], v[52:55]
ds_read_b128 v[68:71], v5 offset:17408
s_waitcnt lgkmcnt(3)
v_mfma_f32_16x16x32_bf16 v[32:35], a[56:59], v[72:75], v[32:35]
v_mfma_f32_16x16x32_bf16 v[48:51], a[184:187], v[72:75], v[48:51]
v_mfma_f32_16x16x32_bf16 v[36:39], a[120:123], v[72:75], v[36:39]
v_mfma_f32_16x16x32_bf16 v[52:55], a[248:251], v[72:75], v[52:55]
ds_read_b128 v[72:75], v5 offset:18432
s_waitcnt lgkmcnt(3)
v_mfma_f32_16x16x32_bf16 v[32:35], a[60:63], v[76:79], v[32:35]
v_mfma_f32_16x16x32_bf16 v[48:51], a[188:191], v[76:79], v[48:51]
v_mfma_f32_16x16x32_bf16 v[36:39], a[124:127], v[76:79], v[36:39]
v_mfma_f32_16x16x32_bf16 v[52:55], a[252:255], v[76:79], v[52:55]
s_waitcnt vmcnt(8)
v_mov_b32 v7, s56
s_mov_b64 exec, 15
global_store_dword v6, v7, s[30:31] sc1
s_mov_b64 exec, -1
ds_read_b128 v[76:79], v5 offset:19456
s_waitcnt lgkmcnt(3)
v_mfma_f32_16x16x32_bf16 v[40:43], a[0:3], v[64:67], 0
v_mfma_f32_16x16x32_bf16 v[56:59], a[128:131], v[64:67], 0
v_mfma_f32_16x16x32_bf16 v[44:47], a[64:67], v[64:67], 0
v_mfma_f32_16x16x32_bf16 v[60:63], a[192:195], v[64:67], 0
ds_read_b128 v[64:67], v5 offset:20480
s_waitcnt lgkmcnt(3)
v_mfma_f32_16x16x32_bf16 v[40:43], a[4:7], v[68:71], v[40:43]
v_mfma_f32_16x16x32_bf16 v[56:59], a[132:135], v[68:71], v[56:59]
v_mfma_f32_16x16x32_bf16 v[44:47], a[68:71], v[68:71], v[44:47]
v_mfma_f32_16x16x32_bf16 v[60:63], a[196:199], v[68:71], v[60:63]
ds_read_b128 v[68:71], v5 offset:21504
s_waitcnt lgkmcnt(3)
v_mfma_f32_16x16x32_bf16 v[40:43], a[8:11], v[72:75], v[40:43]
v_mfma_f32_16x16x32_bf16 v[56:59], a[136:139], v[72:75], v[56:59]
v_mfma_f32_16x16x32_bf16 v[44:47], a[72:75], v[72:75], v[44:47]
v_mfma_f32_16x16x32_bf16 v[60:63], a[200:203], v[72:75], v[60:63]
ds_read_b128 v[72:75], v5 offset:22528
s_waitcnt lgkmcnt(3)
v_mfma_f32_16x16x32_bf16 v[40:43], a[12:15], v[76:79], v[40:43]
v_mfma_f32_16x16x32_bf16 v[56:59], a[140:143], v[76:79], v[56:59]
v_mfma_f32_16x16x32_bf16 v[44:47], a[76:79], v[76:79], v[44:47]
v_mfma_f32_16x16x32_bf16 v[60:63], a[204:207], v[76:79], v[60:63]
ds_read_b128 v[76:79], v5 offset:23552
s_waitcnt lgkmcnt(3)
v_mfma_f32_16x16x32_bf16 v[40:43], a[16:19], v[64:67], v[40:43]
v_mfma_f32_16x16x32_bf16 v[56:59], a[144:147], v[64:67], v[56:59]
v_mfma_f32_16x16x32_bf16 v[44:47], a[80:83], v[64:67], v[44:47]
v_mfma_f32_16x16x32_bf16 v[60:63], a[208:211], v[64:67], v[60:63]
ds_read_b128 v[64:67], v5 offset:24576
s_waitcnt lgkmcnt(3)
v_mfma_f32_16x16x32_bf16 v[40:43], a[20:23], v[68:71], v[40:43]
v_mfma_f32_16x16x32_bf16 v[56:59], a[148:151], v[68:71], v[56:59]
v_mfma_f32_16x16x32_bf16 v[44:47], a[84:87], v[68:71], v[44:47]
v_mfma_f32_16x16x32_bf16 v[60:63], a[212:215], v[68:71], v[60:63]
ds_read_b128 v[68:71], v5 offset:25600
s_waitcnt lgkmcnt(3)
v_mfma_f32_16x16x32_bf16 v[40:43], a[24:27], v[72:75], v[40:43]
v_mfma_f32_16x16x32_bf16 v[56:59], a[152:155], v[72:75], v[56:59]
v_mfma_f32_16x16x32_bf16 v[44:47], a[88:91], v[72:75], v[44:47]
v_mfma_f32_16x16x32_bf16 v[60:63], a[216:219], v[72:75], v[60:63]
ds_read_b128 v[72:75], v5 offset:26624
s_waitcnt lgkmcnt(3)
v_mfma_f32_16x16x32_bf16 v[40:43], a[28:31], v[76:79], v[40:43]
v_mfma_f32_16x16x32_bf16 v[56:59], a[156:159], v[76:79], v[56:59]
v_mfma_f32_16x16x32_bf16 v[44:47], a[92:95], v[76:79], v[44:47]
v_mfma_f32_16x16x32_bf16 v[60:63], a[220:223], v[76:79], v[60:63]
ds_read_b128 v[76:79], v5 offset:27648
s_waitcnt lgkmcnt(3)
v_mfma_f32_16x16x32_bf16 v[40:43], a[32:35], v[64:67], v[40:43]
v_mfma_f32_16x16x32_bf16 v[56:59], a[160:163], v[64:67], v[56:59]
v_mfma_f32_16x16x32_bf16 v[44:47], a[96:99], v[64:67], v[44:47]
v_mfma_f32_16x16x32_bf16 v[60:63], a[224:227], v[64:67], v[60:63]
ds_read_b128 v[64:67], v5 offset:28672
s_waitcnt lgkmcnt(3)
v_mfma_f32_16x16x32_bf16 v[40:43], a[36:39], v[68:71], v[40:43]
v_mfma_f32_16x16x32_bf16 v[56:59], a[164:167], v[68:71], v[56:59]
v_mfma_f32_16x16x32_bf16 v[44:47], a[100:103], v[68:71], v[44:47]
v_mfma_f32_16x16x32_bf16 v[60:63], a[228:231], v[68:71], v[60:63]
ds_read_b128 v[68:71], v5 offset:29696
s_waitcnt lgkmcnt(3)
v_mfma_f32_16x16x32_bf16 v[40:43], a[40:43], v[72:75], v[40:43]
v_mfma_f32_16x16x32_bf16 v[56:59], a[168:171], v[72:75], v[56:59]
v_mfma_f32_16x16x32_bf16 v[44:47], a[104:107], v[72:75], v[44:47]
v_mfma_f32_16x16x32_bf16 v[60:63], a[232:235], v[72:75], v[60:63]
ds_read_b128 v[72:75], v5 offset:30720
s_waitcnt lgkmcnt(3)
v_mfma_f32_16x16x32_bf16 v[40:43], a[44:47], v[76:79], v[40:43]
v_mfma_f32_16x16x32_bf16 v[56:59], a[172:175], v[76:79], v[56:59]
v_mfma_f32_16x16x32_bf16 v[44:47], a[108:111], v[76:79], v[44:47]
v_mfma_f32_16x16x32_bf16 v[60:63], a[236:239], v[76:79], v[60:63]
ds_read_b128 v[76:79], v5 offset:31744
s_waitcnt lgkmcnt(3)
v_mfma_f32_16x16x32_bf16 v[40:43], a[48:51], v[64:67], v[40:43]
v_mfma_f32_16x16x32_bf16 v[56:59], a[176:179], v[64:67], v[56:59]
v_mfma_f32_16x16x32_bf16 v[44:47], a[112:115], v[64:67], v[44:47]
v_mfma_f32_16x16x32_bf16 v[60:63], a[240:243], v[64:67], v[60:63]
s_waitcnt lgkmcnt(2)
v_mfma_f32_16x16x32_bf16 v[40:43], a[52:55], v[68:71], v[40:43]
v_mfma_f32_16x16x32_bf16 v[56:59], a[180:183], v[68:71], v[56:59]
v_mfma_f32_16x16x32_bf16 v[44:47], a[116:119], v[68:71], v[44:47]
v_mfma_f32_16x16x32_bf16 v[60:63], a[244:247], v[68:71], v[60:63]
s_waitcnt lgkmcnt(1)
v_mfma_f32_16x16x32_bf16 v[40:43], a[56:59], v[72:75], v[40:43]
v_mfma_f32_16x16x32_bf16 v[56:59], a[184:187], v[72:75], v[56:59]
v_mfma_f32_16x16x32_bf16 v[44:47], a[120:123], v[72:75], v[44:47]
v_mfma_f32_16x16x32_bf16 v[60:63], a[248:251], v[72:75], v[60:63]
s_waitcnt lgkmcnt(0)
v_mfma_f32_16x16x32_bf16 v[40:43], a[60:63], v[76:79], v[40:43]
v_mfma_f32_16x16x32_bf16 v[56:59], a[188:191], v[76:79], v[56:59]
v_mfma_f32_16x16x32_bf16 v[44:47], a[124:127], v[76:79], v[44:47]
v_mfma_f32_16x16x32_bf16 v[60:63], a[252:255], v[76:79], v[60:63]
v_xor_b32 v5, 0x8000, v5
v_pk_mul_f32 v[32:33], v[32:33], v[48:49]
v_pk_mul_f32 v[34:35], v[34:35], v[50:51]
v_cvt_pk_bf16_f32 v96, v32, v33
v_cvt_pk_bf16_f32 v97, v34, v35
v_pk_mul_f32 v[36:37], v[36:37], v[52:53]
v_pk_mul_f32 v[38:39], v[38:39], v[54:55]
v_cvt_pk_bf16_f32 v98, v36, v37
v_cvt_pk_bf16_f32 v99, v38, v39
v_pk_mul_f32 v[40:41], v[40:41], v[56:57]
v_pk_mul_f32 v[42:43], v[42:43], v[58:59]
v_cvt_pk_bf16_f32 v100, v40, v41
v_cvt_pk_bf16_f32 v101, v42, v43
v_pk_mul_f32 v[44:45], v[44:45], v[60:61]
v_pk_mul_f32 v[46:47], v[46:47], v[62:63]
v_cvt_pk_bf16_f32 v102, v44, v45
v_cvt_pk_bf16_f32 v103, v46, v47
global_store_dwordx4 v2, v[96:99], s[54:55] sc1
v_add_u32 v8, 45056, v2
global_store_dwordx4 v8, v[100:103], s[54:55] sc1
s_add_u32 s54, s54, 180224
s_addc_u32 s55, s55, 0
s_add_u32 s56, s56, 1
s_cmp_lt_u32 s56, 32
s_cbranch_scc1 L_seg_9
s_waitcnt vmcnt(0)
v_mov_b32 v7, 32
s_mov_b64 exec, 15
global_store_dword v6, v7, s[30:31] sc1
s_endpgm
L_rec:
s_sub_u32 s41, s34, 0x1000
v_and_b32 v1, 63, v0
v_lshlrev_b32 v6, 4, v1
s_mov_b64 s[62:63], s[30:31]
s_add_u32 s44, s30, 77594624
s_addc_u32 s45, s31, 0
s_add_u32 s46, s30, 77602816
s_addc_u32 s47, s31, 0
s_add_u32 s48, s30, 77611008
s_addc_u32 s49, s31, 0
s_add_u32 s56, s30, 77660160
s_addc_u32 s57, s31, 0
s_lshl_b32 s36, s41, 13
s_add_u32 s36, s36, 77660160
s_lshl_b32 s67, s32, 6
s_add_u32 s54, s30, s36
s_addc_u32 s55, s31, 0
s_lshl_b32 s36, s41, 17
s_add_u32 s68, s14, s36
s_addc_u32 s69, s15, 0
s_lshl_b32 s36, s41, 8
s_add_u32 s74, s8, s36
s_addc_u32 s75, s9, 0
s_add_u32 s76, s10, s36
s_addc_u32 s77, s11, 0
s_add_u32 s78, s12, s36
s_addc_u32 s79, s13, 0
v_and_b32 v88, 63, v0
v_lshrrev_b32 v89, 4, v88
v_and_b32 v90, 15, v0
s_lshr_b32 s36, s32, 1
s_lshl_b32 s36, s36, 2
v_or_b32 v91, s36, v89
v_lshlrev_b32 v91, 1, v91
v_xor_b32 v90, v90, v91
s_lshl_b32 s36, s32, 2
v_add_u32 v89, s36, v89
v_mul_u32_u24 v89, 8192, v89
v_lshl_add_u32 v85, v90, 4, v89
v_lshrrev_b32 v88, 4, v0
v_and_b32 v88, 3, v88
v_bfe_u32 v89, v0, 2, 2
v_lshl_add_u32 v90, v88, 3, v89
v_lshlrev_b32 v90, 8, v90
v_and_b32 v88, 1, v88
v_lshl_or_b32 v88, v88, 2, v89
v_and_b32 v89, 1, v0
v_lshl_add_u32 v90, v89, 3, v90
v_bfe_u32 v89, v0, 1, 1
v_lshl_add_u32 v90, v89, 4, v90
s_lshl_b32 s36, s32, 1
s_add_u32 s37, s36, 0
v_xor_b32 v89, s37, v88
v_lshl_add_u32 v86, v89, 5, v90
s_add_u32 s37, s36, 1
v_xor_b32 v89, s37, v88
v_lshl_add_u32 v87, v89, 5, v90
s_cmp_eq_u32 s33, 0
s_cbranch_scc1 L_rec_sp
v_mov_b32 v84, v85
s_lshl_b32 s36, s32, 10
s_add_u32 m0, s36, 0
s_nop 0
global_load_lds_dwordx4 v84, s[74:75]
v_add_u32 v84, 131072, v84
s_add_u32 m0, s36, 4096
s_nop 0
global_load_lds_dwordx4 v84, s[74:75]
v_add_u32 v84, 131072, v84
s_add_u32 m0, s36, 8192
s_nop 0
global_load_lds_dwordx4 v84, s[74:75]
v_add_u32 v84, 131072, v84
s_add_u32 m0, s36, 12288
s_nop 0
global_load_lds_dwordx4 v84, s[74:75]
v_add_u32 v84, 131072, v84
s_add_u32 m0, s36, 16384
s_nop 0
global_load_lds_dwordx4 v84, s[74:75]
v_add_u32 v84, 131072, v84
s_add_u32 m0, s36, 20480
s_nop 0
global_load_lds_dwordx4 v84, s[74:75]
v_add_u32 v84, 131072, v84
s_add_u32 m0, s36, 24576
s_nop 0
global_load_lds_dwordx4 v84, s[74:75]
v_add_u32 v84, 131072, v84
s_add_u32 m0, s36, 28672
s_nop 0
global_load_lds_dwordx4 v84, s[74:75]
v_add_u32 v84, 131072, v84
s_add_u32 m0, s36, 32768
s_nop 0
global_load_lds_dwordx4 v84, s[74:75]
v_add_u32 v84, 131072, v84
s_add_u32 m0, s36, 36864
s_nop 0
global_load_lds_dwordx4 v84, s[74:75]
v_add_u32 v84, 131072, v84
s_add_u32 m0, s36, 40960
s_nop 0
global_load_lds_dwordx4 v84, s[74:75]
v_add_u32 v84, 131072, v84
s_add_u32 m0, s36, 45056
s_nop 0
global_load_lds_dwordx4 v84, s[74:75]
v_add_u32 v84, 131072, v84
s_add_u32 m0, s36, 49152
s_nop 0
global_load_lds_dwordx4 v84, s[74:75]
v_add_u32 v84, 131072, v84
s_add_u32 m0, s36, 53248
s_nop 0
global_load_lds_dwordx4 v84, s[74:75]
v_add_u32 v84, 131072, v84
s_add_u32 m0, s36, 57344
s_nop 0
global_load_lds_dwordx4 v84, s[74:75]
v_add_u32 v84, 131072, v84
s_add_u32 m0, s36, 61440
s_nop 0
global_load_lds_dwordx4 v84, s[74:75]
v_add_u32 v84, 131072, v84
s_lshl_b32 s36, s32, 10
s_add_u32 s36, s36, 65536
s_add_u32 m0, s36, 0
s_nop 0
global_load_lds_dwordx4 v84, s[74:75]
v_add_u32 v84, 131072, v84
s_add_u32 m0, s36, 4096
s_nop 0
global_load_lds_dwordx4 v84, s[74:75]
v_add_u32 v84, 131072, v84
s_add_u32 m0, s36, 8192
s_nop 0
global_load_lds_dwordx4 v84, s[74:75]
v_add_u32 v84, 131072, v84
s_add_u32 m0, s36, 12288
s_nop 0
global_load_lds_dwordx4 v84, s[74:75]
v_add_u32 v84, 131072, v84
s_add_u32 m0, s36, 16384
s_nop 0
global_load_lds_dwordx4 v84, s[74:75]
v_add_u32 v84, 131072, v84
s_add_u32 m0, s36, 20480
s_nop 0
global_load_lds_dwordx4 v84, s[74:75]
v_add_u32 v84, 131072, v84
s_add_u32 m0, s36, 24576
s_nop 0
global_load_lds_dwordx4 v84, s[74:75]
v_add_u32 v84, 131072, v84
s_add_u32 m0, s36, 28672
s_nop 0
global_load_lds_dwordx4 v84, s[74:75]
v_add_u32 v84, 131072, v84
s_add_u32 m0, s36, 32768
s_nop 0
global_load_lds_dwordx4 v84, s[74:75]
v_add_u32 v84, 131072, v84
s_add_u32 m0, s36, 36864
s_nop 0
global_load_lds_dwordx4 v84, s[74:75]
v_add_u32 v84, 131072, v84
s_add_u32 m0, s36, 40960
s_nop 0
global_load_lds_dwordx4 v84, s[74:75]
v_add_u32 v84, 131072, v84
s_add_u32 m0, s36, 45056
s_nop 0
global_load_lds_dwordx4 v84, s[74:75]
v_add_u32 v84, 131072, v84
s_add_u32 m0, s36, 49152
s_nop 0
global_load_lds_dwordx4 v84, s[74:75]
v_add_u32 v84, 131072, v84
s_add_u32 m0, s36, 53248
s_nop 0
global_load_lds_dwordx4 v84, s[74:75]
v_add_u32 v84, 131072, v84
s_add_u32 m0, s36, 57344
s_nop 0
global_load_lds_dwordx4 v84, s[74:75]
v_add_u32 v84, 131072, v84
s_add_u32 m0, s36, 61440
s_nop 0
global_load_lds_dwordx4 v84, s[74:75]
v_add_u32 v84, 131072, v84
L_rec_sp:
v_bfe_u32 v90, v0, 2, 1
v_lshlrev_b32 v90, 4, v90
v_bfe_u32 v91, v0, 5, 1
v_lshl_add_u32 v90, v91, 3, v90
v_lshlrev_b32 v91, 2, v91
v_bfe_u32 v93, v0, 4, 1
v_lshl_add_u32 v90, v93, 2, v90
v_bfe_u32 v93, v0, 3, 1
v_add_u32 v90, v90, v93
v_add_u32 v91, v91, v93
v_lshlrev_b32 v90, 8, v90
v_and_b32 v93, 1, v0
v_lshl_add_u32 v90, v93, 3, v90
v_bfe_u32 v93, v0, 1, 1
v_lshl_add_u32 v90, v93, 4, v90
s_lshl_b32 s36, s32, 1
s_add_u32 s37, s36, 0
s_xor_b32 s37, s37, 0
v_xor_b32 v93, s37, v91
v_lshl_add_u32 v86, v93, 5, v90
s_add_u32 s37, s36, 0
s_xor_b32 s37, s37, 2
v_xor_b32 v93, s37, v91
v_lshl_add_u32 v87, v93, 5, v90
v_add_u32 v87, 512, v87
s_add_u32 s37, s36, 1
s_xor_b32 s37, s37, 0
v_xor_b32 v93, s37, v91
v_lshl_add_u32 v88, v93, 5, v90
s_add_u32 s37, s36, 1
s_xor_b32 s37, s37, 2
v_xor_b32 v93, s37, v91
v_lshl_add_u32 v89, v93, 5, v90
v_add_u32 v89, 512, v89
s_and_b32 s36, s32, 1
s_xor_b32 s36, s36, 1
s_lshl_b32 s36, s36, 15
v_xor_b32 v86, s36, v86
v_xor_b32 v87, s36, v87
v_xor_b32 v88, s36, v88
v_xor_b32 v89, s36, v89
s_waitcnt vmcnt(16)
s_barrier
s_cmp_lt_u32 s32, 2
s_cbranch_scc0 L_wv_11
ds_read_b64_tr_b16 a[16:17], v86 offset:0
ds_read_b64_tr_b16 a[18:19], v87 offset:0
ds_read_b64_tr_b16 a[20:21], v86 offset:8192
ds_read_b64_tr_b16 a[22:23], v87 offset:8192
ds_read_b64_tr_b16 a[24:25], v86 offset:16384
ds_read_b64_tr_b16 a[26:27], v87 offset:16384
ds_read_b64_tr_b16 a[28:29], v86 offset:24576
ds_read_b64_tr_b16 a[30:31], v87 offset:24576
ds_read_b64_tr_b16 a[64:65], v88 offset:0
ds_read_b64_tr_b16 a[66:67], v89 offset:0
ds_read_b64_tr_b16 a[68:69], v88 offset:8192
ds_read_b64_tr_b16 a[70:71], v89 offset:8192
ds_read_b64_tr_b16 a[72:73], v88 offset:16384
ds_read_b64_tr_b16 a[74:75], v89 offset:16384
ds_read_b64_tr_b16 a[76:77], v88 offset:24576
ds_read_b64_tr_b16 a[78:79], v89 offset:24576
v_xor_b32 v86, 0x8000, v86
v_xor_b32 v87, 0x8000, v87
v_xor_b32 v88, 0x8000, v88
v_xor_b32 v89, 0x8000, v89
ds_read_b64_tr_b16 a[32:33], v86 offset:0
ds_read_b64_tr_b16 a[34:35], v87 offset:0
ds_read_b64_tr_b16 a[36:37], v86 offset:8192
ds_read_b64_tr_b16 a[38:39], v87 offset:8192
ds_read_b64_tr_b16 a[40:41], v86 offset:16384
ds_read_b64_tr_b16 a[42:43], v87 offset:16384
ds_read_b64_tr_b16 a[44:45], v86 offset:24576
ds_read_b64_tr_b16 a[46:47], v87 offset:24576
ds_read_b64_tr_b16 a[80:81], v88 offset:0
ds_read_b64_tr_b16 a[82:83], v89 offset:0
ds_read_b64_tr_b16 a[84:85], v88 offset:8192
ds_read_b64_tr_b16 a[86:87], v89 offset:8192
ds_read_b64_tr_b16 a[88:89], v88 offset:16384
ds_read_b64_tr_b16 a[90:91], v89 offset:16384
ds_read_b64_tr_b16 a[92:93], v88 offset:24576
ds_read_b64_tr_b16 a[94:95], v89 offset:24576
s_branch L_wj_12
L_wv_11:
ds_read_b64_tr_b16 v[128:129], v86 offset:0
ds_read_b64_tr_b16 v[130:131], v87 offset:0
ds_read_b64_tr_b16 v[132:133], v86 offset:8192
ds_read_b64_tr_b16 v[134:135], v87 offset:8192
ds_read_b64_tr_b16 v[144:145], v86 offset:16384
ds_read_b64_tr_b16 v[146:147], v87 offset:16384
ds_read_b64_tr_b16 v[148:149], v86 offset:24576
ds_read_b64_tr_b16 v[150:151], v87 offset:24576
ds_read_b64_tr_b16 v[136:137], v88 offset:0
ds_read_b64_tr_b16 v[138:139], v89 offset:0
ds_read_b64_tr_b16 v[140:141], v88 offset:8192
ds_read_b64_tr_b16 v[142:143], v89 offset:8192
ds_read_b64_tr_b16 v[152:153], v88 offset:16384
ds_read_b64_tr_b16 v[154:155], v89 offset:16384
ds_read_b64_tr_b16 v[156:157], v88 offset:24576
ds_read_b64_tr_b16 v[158:159], v89 offset:24576
v_xor_b32 v86, 0x8000, v86
v_xor_b32 v87, 0x8000, v87
v_xor_b32 v88, 0x8000, v88
v_xor_b32 v89, 0x8000, v89
ds_read_b64_tr_b16 a[0:1], v86 offset:0
ds_read_b64_tr_b16 a[2:3], v87 offset:0
ds_read_b64_tr_b16 a[4:5], v86 offset:8192
ds_read_b64_tr_b16 a[6:7], v87 offset:8192
ds_read_b64_tr_b16 a[8:9], v86 offset:16384
ds_read_b64_tr_b16 a[10:11], v87 offset:16384
ds_read_b64_tr_b16 a[12:13], v86 offset:24576
ds_read_b64_tr_b16 a[14:15], v87 offset:24576
ds_read_b64_tr_b16 a[48:49], v88 offset:0
ds_read_b64_tr_b16 a[50:51], v89 offset:0
ds_read_b64_tr_b16 a[52:53], v88 offset:8192
ds_read_b64_tr_b16 a[54:55], v89 offset:8192
ds_read_b64_tr_b16 a[56:57], v88 offset:16384
ds_read_b64_tr_b16 a[58:59], v89 offset:16384
ds_read_b64_tr_b16 a[60:61], v88 offset:24576
ds_read_b64_tr_b16 a[62:63], v89 offset:24576
L_wj_12:
s_waitcnt lgkmcnt(0)
s_barrier
v_xor_b32 v86, 98304, v86
v_xor_b32 v87, 98304, v87
v_xor_b32 v88, 98304, v88
v_xor_b32 v89, 98304, v89
v_mov_b32 v84, v85
s_lshl_b32 s36, s32, 10
s_add_u32 m0, s36, 0
s_nop 0
global_load_lds_dwordx4 v84, s[76:77]
v_add_u32 v84, 131072, v84
s_add_u32 m0, s36, 4096
s_nop 0
global_load_lds_dwordx4 v84, s[76:77]
v_add_u32 v84, 131072, v84
s_add_u32 m0, s36, 8192
s_nop 0
global_load_lds_dwordx4 v84, s[76:77]
v_add_u32 v84, 131072, v84
s_add_u32 m0, s36, 12288
s_nop 0
global_load_lds_dwordx4 v84, s[76:77]
v_add_u32 v84, 131072, v84
s_add_u32 m0, s36, 16384
s_nop 0
global_load_lds_dwordx4 v84, s[76:77]
v_add_u32 v84, 131072, v84
s_add_u32 m0, s36, 20480
s_nop 0
global_load_lds_dwordx4 v84, s[76:77]
v_add_u32 v84, 131072, v84
s_add_u32 m0, s36, 24576
s_nop 0
global_load_lds_dwordx4 v84, s[76:77]
v_add_u32 v84, 131072, v84
s_add_u32 m0, s36, 28672
s_nop 0
global_load_lds_dwordx4 v84, s[76:77]
v_add_u32 v84, 131072, v84
s_add_u32 m0, s36, 32768
s_nop 0
global_load_lds_dwordx4 v84, s[76:77]
v_add_u32 v84, 131072, v84
s_add_u32 m0, s36, 36864
s_nop 0
global_load_lds_dwordx4 v84, s[76:77]
v_add_u32 v84, 131072, v84
s_add_u32 m0, s36, 40960
s_nop 0
global_load_lds_dwordx4 v84, s[76:77]
v_add_u32 v84, 131072, v84
s_add_u32 m0, s36, 45056
s_nop 0
global_load_lds_dwordx4 v84, s[76:77]
v_add_u32 v84, 131072, v84
s_add_u32 m0, s36, 49152
s_nop 0
global_load_lds_dwordx4 v84, s[76:77]
v_add_u32 v84, 131072, v84
s_add_u32 m0, s36, 53248
s_nop 0
global_load_lds_dwordx4 v84, s[76:77]
v_add_u32 v84, 131072, v84
s_add_u32 m0, s36, 57344
s_nop 0
global_load_lds_dwordx4 v84, s[76:77]
v_add_u32 v84, 131072, v84
s_add_u32 m0, s36, 61440
s_nop 0
global_load_lds_dwordx4 v84, s[76:77]
v_add_u32 v84, 131072, v84
s_waitcnt vmcnt(16)
s_barrier
s_cmp_lt_u32 s32, 2
s_cbranch_scc0 L_wv_13
ds_read_b64_tr_b16 v[128:129], v86 offset:0
ds_read_b64_tr_b16 v[130:131], v87 offset:0
ds_read_b64_tr_b16 v[132:133], v86 offset:8192
ds_read_b64_tr_b16 v[134:135], v87 offset:8192
ds_read_b64_tr_b16 v[144:145], v86 offset:16384
ds_read_b64_tr_b16 v[146:147], v87 offset:16384
ds_read_b64_tr_b16 v[148:149], v86 offset:24576
ds_read_b64_tr_b16 v[150:151], v87 offset:24576
ds_read_b64_tr_b16 v[136:137], v88 offset:0
ds_read_b64_tr_b16 v[138:139], v89 offset:0
ds_read_b64_tr_b16 v[140:141], v88 offset:8192
ds_read_b64_tr_b16 v[142:143], v89 offset:8192
ds_read_b64_tr_b16 v[152:153], v88 offset:16384
ds_read_b64_tr_b16 v[154:155], v89 offset:16384
ds_read_b64_tr_b16 v[156:157], v88 offset:24576
ds_read_b64_tr_b16 v[158:159], v89 offset:24576
v_xor_b32 v86, 0x8000, v86
v_xor_b32 v87, 0x8000, v87
v_xor_b32 v88, 0x8000, v88
v_xor_b32 v89, 0x8000, v89
ds_read_b64_tr_b16 a[0:1], v86 offset:0
ds_read_b64_tr_b16 a[2:3], v87 offset:0
ds_read_b64_tr_b16 a[4:5], v86 offset:8192
ds_read_b64_tr_b16 a[6:7], v87 offset:8192
ds_read_b64_tr_b16 a[8:9], v86 offset:16384
ds_read_b64_tr_b16 a[10:11], v87 offset:16384
ds_read_b64_tr_b16 a[12:13], v86 offset:24576
ds_read_b64_tr_b16 a[14:15], v87 offset:24576
ds_read_b64_tr_b16 a[48:49], v88 offset:0
ds_read_b64_tr_b16 a[50:51], v89 offset:0
ds_read_b64_tr_b16 a[52:53], v88 offset:8192
ds_read_b64_tr_b16 a[54:55], v89 offset:8192
ds_read_b64_tr_b16 a[56:57], v88 offset:16384
ds_read_b64_tr_b16 a[58:59], v89 offset:16384
ds_read_b64_tr_b16 a[60:61], v88 offset:24576
ds_read_b64_tr_b16 a[62:63], v89 offset:24576
s_branch L_wj_14
L_wv_13:
ds_read_b64_tr_b16 a[16:17], v86 offset:0
ds_read_b64_tr_b16 a[18:19], v87 offset:0
ds_read_b64_tr_b16 a[20:21], v86 offset:8192
ds_read_b64_tr_b16 a[22:23], v87 offset:8192
ds_read_b64_tr_b16 a[24:25], v86 offset:16384
ds_read_b64_tr_b16 a[26:27], v87 offset:16384
ds_read_b64_tr_b16 a[28:29], v86 offset:24576
ds_read_b64_tr_b16 a[30:31], v87 offset:24576
ds_read_b64_tr_b16 a[64:65], v88 offset:0
ds_read_b64_tr_b16 a[66:67], v89 offset:0
ds_read_b64_tr_b16 a[68:69], v88 offset:8192
ds_read_b64_tr_b16 a[70:71], v89 offset:8192
ds_read_b64_tr_b16 a[72:73], v88 offset:16384
ds_read_b64_tr_b16 a[74:75], v89 offset:16384
ds_read_b64_tr_b16 a[76:77], v88 offset:24576
ds_read_b64_tr_b16 a[78:79], v89 offset:24576
v_xor_b32 v86, 0x8000, v86
v_xor_b32 v87, 0x8000, v87
v_xor_b32 v88, 0x8000, v88
v_xor_b32 v89, 0x8000, v89
ds_read_b64_tr_b16 a[32:33], v86 offset:0
ds_read_b64_tr_b16 a[34:35], v87 offset:0
ds_read_b64_tr_b16 a[36:37], v86 offset:8192
ds_read_b64_tr_b16 a[38:39], v87 offset:8192
ds_read_b64_tr_b16 a[40:41], v86 offset:16384
ds_read_b64_tr_b16 a[42:43], v87 offset:16384
ds_read_b64_tr_b16 a[44:45], v86 offset:24576
ds_read_b64_tr_b16 a[46:47], v87 offset:24576
ds_read_b64_tr_b16 a[80:81], v88 offset:0
ds_read_b64_tr_b16 a[82:83], v89 offset:0
ds_read_b64_tr_b16 a[84:85], v88 offset:8192
ds_read_b64_tr_b16 a[86:87], v89 offset:8192
ds_read_b64_tr_b16 a[88:89], v88 offset:16384
ds_read_b64_tr_b16 a[90:91], v89 offset:16384
ds_read_b64_tr_b16 a[92:93], v88 offset:24576
ds_read_b64_tr_b16 a[94:95], v89 offset:24576
L_wj_14:
s_waitcnt lgkmcnt(0)
s_barrier
v_xor_b32 v86, 98304, v86
v_xor_b32 v87, 98304, v87
v_xor_b32 v88, 98304, v88
v_xor_b32 v89, 98304, v89
s_lshl_b32 s36, s32, 10
s_add_u32 s36, s36, 65536
s_add_u32 m0, s36, 0
s_nop 0
global_load_lds_dwordx4 v84, s[76:77]
v_add_u32 v84, 131072, v84
s_add_u32 m0, s36, 4096
s_nop 0
global_load_lds_dwordx4 v84, s[76:77]
v_add_u32 v84, 131072, v84
s_add_u32 m0, s36, 8192
s_nop 0
global_load_lds_dwordx4 v84, s[76:77]
v_add_u32 v84, 131072, v84
s_add_u32 m0, s36, 12288
s_nop 0
global_load_lds_dwordx4 v84, s[76:77]
v_add_u32 v84, 131072, v84
s_add_u32 m0, s36, 16384
s_nop 0
global_load_lds_dwordx4 v84, s[76:77]
v_add_u32 v84, 131072, v84
s_add_u32 m0, s36, 20480
s_nop 0
global_load_lds_dwordx4 v84, s[76:77]
v_add_u32 v84, 131072, v84
s_add_u32 m0, s36, 24576
s_nop 0
global_load_lds_dwordx4 v84, s[76:77]
v_add_u32 v84, 131072, v84
s_add_u32 m0, s36, 28672
s_nop 0
global_load_lds_dwordx4 v84, s[76:77]
v_add_u32 v84, 131072, v84
s_add_u32 m0, s36, 32768
s_nop 0
global_load_lds_dwordx4 v84, s[76:77]
v_add_u32 v84, 131072, v84
s_add_u32 m0, s36, 36864
s_nop 0
global_load_lds_dwordx4 v84, s[76:77]
v_add_u32 v84, 131072, v84
s_add_u32 m0, s36, 40960
s_nop 0
global_load_lds_dwordx4 v84, s[76:77]
v_add_u32 v84, 131072, v84
s_add_u32 m0, s36, 45056
s_nop 0
global_load_lds_dwordx4 v84, s[76:77]
v_add_u32 v84, 131072, v84
s_add_u32 m0, s36, 49152
s_nop 0
global_load_lds_dwordx4 v84, s[76:77]
v_add_u32 v84, 131072, v84
s_add_u32 m0, s36, 53248
s_nop 0
global_load_lds_dwordx4 v84, s[76:77]
v_add_u32 v84, 131072, v84
s_add_u32 m0, s36, 57344
s_nop 0
global_load_lds_dwordx4 v84, s[76:77]
v_add_u32 v84, 131072, v84
s_add_u32 m0, s36, 61440
s_nop 0
global_load_lds_dwordx4 v84, s[76:77]
v_add_u32 v84, 131072, v84
v_and_b32 v2, 15, v0
v_bfe_u32 v3, v0, 4, 2
v_lshlrev_b32 v92, 4, v2
v_lshl_add_u32 v92, v3, 2, v92
s_lshl_b32 s36, s41, 8
v_add_u32 v92, s36, v92
v_mov_b32 v4, -1
s_cmp_lt_u32 s32, 3
s_cbranch_scc0 L_rec_i0
s_lshl_b32 s37, s32, 13
v_add_u32 v5, s37, v92
global_store_dword v5, v4, s[44:45]
L_rec_i0:
v_lshrrev_b32 v5, 1, v0
v_lshlrev_b32 v5, 11, v5
v_and_b32 v7, 1, v0
v_lshl_add_u32 v5, v7, 5, v5
s_lshl_b32 s36, s41, 6
v_add_u32 v5, s36, v5
v_mov_b32 v8, 1
v_mov_b32 v9, 0
v_mov_b32 v10, 1
v_mov_b32 v11, 0
global_store_dwordx4 v5, v[8:11], s[56:57]
global_store_dwordx4 v5, v[8:11], s[56:57] offset:16
s_waitcnt vmcnt(16)
s_barrier
s_cmp_lt_u32 s32, 2
s_cbranch_scc0 L_wv_15
ds_read_b64_tr_b16 a[112:113], v86 offset:0
ds_read_b64_tr_b16 a[114:115], v87 offset:0
ds_read_b64_tr_b16 a[116:117], v86 offset:8192
ds_read_b64_tr_b16 a[118:119], v87 offset:8192
ds_read_b64_tr_b16 a[120:121], v86 offset:16384
ds_read_b64_tr_b16 a[122:123], v87 offset:16384
ds_read_b64_tr_b16 a[124:125], v86 offset:24576
ds_read_b64_tr_b16 a[126:127], v87 offset:24576
ds_read_b64_tr_b16 a[160:161], v88 offset:0
ds_read_b64_tr_b16 a[162:163], v89 offset:0
ds_read_b64_tr_b16 a[164:165], v88 offset:8192
ds_read_b64_tr_b16 a[166:167], v89 offset:8192
ds_read_b64_tr_b16 a[168:169], v88 offset:16384
ds_read_b64_tr_b16 a[170:171], v89 offset:16384
ds_read_b64_tr_b16 a[172:173], v88 offset:24576
ds_read_b64_tr_b16 a[174:175], v89 offset:24576
v_xor_b32 v86, 0x8000, v86
v_xor_b32 v87, 0x8000, v87
v_xor_b32 v88, 0x8000, v88
v_xor_b32 v89, 0x8000, v89
ds_read_b64_tr_b16 a[128:129], v86 offset:0
ds_read_b64_tr_b16 a[130:131], v87 offset:0
ds_read_b64_tr_b16 a[132:133], v86 offset:8192
ds_read_b64_tr_b16 a[134:135], v87 offset:8192
ds_read_b64_tr_b16 a[136:137], v86 offset:16384
ds_read_b64_tr_b16 a[138:139], v87 offset:16384
ds_read_b64_tr_b16 a[140:141], v86 offset:24576
ds_read_b64_tr_b16 a[142:143], v87 offset:24576
ds_read_b64_tr_b16 a[176:177], v88 offset:0
ds_read_b64_tr_b16 a[178:179], v89 offset:0
ds_read_b64_tr_b16 a[180:181], v88 offset:8192
ds_read_b64_tr_b16 a[182:183], v89 offset:8192
ds_read_b64_tr_b16 a[184:185], v88 offset:16384
ds_read_b64_tr_b16 a[186:187], v89 offset:16384
ds_read_b64_tr_b16 a[188:189], v88 offset:24576
ds_read_b64_tr_b16 a[190:191], v89 offset:24576
s_branch L_wj_16
L_wv_15:
ds_read_b64_tr_b16 v[160:161], v86 offset:0
ds_read_b64_tr_b16 v[162:163], v87 offset:0
ds_read_b64_tr_b16 v[164:165], v86 offset:8192
ds_read_b64_tr_b16 v[166:167], v87 offset:8192
ds_read_b64_tr_b16 v[176:177], v86 offset:16384
ds_read_b64_tr_b16 v[178:179], v87 offset:16384
ds_read_b64_tr_b16 v[180:181], v86 offset:24576
ds_read_b64_tr_b16 v[182:183], v87 offset:24576
ds_read_b64_tr_b16 v[168:169], v88 offset:0
ds_read_b64_tr_b16 v[170:171], v89 offset:0
ds_read_b64_tr_b16 v[172:173], v88 offset:8192
ds_read_b64_tr_b16 v[174:175], v89 offset:8192
ds_read_b64_tr_b16 v[184:185], v88 offset:16384
ds_read_b64_tr_b16 v[186:187], v89 offset:16384
ds_read_b64_tr_b16 v[188:189], v88 offset:24576
ds_read_b64_tr_b16 v[190:191], v89 offset:24576
v_xor_b32 v86, 0x8000, v86
v_xor_b32 v87, 0x8000, v87
v_xor_b32 v88, 0x8000, v88
v_xor_b32 v89, 0x8000, v89
ds_read_b64_tr_b16 a[96:97], v86 offset:0
ds_read_b64_tr_b16 a[98:99], v87 offset:0
ds_read_b64_tr_b16 a[100:101], v86 offset:8192
ds_read_b64_tr_b16 a[102:103], v87 offset:8192
ds_read_b64_tr_b16 a[104:105], v86 offset:16384
ds_read_b64_tr_b16 a[106:107], v87 offset:16384
ds_read_b64_tr_b16 a[108:109], v86 offset:24576
ds_read_b64_tr_b16 a[110:111], v87 offset:24576
ds_read_b64_tr_b16 a[144:145], v88 offset:0
ds_read_b64_tr_b16 a[146:147], v89 offset:0
ds_read_b64_tr_b16 a[148:149], v88 offset:8192
ds_read_b64_tr_b16 a[150:151], v89 offset:8192
ds_read_b64_tr_b16 a[152:153], v88 offset:16384
ds_read_b64_tr_b16 a[154:155], v89 offset:16384
ds_read_b64_tr_b16 a[156:157], v88 offset:24576
ds_read_b64_tr_b16 a[158:159], v89 offset:24576
L_wj_16:
s_waitcnt lgkmcnt(0)
s_barrier
v_xor_b32 v86, 98304, v86
v_xor_b32 v87, 98304, v87
v_xor_b32 v88, 98304, v88
v_xor_b32 v89, 98304, v89
v_mov_b32 v84, v85
s_lshl_b32 s36, s32, 10
s_add_u32 m0, s36, 0
s_nop 0
global_load_lds_dwordx4 v84, s[78:79]
v_add_u32 v84, 131072, v84
s_add_u32 m0, s36, 4096
s_nop 0
global_load_lds_dwordx4 v84, s[78:79]
v_add_u32 v84, 131072, v84
s_add_u32 m0, s36, 8192
s_nop 0
global_load_lds_dwordx4 v84, s[78:79]
v_add_u32 v84, 131072, v84
s_add_u32 m0, s36, 12288
s_nop 0
global_load_lds_dwordx4 v84, s[78:79]
v_add_u32 v84, 131072, v84
s_add_u32 m0, s36, 16384
s_nop 0
global_load_lds_dwordx4 v84, s[78:79]
v_add_u32 v84, 131072, v84
s_add_u32 m0, s36, 20480
s_nop 0
global_load_lds_dwordx4 v84, s[78:79]
v_add_u32 v84, 131072, v84
s_add_u32 m0, s36, 24576
s_nop 0
global_load_lds_dwordx4 v84, s[78:79]
v_add_u32 v84, 131072, v84
s_add_u32 m0, s36, 28672
s_nop 0
global_load_lds_dwordx4 v84, s[78:79]
v_add_u32 v84, 131072, v84
s_add_u32 m0, s36, 32768
s_nop 0
global_load_lds_dwordx4 v84, s[78:79]
v_add_u32 v84, 131072, v84
s_add_u32 m0, s36, 36864
s_nop 0
global_load_lds_dwordx4 v84, s[78:79]
v_add_u32 v84, 131072, v84
s_add_u32 m0, s36, 40960
s_nop 0
global_load_lds_dwordx4 v84, s[78:79]
v_add_u32 v84, 131072, v84
s_add_u32 m0, s36, 45056
s_nop 0
global_load_lds_dwordx4 v84, s[78:79]
v_add_u32 v84, 131072, v84
s_add_u32 m0, s36, 49152
s_nop 0
global_load_lds_dwordx4 v84, s[78:79]
v_add_u32 v84, 131072, v84
s_add_u32 m0, s36, 53248
s_nop 0
global_load_lds_dwordx4 v84, s[78:79]
v_add_u32 v84, 131072, v84
s_add_u32 m0, s36, 57344
s_nop 0
global_load_lds_dwordx4 v84, s[78:79]
v_add_u32 v84, 131072, v84
s_add_u32 m0, s36, 61440
s_nop 0
global_load_lds_dwordx4 v84, s[78:79]
v_add_u32 v84, 131072, v84
s_waitcnt vmcnt(16)
s_barrier
s_cmp_eq_u32 s32, 0
s_cbranch_scc0 L_rec_i1
s_mov_b64 exec, 1
v_mov_b32 v5, 20480
v_mov_b32 v8, 1
global_atomic_add v5, v8, s[30:31]
s_mov_b64 exec, -1
L_rec_i1:
s_cmp_lt_u32 s32, 2
s_cbranch_scc0 L_wv_17
ds_read_b64_tr_b16 v[160:161], v86 offset:0
ds_read_b64_tr_b16 v[162:163], v87 offset:0
ds_read_b64_tr_b16 v[164:165], v86 offset:8192
ds_read_b64_tr_b16 v[166:167], v87 offset:8192
ds_read_b64_tr_b16 v[176:177], v86 offset:16384
ds_read_b64_tr_b16 v[178:179], v87 offset:16384
ds_read_b64_tr_b16 v[180:181], v86 offset:24576
ds_read_b64_tr_b16 v[182:183], v87 offset:24576
ds_read_b64_tr_b16 v[168:169], v88 offset:0
ds_read_b64_tr_b16 v[170:171], v89 offset:0
ds_read_b64_tr_b16 v[172:173], v88 offset:8192
ds_read_b64_tr_b16 v[174:175], v89 offset:8192
ds_read_b64_tr_b16 v[184:185], v88 offset:16384
ds_read_b64_tr_b16 v[186:187], v89 offset:16384
ds_read_b64_tr_b16 v[188:189], v88 offset:24576
ds_read_b64_tr_b16 v[190:191], v89 offset:24576
v_xor_b32 v86, 0x8000, v86
v_xor_b32 v87, 0x8000, v87
v_xor_b32 v88, 0x8000, v88
v_xor_b32 v89, 0x8000, v89
ds_read_b64_tr_b16 a[96:97], v86 offset:0
ds_read_b64_tr_b16 a[98:99], v87 offset:0
ds_read_b64_tr_b16 a[100:101], v86 offset:8192
ds_read_b64_tr_b16 a[102:103], v87 offset:8192
ds_read_b64_tr_b16 a[104:105], v86 offset:16384
ds_read_b64_tr_b16 a[106:107], v87 offset:16384
ds_read_b64_tr_b16 a[108:109], v86 offset:24576
ds_read_b64_tr_b16 a[110:111], v87 offset:24576
ds_read_b64_tr_b16 a[144:145], v88 offset:0
ds_read_b64_tr_b16 a[146:147], v89 offset:0
ds_read_b64_tr_b16 a[148:149], v88 offset:8192
ds_read_b64_tr_b16 a[150:151], v89 offset:8192
ds_read_b64_tr_b16 a[152:153], v88 offset:16384
ds_read_b64_tr_b16 a[154:155], v89 offset:16384
ds_read_b64_tr_b16 a[156:157], v88 offset:24576
ds_read_b64_tr_b16 a[158:159], v89 offset:24576
s_branch L_wj_18
L_wv_17:
ds_read_b64_tr_b16 a[112:113], v86 offset:0
ds_read_b64_tr_b16 a[114:115], v87 offset:0
ds_read_b64_tr_b16 a[116:117], v86 offset:8192
ds_read_b64_tr_b16 a[118:119], v87 offset:8192
ds_read_b64_tr_b16 a[120:121], v86 offset:16384
ds_read_b64_tr_b16 a[122:123], v87 offset:16384
ds_read_b64_tr_b16 a[124:125], v86 offset:24576
ds_read_b64_tr_b16 a[126:127], v87 offset:24576
ds_read_b64_tr_b16 a[160:161], v88 offset:0
ds_read_b64_tr_b16 a[162:163], v89 offset:0
ds_read_b64_tr_b16 a[164:165], v88 offset:8192
ds_read_b64_tr_b16 a[166:167], v89 offset:8192
ds_read_b64_tr_b16 a[168:169], v88 offset:16384
ds_read_b64_tr_b16 a[170:171], v89 offset:16384
ds_read_b64_tr_b16 a[172:173], v88 offset:24576
ds_read_b64_tr_b16 a[174:175], v89 offset:24576
v_xor_b32 v86, 0x8000, v86
v_xor_b32 v87, 0x8000, v87
v_xor_b32 v88, 0x8000, v88
v_xor_b32 v89, 0x8000, v89
ds_read_b64_tr_b16 a[128:129], v86 offset:0
ds_read_b64_tr_b16 a[130:131], v87 offset:0
ds_read_b64_tr_b16 a[132:133], v86 offset:8192
ds_read_b64_tr_b16 a[134:135], v87 offset:8192
ds_read_b64_tr_b16 a[136:137], v86 offset:16384
ds_read_b64_tr_b16 a[138:139], v87 offset:16384
ds_read_b64_tr_b16 a[140:141], v86 offset:24576
ds_read_b64_tr_b16 a[142:143], v87 offset:24576
ds_read_b64_tr_b16 a[176:177], v88 offset:0
ds_read_b64_tr_b16 a[178:179], v89 offset:0
ds_read_b64_tr_b16 a[180:181], v88 offset:8192
ds_read_b64_tr_b16 a[182:183], v89 offset:8192
ds_read_b64_tr_b16 a[184:185], v88 offset:16384
ds_read_b64_tr_b16 a[186:187], v89 offset:16384
ds_read_b64_tr_b16 a[188:189], v88 offset:24576
ds_read_b64_tr_b16 a[190:191], v89 offset:24576
L_wj_18:
s_waitcnt lgkmcnt(0)
s_barrier
v_xor_b32 v86, 98304, v86
v_xor_b32 v87, 98304, v87
v_xor_b32 v88, 98304, v88
v_xor_b32 v89, 98304, v89
s_lshl_b32 s36, s32, 10
s_add_u32 s36, s36, 65536
s_add_u32 m0, s36, 0
s_nop 0
global_load_lds_dwordx4 v84, s[78:79]
v_add_u32 v84, 131072, v84
s_add_u32 m0, s36, 4096
s_nop 0
global_load_lds_dwordx4 v84, s[78:79]
v_add_u32 v84, 131072, v84
s_add_u32 m0, s36, 8192
s_nop 0
global_load_lds_dwordx4 v84, s[78:79]
v_add_u32 v84, 131072, v84
s_add_u32 m0, s36, 12288
s_nop 0
global_load_lds_dwordx4 v84, s[78:79]
v_add_u32 v84, 131072, v84
s_add_u32 m0, s36, 16384
s_nop 0
global_load_lds_dwordx4 v84, s[78:79]
v_add_u32 v84, 131072, v84
s_add_u32 m0, s36, 20480
s_nop 0
global_load_lds_dwordx4 v84, s[78:79]
v_add_u32 v84, 131072, v84
s_add_u32 m0, s36, 24576
s_nop 0
global_load_lds_dwordx4 v84, s[78:79]
v_add_u32 v84, 131072, v84
s_add_u32 m0, s36, 28672
s_nop 0
global_load_lds_dwordx4 v84, s[78:79]
v_add_u32 v84, 131072, v84
s_add_u32 m0, s36, 32768
s_nop 0
global_load_lds_dwordx4 v84, s[78:79]
v_add_u32 v84, 131072, v84
s_add_u32 m0, s36, 36864
s_nop 0
global_load_lds_dwordx4 v84, s[78:79]
v_add_u32 v84, 131072, v84
s_add_u32 m0, s36, 40960
s_nop 0
global_load_lds_dwordx4 v84, s[78:79]
v_add_u32 v84, 131072, v84
s_add_u32 m0, s36, 45056
s_nop 0
global_load_lds_dwordx4 v84, s[78:79]
v_add_u32 v84, 131072, v84
s_add_u32 m0, s36, 49152
s_nop 0
global_load_lds_dwordx4 v84, s[78:79]
v_add_u32 v84, 131072, v84
s_add_u32 m0, s36, 53248
s_nop 0
global_load_lds_dwordx4 v84, s[78:79]
v_add_u32 v84, 131072, v84
s_add_u32 m0, s36, 57344
s_nop 0
global_load_lds_dwordx4 v84, s[78:79]
v_add_u32 v84, 131072, v84
s_add_u32 m0, s36, 61440
s_nop 0
global_load_lds_dwordx4 v84, s[78:79]
v_add_u32 v84, 131072, v84
s_waitcnt vmcnt(16)
s_barrier
s_cmp_lt_u32 s32, 2
s_cbranch_scc0 L_wv_19
ds_read_b64_tr_b16 a[192:193], v86 offset:0
ds_read_b64_tr_b16 a[194:195], v87 offset:0
ds_read_b64_tr_b16 a[196:197], v86 offset:8192
ds_read_b64_tr_b16 a[198:199], v87 offset:8192
ds_read_b64_tr_b16 a[200:201], v86 offset:16384
ds_read_b64_tr_b16 a[202:203], v87 offset:16384
ds_read_b64_tr_b16 a[204:205], v86 offset:24576
ds_read_b64_tr_b16 a[206:207], v87 offset:24576
ds_read_b64_tr_b16 a[224:225], v88 offset:0
ds_read_b64_tr_b16 a[226:227], v89 offset:0
ds_read_b64_tr_b16 a[228:229], v88 offset:8192
ds_read_b64_tr_b16 a[230:231], v89 offset:8192
ds_read_b64_tr_b16 a[232:233], v88 offset:16384
ds_read_b64_tr_b16 a[234:235], v89 offset:16384
ds_read_b64_tr_b16 a[236:237], v88 offset:24576
ds_read_b64_tr_b16 a[238:239], v89 offset:24576
v_xor_b32 v86, 0x8000, v86
v_xor_b32 v87, 0x8000, v87
v_xor_b32 v88, 0x8000, v88
v_xor_b32 v89, 0x8000, v89
ds_read_b64_tr_b16 a[208:209], v86 offset:0
ds_read_b64_tr_b16 a[210:211], v87 offset:0
ds_read_b64_tr_b16 a[212:213], v86 offset:8192
ds_read_b64_tr_b16 a[214:215], v87 offset:8192
ds_read_b64_tr_b16 a[216:217], v86 offset:16384
ds_read_b64_tr_b16 a[218:219], v87 offset:16384
ds_read_b64_tr_b16 a[220:221], v86 offset:24576
ds_read_b64_tr_b16 a[222:223], v87 offset:24576
ds_read_b64_tr_b16 a[240:241], v88 offset:0
ds_read_b64_tr_b16 a[242:243], v89 offset:0
ds_read_b64_tr_b16 a[244:245], v88 offset:8192
ds_read_b64_tr_b16 a[246:247], v89 offset:8192
ds_read_b64_tr_b16 a[248:249], v88 offset:16384
ds_read_b64_tr_b16 a[250:251], v89 offset:16384
ds_read_b64_tr_b16 a[252:253], v88 offset:24576
ds_read_b64_tr_b16 a[254:255], v89 offset:24576
s_branch L_wj_20
L_wv_19:
ds_read_b64_tr_b16 v[192:193], v86 offset:0
ds_read_b64_tr_b16 v[194:195], v87 offset:0
ds_read_b64_tr_b16 v[196:197], v86 offset:8192
ds_read_b64_tr_b16 v[198:199], v87 offset:8192
ds_read_b64_tr_b16 v[208:209], v86 offset:16384
ds_read_b64_tr_b16 v[210:211], v87 offset:16384
ds_read_b64_tr_b16 v[212:213], v86 offset:24576
ds_read_b64_tr_b16 v[214:215], v87 offset:24576
ds_read_b64_tr_b16 v[200:201], v88 offset:0
ds_read_b64_tr_b16 v[202:203], v89 offset:0
ds_read_b64_tr_b16 v[204:205], v88 offset:8192
ds_read_b64_tr_b16 v[206:207], v89 offset:8192
ds_read_b64_tr_b16 v[216:217], v88 offset:16384
ds_read_b64_tr_b16 v[218:219], v89 offset:16384
ds_read_b64_tr_b16 v[220:221], v88 offset:24576
ds_read_b64_tr_b16 v[222:223], v89 offset:24576
v_xor_b32 v86, 0x8000, v86
v_xor_b32 v87, 0x8000, v87
v_xor_b32 v88, 0x8000, v88
v_xor_b32 v89, 0x8000, v89
ds_read_b64_tr_b16 v[224:225], v86 offset:0
ds_read_b64_tr_b16 v[226:227], v87 offset:0
ds_read_b64_tr_b16 v[228:229], v86 offset:8192
ds_read_b64_tr_b16 v[230:231], v87 offset:8192
ds_read_b64_tr_b16 v[240:241], v86 offset:16384
ds_read_b64_tr_b16 v[242:243], v87 offset:16384
ds_read_b64_tr_b16 v[244:245], v86 offset:24576
ds_read_b64_tr_b16 v[246:247], v87 offset:24576
ds_read_b64_tr_b16 v[232:233], v88 offset:0
ds_read_b64_tr_b16 v[234:235], v89 offset:0
ds_read_b64_tr_b16 v[236:237], v88 offset:8192
ds_read_b64_tr_b16 v[238:239], v89 offset:8192
ds_read_b64_tr_b16 v[248:249], v88 offset:16384
ds_read_b64_tr_b16 v[250:251], v89 offset:16384
ds_read_b64_tr_b16 v[252:253], v88 offset:24576
ds_read_b64_tr_b16 v[254:255], v89 offset:24576
L_wj_20:
s_waitcnt lgkmcnt(0)
s_barrier
v_xor_b32 v86, 98304, v86
v_xor_b32 v87, 98304, v87
v_xor_b32 v88, 98304, v88
v_xor_b32 v89, 98304, v89
v_bfe_u32 v110, v0, 3, 3
v_bfe_u32 v111, v0, 5, 1
v_lshlrev_b32 v111, 1, v111
v_and_b32 v112, 7, v0
v_xor_b32 v108, v112, v111
v_xor_b32 v109, 4, v108
v_lshlrev_b32 v110, 10, v110
s_lshr_b32 s36, s32, 1
s_lshl_b32 s36, s36, 8
s_and_b32 s37, s32, 1
s_lshl_b32 s37, s37, 7
s_add_u32 s36, s36, s37
v_add_u32 v110, s36, v110
v_lshl_add_u32 v108, v108, 4, v110
v_lshl_add_u32 v109, v109, 4, v110
s_lshr_b32 s36, s32, 1
s_lshl_b32 s36, s36, 15
s_and_b32 s37, s32, 1
s_lshl_b32 s37, s37, 14
s_add_u32 s36, s36, s37
s_add_u32 s36, s36, 0
s_add_u32 m0, s36, 0
s_nop 0
global_load_lds_dwordx4 v108, s[68:69]
v_add_u32 v108, 8192, v108
v_add_u32 v109, 8192, v109
s_add_u32 m0, s36, 1024
s_nop 0
global_load_lds_dwordx4 v108, s[68:69]
v_add_u32 v108, 8192, v108
v_add_u32 v109, 8192, v109
s_add_u32 m0, s36, 2048
s_nop 0
global_load_lds_dwordx4 v109, s[68:69]
v_add_u32 v108, 8192, v108
v_add_u32 v109, 8192, v109
s_add_u32 m0, s36, 3072
s_nop 0
global_load_lds_dwordx4 v109, s[68:69]
v_add_u32 v108, 8192, v108
v_add_u32 v109, 8192, v109
s_add_u32 m0, s36, 4096
s_nop 0
global_load_lds_dwordx4 v108, s[68:69]
v_add_u32 v108, 8192, v108
v_add_u32 v109, 8192, v109
s_add_u32 m0, s36, 5120
s_nop 0
global_load_lds_dwordx4 v108, s[68:69]
v_add_u32 v108, 8192, v108
v_add_u32 v109, 8192, v109
s_add_u32 m0, s36, 6144
s_nop 0
global_load_lds_dwordx4 v109, s[68:69]
v_add_u32 v108, 8192, v108
v_add_u32 v109, 8192, v109
s_add_u32 m0, s36, 7168
s_nop 0
global_load_lds_dwordx4 v109, s[68:69]
v_add_u32 v108, 8192, v108
v_add_u32 v109, 8192, v109
s_add_u32 m0, s36, 8192
s_nop 0
global_load_lds_dwordx4 v108, s[68:69]
v_add_u32 v108, 8192, v108
v_add_u32 v109, 8192, v109
s_add_u32 m0, s36, 9216
s_nop 0
global_load_lds_dwordx4 v108, s[68:69]
v_add_u32 v108, 8192, v108
v_add_u32 v109, 8192, v109
s_add_u32 m0, s36, 10240
s_nop 0
global_load_lds_dwordx4 v109, s[68:69]
v_add_u32 v108, 8192, v108
v_add_u32 v109, 8192, v109
s_add_u32 m0, s36, 11264
s_nop 0
global_load_lds_dwordx4 v109, s[68:69]
v_add_u32 v108, 8192, v108
v_add_u32 v109, 8192, v109
s_add_u32 m0, s36, 12288
s_nop 0
global_load_lds_dwordx4 v108, s[68:69]
v_add_u32 v108, 8192, v108
v_add_u32 v109, 8192, v109
s_add_u32 m0, s36, 13312
s_nop 0
global_load_lds_dwordx4 v108, s[68:69]
v_add_u32 v108, 8192, v108
v_add_u32 v109, 8192, v109
s_add_u32 m0, s36, 14336
s_nop 0
global_load_lds_dwordx4 v109, s[68:69]
v_add_u32 v108, 8192, v108
v_add_u32 v109, 8192, v109
s_add_u32 m0, s36, 15360
s_nop 0
global_load_lds_dwordx4 v109, s[68:69]
v_add_u32 v108, 8192, v108
v_add_u32 v109, 8192, v109
s_waitcnt vmcnt(16)
s_barrier
s_cmp_lt_u32 s32, 2
s_cbranch_scc0 L_wv_21
ds_read_b64_tr_b16 v[192:193], v86 offset:0
ds_read_b64_tr_b16 v[194:195], v87 offset:0
ds_read_b64_tr_b16 v[196:197], v86 offset:8192
ds_read_b64_tr_b16 v[198:199], v87 offset:8192
ds_read_b64_tr_b16 v[208:209], v86 offset:16384
ds_read_b64_tr_b16 v[210:211], v87 offset:16384
ds_read_b64_tr_b16 v[212:213], v86 offset:24576
ds_read_b64_tr_b16 v[214:215], v87 offset:24576
ds_read_b64_tr_b16 v[200:201], v88 offset:0
ds_read_b64_tr_b16 v[202:203], v89 offset:0
ds_read_b64_tr_b16 v[204:205], v88 offset:8192
ds_read_b64_tr_b16 v[206:207], v89 offset:8192
ds_read_b64_tr_b16 v[216:217], v88 offset:16384
ds_read_b64_tr_b16 v[218:219], v89 offset:16384
ds_read_b64_tr_b16 v[220:221], v88 offset:24576
ds_read_b64_tr_b16 v[222:223], v89 offset:24576
v_xor_b32 v86, 0x8000, v86
v_xor_b32 v87, 0x8000, v87
v_xor_b32 v88, 0x8000, v88
v_xor_b32 v89, 0x8000, v89
ds_read_b64_tr_b16 v[224:225], v86 offset:0
ds_read_b64_tr_b16 v[226:227], v87 offset:0
ds_read_b64_tr_b16 v[228:229], v86 offset:8192
ds_read_b64_tr_b16 v[230:231], v87 offset:8192
ds_read_b64_tr_b16 v[240:241], v86 offset:16384
ds_read_b64_tr_b16 v[242:243], v87 offset:16384
ds_read_b64_tr_b16 v[244:245], v86 offset:24576
ds_read_b64_tr_b16 v[246:247], v87 offset:24576
ds_read_b64_tr_b16 v[232:233], v88 offset:0
ds_read_b64_tr_b16 v[234:235], v89 offset:0
ds_read_b64_tr_b16 v[236:237], v88 offset:8192
ds_read_b64_tr_b16 v[238:239], v89 offset:8192
ds_read_b64_tr_b16 v[248:249], v88 offset:16384
ds_read_b64_tr_b16 v[250:251], v89 offset:16384
ds_read_b64_tr_b16 v[252:253], v88 offset:24576
ds_read_b64_tr_b16 v[254:255], v89 offset:24576
s_branch L_wj_22
L_wv_21:
ds_read_b64_tr_b16 a[192:193], v86 offset:0
ds_read_b64_tr_b16 a[194:195], v87 offset:0
ds_read_b64_tr_b16 a[196:197], v86 offset:8192
ds_read_b64_tr_b16 a[198:199], v87 offset:8192
ds_read_b64_tr_b16 a[200:201], v86 offset:16384
ds_read_b64_tr_b16 a[202:203], v87 offset:16384
ds_read_b64_tr_b16 a[204:205], v86 offset:24576
ds_read_b64_tr_b16 a[206:207], v87 offset:24576
ds_read_b64_tr_b16 a[224:225], v88 offset:0
ds_read_b64_tr_b16 a[226:227], v89 offset:0
ds_read_b64_tr_b16 a[228:229], v88 offset:8192
ds_read_b64_tr_b16 a[230:231], v89 offset:8192
ds_read_b64_tr_b16 a[232:233], v88 offset:16384
ds_read_b64_tr_b16 a[234:235], v89 offset:16384
ds_read_b64_tr_b16 a[236:237], v88 offset:24576
ds_read_b64_tr_b16 a[238:239], v89 offset:24576
v_xor_b32 v86, 0x8000, v86
v_xor_b32 v87, 0x8000, v87
v_xor_b32 v88, 0x8000, v88
v_xor_b32 v89, 0x8000, v89
ds_read_b64_tr_b16 a[208:209], v86 offset:0
ds_read_b64_tr_b16 a[210:211], v87 offset:0
ds_read_b64_tr_b16 a[212:213], v86 offset:8192
ds_read_b64_tr_b16 a[214:215], v87 offset:8192
ds_read_b64_tr_b16 a[216:217], v86 offset:16384
ds_read_b64_tr_b16 a[218:219], v87 offset:16384
ds_read_b64_tr_b16 a[220:221], v86 offset:24576
ds_read_b64_tr_b16 a[222:223], v87 offset:24576
ds_read_b64_tr_b16 a[240:241], v88 offset:0
ds_read_b64_tr_b16 a[242:243], v89 offset:0
ds_read_b64_tr_b16 a[244:245], v88 offset:8192
ds_read_b64_tr_b16 a[246:247], v89 offset:8192
ds_read_b64_tr_b16 a[248:249], v88 offset:16384
ds_read_b64_tr_b16 a[250:251], v89 offset:16384
ds_read_b64_tr_b16 a[252:253], v88 offset:24576
ds_read_b64_tr_b16 a[254:255], v89 offset:24576
L_wj_22:
s_waitcnt lgkmcnt(0)
s_barrier
v_xor_b32 v86, 98304, v86
v_xor_b32 v87, 98304, v87
v_xor_b32 v88, 98304, v88
v_xor_b32 v89, 98304, v89
v_subrev_u32 v108, 130560, v108
v_subrev_u32 v109, 130560, v109
s_lshr_b32 s36, s32, 1
s_lshl_b32 s36, s36, 15
s_and_b32 s37, s32, 1
s_lshl_b32 s37, s37, 14
s_add_u32 s36, s36, s37
s_add_u32 s36, s36, 65536
s_add_u32 m0, s36, 0
s_nop 0
global_load_lds_dwordx4 v108, s[68:69]
v_add_u32 v108, 8192, v108
v_add_u32 v109, 8192, v109
s_add_u32 m0, s36, 1024
s_nop 0
global_load_lds_dwordx4 v108, s[68:69]
v_add_u32 v108, 8192, v108
v_add_u32 v109, 8192, v109
s_add_u32 m0, s36, 2048
s_nop 0
global_load_lds_dwordx4 v109, s[68:69]
v_add_u32 v108, 8192, v108
v_add_u32 v109, 8192, v109
s_add_u32 m0, s36, 3072
s_nop 0
global_load_lds_dwordx4 v109, s[68:69]
v_add_u32 v108, 8192, v108
v_add_u32 v109, 8192, v109
s_add_u32 m0, s36, 4096
s_nop 0
global_load_lds_dwordx4 v108, s[68:69]
v_add_u32 v108, 8192, v108
v_add_u32 v109, 8192, v109
s_add_u32 m0, s36, 5120
s_nop 0
global_load_lds_dwordx4 v108, s[68:69]
v_add_u32 v108, 8192, v108
v_add_u32 v109, 8192, v109
s_add_u32 m0, s36, 6144
s_nop 0
global_load_lds_dwordx4 v109, s[68:69]
v_add_u32 v108, 8192, v108
v_add_u32 v109, 8192, v109
s_add_u32 m0, s36, 7168
s_nop 0
global_load_lds_dwordx4 v109, s[68:69]
v_add_u32 v108, 8192, v108
v_add_u32 v109, 8192, v109
s_add_u32 m0, s36, 8192
s_nop 0
global_load_lds_dwordx4 v108, s[68:69]
v_add_u32 v108, 8192, v108
v_add_u32 v109, 8192, v109
s_add_u32 m0, s36, 9216
s_nop 0
global_load_lds_dwordx4 v108, s[68:69]
v_add_u32 v108, 8192, v108
v_add_u32 v109, 8192, v109
s_add_u32 m0, s36, 10240
s_nop 0
global_load_lds_dwordx4 v109, s[68:69]
v_add_u32 v108, 8192, v108
v_add_u32 v109, 8192, v109
s_add_u32 m0, s36, 11264
s_nop 0
global_load_lds_dwordx4 v109, s[68:69]
v_add_u32 v108, 8192, v108
v_add_u32 v109, 8192, v109
s_add_u32 m0, s36, 12288
s_nop 0
global_load_lds_dwordx4 v108, s[68:69]
v_add_u32 v108, 8192, v108
v_add_u32 v109, 8192, v109
s_add_u32 m0, s36, 13312
s_nop 0
global_load_lds_dwordx4 v108, s[68:69]
v_add_u32 v108, 8192, v108
v_add_u32 v109, 8192, v109
s_add_u32 m0, s36, 14336
s_nop 0
global_load_lds_dwordx4 v109, s[68:69]
v_add_u32 v108, 8192, v108
v_add_u32 v109, 8192, v109
s_add_u32 m0, s36, 15360
s_nop 0
global_load_lds_dwordx4 v109, s[68:69]
v_add_u32 v108, 8192, v108
v_add_u32 v109, 8192, v109
v_and_b32 v21, 15, v0
v_bfe_u32 v22, v0, 4, 2
v_bfe_u32 v27, v0, 1, 1
v_lshrrev_b32 v23, 2, v21
v_and_b32 v24, 1, v21
v_lshl_add_u32 v28, v23, 1, v24
v_mov_b32 v1, 0x4444
v_mov_b32 v25, 0xeeee
v_cmp_eq_u32 vcc, 0, v27
s_mov_b64 s[58:59], vcc
s_not_b64 s[60:61], vcc
v_cndmask_b32 v1, v25, v1, vcc
v_lshlrev_b32 v24, 4, v24
v_mov_b32 v25, 0x3f80
v_lshlrev_b32 v25, v24, v25
v_cmp_eq_u32 vcc, v23, v22
s_nop 1
v_cndmask_b32 v2, 0, v25, vcc
v_mov_b32 v3, 0
v_mov_b32 v4, 0
v_mov_b32 v5, v2
v_mov_b32 v16, 0
v_mov_b32 v17, 0
v_mov_b32 v18, 0
v_mov_b32 v19, 0
v_mov_b32 v15, -1
s_lshl_b32 s36, s32, 11
v_add_u32 v7, s36, v6
v_add_u32 v7, 131072, v7
v_add_u32 v8, 131072, v6
v_mul_u32_u24 v23, 288, v28
s_lshl_b32 s36, s32, 6
v_add_u32 v10, s36, v23
v_lshl_add_u32 v10, v22, 4, v10
v_add_u32 v10, 147456, v10
s_lshl_b32 s36, s32, 10
s_add_u32 s36, s36, 151552
v_add_u32 v24, s36, v6
v_cndmask_b32 v10, v24, v10, s[58:59]
v_lshl_add_u32 v11, v22, 5, v23
v_lshl_add_u32 v11, v27, 4, v11
v_add_u32 v11, 147456, v11
s_lshl_b32 s36, s32, 15
v_add_u32 v9, s36, v6
v_bfe_u32 v23, v0, 2, 1
v_lshlrev_b32 v23, 4, v23
v_mov_b32 v24, 0x3f80
v_lshlrev_b32 v24, v23, v24
v_cndmask_b32 v24, 0, v24, s[58:59]
v_bfe_u32 v23, v0, 3, 1
v_and_b32 v25, 1, v0
v_lshl_add_u32 v23, v23, 1, v25
v_cmp_eq_u32 vcc, 0, v23
s_nop 1
v_cndmask_b32 v32, 0, v24, vcc
v_mov_b32 v36, 0x3f803f80
v_mov_b32 v40, 0
v_cmp_eq_u32 vcc, 1, v23
s_nop 1
v_cndmask_b32 v33, 0, v24, vcc
v_mov_b32 v37, 0x3f803f80
v_mov_b32 v41, 0
v_cmp_eq_u32 vcc, 2, v23
s_nop 1
v_cndmask_b32 v34, 0, v24, vcc
v_mov_b32 v38, 0x3f803f80
v_mov_b32 v42, 0
v_cmp_eq_u32 vcc, 3, v23
s_nop 1
v_cndmask_b32 v35, 0, v24, vcc
v_mov_b32 v39, 0x3f803f80
v_mov_b32 v43, 0
ds_write_b128 v8, v[32:35] offset:24576
ds_write_b128 v8, v[36:39] offset:25600
ds_write_b128 v8, v[40:43] offset:26624
v_lshrrev_b32 v23, 3, v21
s_lshl_b32 s36, s32, 3
v_add_u32 v23, s36, v23
v_lshlrev_b32 v23, 13, v23
v_bfe_u32 v24, v0, 1, 2
v_lshl_add_u32 v23, v24, 11, v23
v_and_b32 v24, 1, v21
v_lshl_add_u32 v23, v24, 5, v23
v_lshrrev_b32 v24, 1, v22
v_lshl_add_u32 v23, v24, 4, v23
v_and_b32 v24, 1, v22
v_lshl_add_u32 v23, v24, 3, v23
s_lshl_b32 s36, s41, 6
v_add_u32 v12, s36, v23
v_and_b32 v23, 1, v21
v_lshlrev_b32 v23, 3, v23
v_lshrrev_b32 v24, 1, v22
v_lshl_add_u32 v23, v24, 2, v23
v_lshl_add_u32 v23, v27, 1, v23
v_and_b32 v24, 1, v22
v_add_u32 v23, v23, v24
v_lshlrev_b32 v23, 4, v23
s_lshl_b32 s36, s41, 8
s_lshl_b32 s37, s32, 2
s_add_u32 s36, s36, s37
v_add_u32 v13, s36, v23
s_lshl_b32 s37, s41, 7
s_lshl_b32 s36, s32, 2
s_add_u32 s37, s37, s36
s_add_u32 s64, s37, 8192
s_add_u32 s65, s37, 12288
s_add_u32 s66, s37, 16384
s_lshl_b32 s36, s41, 2
s_add_u32 s36, s36, s32
s_lshl_b32 s37, s36, 12
s_add_u32 s37, s37, 4194304
s_add_u32 s50, s30, s37
s_addc_u32 s51, s31, 0
s_lshl_b32 s37, s36, 11
s_add_u32 s37, s37, 37748736
s_add_u32 s52, s30, s37
s_addc_u32 s53, s31, 0
s_add_u32 s74, s62, s64
s_addc_u32 s75, s63, 0
s_add_u32 s76, s62, s65
s_addc_u32 s77, s63, 0
s_add_u32 s78, s62, s66
s_addc_u32 s79, s63, 0
s_mov_b32 s70, 1040356334
s_mov_b32 s71, 1040356334
s_mov_b32 s80, 0x000f000f
s_mov_b32 s81, 0x000f000f
s_waitcnt vmcnt(0)
s_barrier
v_bfe_u32 v97, v0, 2, 2
v_and_b32 v98, 1, v0
v_lshl_add_u32 v97, v97, 1, v98
v_lshlrev_b32 v94, 10, v97
v_bfe_u32 v98, v0, 4, 2
v_lshl_add_u32 v94, v98, 2, v94
v_bfe_u32 v98, v0, 1, 1
v_lshl_add_u32 v94, v98, 1, v94
s_lshr_b32 s36, s41, 1
s_lshl_b32 s36, s36, 6
s_and_b32 s37, s41, 1
s_lshl_b32 s37, s37, 4
s_add_u32 s36, s36, s37
v_add_u32 v94, s36, v94
global_load_ushort v95, v94, s[6:7]
global_load_ushort v96, v94, s[6:7] offset:32
v_bfe_u32 v109, v0, 4, 1
v_bfe_u32 v110, v0, 5, 1
v_lshlrev_b32 v110, 3, v110
v_lshl_add_u32 v110, v109, 4, v110
v_bfe_u32 v111, v0, 3, 1
v_lshl_add_u32 v110, v111, 2, v110
v_bfe_u32 v112, v0, 2, 1
v_add_u32 v110, v110, v112
v_lshl_or_b32 v112, v109, 1, v111
v_lshlrev_b32 v110, 7, v110
v_and_b32 v109, 1, v0
v_lshl_add_u32 v110, v109, 3, v110
v_bfe_u32 v109, v0, 1, 1
v_lshl_add_u32 v110, v109, 4, v110
s_lshl_b32 s36, s32, 15
v_add_u32 v110, s36, v110
v_xor_b32 v109, 0, v112
v_lshl_add_u32 v108, v109, 5, v110
ds_read_b64_tr_b16 v[20:21], v108 offset:0
ds_read_b64_tr_b16 v[22:23], v108 offset:256
ds_read_b64_tr_b16 v[24:25], v108 offset:4096
ds_read_b64_tr_b16 v[26:27], v108 offset:4352
ds_read_b64_tr_b16 v[28:29], v108 offset:8192
ds_read_b64_tr_b16 v[30:31], v108 offset:8448
ds_read_b64_tr_b16 v[32:33], v108 offset:12288
ds_read_b64_tr_b16 v[34:35], v108 offset:12544
v_xor_b32 v109, 1, v112
v_lshl_add_u32 v108, v109, 5, v110
ds_read_b64_tr_b16 v[36:37], v108 offset:0
ds_read_b64_tr_b16 v[38:39], v108 offset:256
ds_read_b64_tr_b16 v[40:41], v108 offset:4096
ds_read_b64_tr_b16 v[42:43], v108 offset:4352
ds_read_b64_tr_b16 v[44:45], v108 offset:8192
ds_read_b64_tr_b16 v[46:47], v108 offset:8448
ds_read_b64_tr_b16 v[48:49], v108 offset:12288
ds_read_b64_tr_b16 v[50:51], v108 offset:12544
v_xor_b32 v109, 2, v112
v_lshl_add_u32 v108, v109, 5, v110
ds_read_b64_tr_b16 v[52:53], v108 offset:0
ds_read_b64_tr_b16 v[54:55], v108 offset:256
ds_read_b64_tr_b16 v[56:57], v108 offset:4096
ds_read_b64_tr_b16 v[58:59], v108 offset:4352
ds_read_b64_tr_b16 v[60:61], v108 offset:8192
ds_read_b64_tr_b16 v[62:63], v108 offset:8448
ds_read_b64_tr_b16 v[64:65], v108 offset:12288
ds_read_b64_tr_b16 v[66:67], v108 offset:12544
v_xor_b32 v109, 3, v112
v_lshl_add_u32 v108, v109, 5, v110
ds_read_b64_tr_b16 v[68:69], v108 offset:0
ds_read_b64_tr_b16 v[70:71], v108 offset:256
ds_read_b64_tr_b16 v[72:73], v108 offset:4096
ds_read_b64_tr_b16 v[74:75], v108 offset:4352
ds_read_b64_tr_b16 v[76:77], v108 offset:8192
ds_read_b64_tr_b16 v[78:79], v108 offset:8448
ds_read_b64_tr_b16 v[80:81], v108 offset:12288
ds_read_b64_tr_b16 v[82:83], v108 offset:12544
s_waitcnt lgkmcnt(0)
ds_write_b128 v9, v[128:131] offset:0
ds_write_b128 v9, v[132:135] offset:1024
ds_write_b128 v9, v[136:139] offset:2048
ds_write_b128 v9, v[140:143] offset:3072
ds_write_b128 v9, v[144:147] offset:4096
ds_write_b128 v9, v[148:151] offset:5120
ds_write_b128 v9, v[152:155] offset:6144
ds_write_b128 v9, v[156:159] offset:7168
ds_write_b128 v9, v[160:163] offset:8192
ds_write_b128 v9, v[164:167] offset:9216
ds_write_b128 v9, v[168:171] offset:10240
ds_write_b128 v9, v[172:175] offset:11264
ds_write_b128 v9, v[176:179] offset:12288
ds_write_b128 v9, v[180:183] offset:13312
ds_write_b128 v9, v[184:187] offset:14336
ds_write_b128 v9, v[188:191] offset:15360
v_mov_b64 v[128:129], v[20:21]
v_mov_b64 v[130:131], v[22:23]
v_mov_b64 v[132:133], v[24:25]
v_mov_b64 v[134:135], v[26:27]
v_mov_b64 v[136:137], v[28:29]
v_mov_b64 v[138:139], v[30:31]
v_mov_b64 v[140:141], v[32:33]
v_mov_b64 v[142:143], v[34:35]
v_mov_b64 v[144:145], v[36:37]
v_mov_b64 v[146:147], v[38:39]
v_mov_b64 v[148:149], v[40:41]
v_mov_b64 v[150:151], v[42:43]
v_mov_b64 v[152:153], v[44:45]
v_mov_b64 v[154:155], v[46:47]
v_mov_b64 v[156:157], v[48:49]
v_mov_b64 v[158:159], v[50:51]
v_mov_b64 v[160:161], v[52:53]
v_mov_b64 v[162:163], v[54:55]
v_mov_b64 v[164:165], v[56:57]
v_mov_b64 v[166:167], v[58:59]
v_mov_b64 v[168:169], v[60:61]
v_mov_b64 v[170:171], v[62:63]
v_mov_b64 v[172:173], v[64:65]
v_mov_b64 v[174:175], v[66:67]
v_mov_b64 v[176:177], v[68:69]
v_mov_b64 v[178:179], v[70:71]
v_mov_b64 v[180:181], v[72:73]
v_mov_b64 v[182:183], v[74:75]
v_mov_b64 v[184:185], v[76:77]
v_mov_b64 v[186:187], v[78:79]
v_mov_b64 v[188:189], v[80:81]
v_mov_b64 v[190:191], v[82:83]
v_xor_b32 v109, 0, v112
v_lshl_add_u32 v108, v109, 5, v110
ds_read_b64_tr_b16 v[20:21], v108 offset:16384
ds_read_b64_tr_b16 v[22:23], v108 offset:16640
ds_read_b64_tr_b16 v[24:25], v108 offset:20480
ds_read_b64_tr_b16 v[26:27], v108 offset:20736
ds_read_b64_tr_b16 v[28:29], v108 offset:24576
ds_read_b64_tr_b16 v[30:31], v108 offset:24832
ds_read_b64_tr_b16 v[32:33], v108 offset:28672
ds_read_b64_tr_b16 v[34:35], v108 offset:28928
v_xor_b32 v109, 1, v112
v_lshl_add_u32 v108, v109, 5, v110
ds_read_b64_tr_b16 v[36:37], v108 offset:16384
ds_read_b64_tr_b16 v[38:39], v108 offset:16640
ds_read_b64_tr_b16 v[40:41], v108 offset:20480
ds_read_b64_tr_b16 v[42:43], v108 offset:20736
ds_read_b64_tr_b16 v[44:45], v108 offset:24576
ds_read_b64_tr_b16 v[46:47], v108 offset:24832
ds_read_b64_tr_b16 v[48:49], v108 offset:28672
ds_read_b64_tr_b16 v[50:51], v108 offset:28928
v_xor_b32 v109, 2, v112
v_lshl_add_u32 v108, v109, 5, v110
ds_read_b64_tr_b16 v[52:53], v108 offset:16384
ds_read_b64_tr_b16 v[54:55], v108 offset:16640
ds_read_b64_tr_b16 v[56:57], v108 offset:20480
ds_read_b64_tr_b16 v[58:59], v108 offset:20736
ds_read_b64_tr_b16 v[60:61], v108 offset:24576
ds_read_b64_tr_b16 v[62:63], v108 offset:24832
ds_read_b64_tr_b16 v[64:65], v108 offset:28672
ds_read_b64_tr_b16 v[66:67], v108 offset:28928
v_xor_b32 v109, 3, v112
v_lshl_add_u32 v108, v109, 5, v110
ds_read_b64_tr_b16 v[68:69], v108 offset:16384
ds_read_b64_tr_b16 v[70:71], v108 offset:16640
ds_read_b64_tr_b16 v[72:73], v108 offset:20480
ds_read_b64_tr_b16 v[74:75], v108 offset:20736
ds_read_b64_tr_b16 v[76:77], v108 offset:24576
ds_read_b64_tr_b16 v[78:79], v108 offset:24832
ds_read_b64_tr_b16 v[80:81], v108 offset:28672
ds_read_b64_tr_b16 v[82:83], v108 offset:28928
s_waitcnt lgkmcnt(0)
ds_write_b128 v9, v[192:195] offset:16384
ds_write_b128 v9, v[196:199] offset:17408
ds_write_b128 v9, v[200:203] offset:18432
ds_write_b128 v9, v[204:207] offset:19456
ds_write_b128 v9, v[208:211] offset:20480
ds_write_b128 v9, v[212:215] offset:21504
ds_write_b128 v9, v[216:219] offset:22528
ds_write_b128 v9, v[220:223] offset:23552
ds_write_b128 v9, v[224:227] offset:24576
ds_write_b128 v9, v[228:231] offset:25600
ds_write_b128 v9, v[232:235] offset:26624
ds_write_b128 v9, v[236:239] offset:27648
ds_write_b128 v9, v[240:243] offset:28672
ds_write_b128 v9, v[244:247] offset:29696
ds_write_b128 v9, v[248:251] offset:30720
ds_write_b128 v9, v[252:255] offset:31744
v_mov_b64 v[192:193], v[20:21]
v_mov_b64 v[194:195], v[22:23]
v_mov_b64 v[196:197], v[24:25]
v_mov_b64 v[198:199], v[26:27]
v_mov_b64 v[200:201], v[28:29]
v_mov_b64 v[202:203], v[30:31]
v_mov_b64 v[204:205], v[32:33]
v_mov_b64 v[206:207], v[34:35]
v_mov_b64 v[208:209], v[36:37]
v_mov_b64 v[210:211], v[38:39]
v_mov_b64 v[212:213], v[40:41]
v_mov_b64 v[214:215], v[42:43]
v_mov_b64 v[216:217], v[44:45]
v_mov_b64 v[218:219], v[46:47]
v_mov_b64 v[220:221], v[48:49]
v_mov_b64 v[222:223], v[50:51]
v_mov_b64 v[224:225], v[52:53]
v_mov_b64 v[226:227], v[54:55]
v_mov_b64 v[228:229], v[56:57]
v_mov_b64 v[230:231], v[58:59]
v_mov_b64 v[232:233], v[60:61]
v_mov_b64 v[234:235], v[62:63]
v_mov_b64 v[236:237], v[64:65]
v_mov_b64 v[238:239], v[66:67]
v_mov_b64 v[240:241], v[68:69]
v_mov_b64 v[242:243], v[70:71]
v_mov_b64 v[244:245], v[72:73]
v_mov_b64 v[246:247], v[74:75]
v_mov_b64 v[248:249], v[76:77]
v_mov_b64 v[250:251], v[78:79]
v_mov_b64 v[252:253], v[80:81]
v_mov_b64 v[254:255], v[82:83]
v_mov_b32 v124, s64
s_mov_b32 s98, 0
L_poll_23:
global_load_dword v125, v124, s[62:63] offset:0 sc1
s_waitcnt vmcnt(0)
v_cmp_gt_u32 vcc, 1, v125
s_cbranch_vccz L_polld_24
s_add_u32 s98, s98, 1
s_cmp_lt_u32 s98, 200000
s_cbranch_scc1 L_poll_23
s_mov_b32 s99, 23
s_branch L_fail
L_polld_24:
global_load_dwordx4 v[60:63], v6, s[50:51] offset:0 sc1
global_load_dwordx4 v[64:67], v6, s[50:51] offset:1024 sc1
v_mov_b32 v14, 0
s_cmp_eq_u32 s32, 3
s_cbranch_scc0 L_rec_i2
v_mov_b32 v124, 20480
s_mov_b32 s98, 0
L_poll_25:
global_load_dword v125, v124, s[62:63] offset:0 sc1
s_waitcnt vmcnt(0)
v_cmp_gt_u32 vcc, 32, v125
s_cbranch_vccz L_polld_26
s_add_u32 s98, s98, 1
s_cmp_lt_u32 s98, 200000
s_cbranch_scc1 L_poll_25
s_mov_b32 s99, 24
s_branch L_fail
L_polld_26:
s_waitcnt vmcnt(0)
v_lshl_or_b32 v95, v96, 16, v95
v_min_u32 v95, 0xfffffffe, v95
global_store_dword v92, v95, s[44:45]
L_rec_i2:
s_mov_b32 s42, 0
s_lshl_b32 s36, s41, 2
s_add_u32 s36, s36, s32
s_lshl_b32 s36, s36, 11
s_add_u32 s36, s36, 78643200
s_add_u32 s100, s30, s36
s_addc_u32 s101, s31, 0
s_lshl_b32 s36, s32, 11
v_add_u32 v0, s36, v6
s_add_u32 s4, s56, 16384
s_addc_u32 s5, s57, 0
s_add_u32 s6, s56, 32768
s_addc_u32 s7, s57, 0
s_add_u32 s8, s56, 49152
s_addc_u32 s9, s57, 0
s_waitcnt lgkmcnt(0)
s_barrier
v_mov_b64 v[108:109], 0
v_mov_b64 v[110:111], 0
v_mov_b64 v[112:113], 0
v_mov_b64 v[114:115], 0
v_mov_b64 v[116:117], 0
v_mov_b64 v[118:119], 0
v_mov_b64 v[120:121], 0
v_mov_b64 v[122:123], 0
v_xor_b32 v125, 6144, v7
v_xor_b32 v126, 4096, v7
v_xor_b32 v127, 2048, v7
ds_read_b128 v[76:79], v9 offset:0
ds_read_b128 v[80:83], v9 offset:1024
ds_read_b128 v[84:87], v9 offset:2048
ds_read_b128 v[88:91], v9 offset:3072
ds_read_b128 v[92:95], v9 offset:4096
ds_read_b128 v[96:99], v9 offset:5120
ds_read_b128 v[100:103], v9 offset:6144
ds_read_b128 v[104:107], v9 offset:7168
s_waitcnt lgkmcnt(0)
L_rec_loop:
s_mov_b32 s98, 0
global_load_dwordx4 v[44:47], v0, s[44:45] nt
global_load_dwordx4 v[48:51], v0, s[44:45] offset:1024 nt
s_waitcnt vmcnt(2)
L_g_27:
global_load_dwordx4 v[52:55], v0, s[44:45] nt
global_load_dwordx4 v[56:59], v0, s[44:45] offset:1024 nt
s_waitcnt vmcnt(3)
ds_write_b128 v7, v[44:47]
v_max3_u32 v124, v44, v45, v46
s_waitcnt vmcnt(2)
ds_write_b128 v7, v[48:51] offset:1024
v_max3_u32 v124, v124, v47, v48
v_max3_u32 v124, v124, v49, v50
v_max_u32 v124, v124, v51
v_cmp_eq_u32 vcc, -1, v124
s_cbranch_vccz L_gd_28
global_load_dwordx4 v[44:47], v0, s[44:45] nt
global_load_dwordx4 v[48:51], v0, s[44:45] offset:1024 nt
s_waitcnt vmcnt(3)
ds_write_b128 v7, v[52:55]
v_max3_u32 v124, v52, v53, v54
s_waitcnt vmcnt(2)
ds_write_b128 v7, v[56:59] offset:1024
v_max3_u32 v124, v124, v55, v56
v_max3_u32 v124, v124, v57, v58
v_max_u32 v124, v124, v59
v_cmp_eq_u32 vcc, -1, v124
s_cbranch_vccz L_gc_29
s_add_u32 s98, s98, 1
s_cmp_lt_u32 s98, 200000
s_cbranch_scc1 L_g_27
s_mov_b32 s99, 20
s_branch L_fail
L_gc_29:
v_mov_b64 v[44:45], v[52:53]
v_mov_b64 v[46:47], v[54:55]
v_mov_b64 v[48:49], v[56:57]
v_mov_b64 v[50:51], v[58:59]
L_gd_28:
v_smfmac_f32_16x16x64_bf16 v[108:111], v[44:47], a[32:39], v1
v_smfmac_f32_16x16x64_bf16 v[112:115], v[44:47], a[80:87], v1
v_smfmac_f32_16x16x64_bf16 v[108:111], v[48:51], a[40:47], v1
v_smfmac_f32_16x16x64_bf16 v[112:115], v[48:51], a[88:95], v1
s_waitcnt lgkmcnt(0)
s_barrier
ds_read_b128 v[20:23], v125 offset:0
ds_read_b128 v[24:27], v125 offset:1024
ds_read_b128 v[28:31], v126 offset:0
ds_read_b128 v[32:35], v126 offset:1024
ds_read_b128 v[36:39], v127 offset:0
ds_read_b128 v[40:43], v127 offset:1024
v_mov_b32 v124, -1
v_add_u32 v15, 1, v15
v_readfirstlane_b32 s82, v14
s_add_u32 s83, s42, 3
s_lshr_b32 s83, s83, 1
s_cmp_ge_u32 s82, s83
s_cbranch_scc1 L_kd_31
s_mov_b32 s98, 0
L_k_30:
global_load_dword v14, v17, s[76:77] sc1
s_waitcnt vmcnt(0)
v_readfirstlane_b32 s82, v14
s_cmp_ge_u32 s82, s83
s_cbranch_scc1 L_kd_31
s_add_u32 s98, s98, 1
s_cmp_lt_u32 s98, 200000
s_cbranch_scc1 L_k_30
s_mov_b32 s99, 21
s_branch L_fail
L_kd_31:
v_smfmac_f32_16x16x64_bf16 v[116:119], v[44:47], a[128:135], v1
global_store_dword v13, v124, s[48:49]
v_smfmac_f32_16x16x64_bf16 v[120:123], v[44:47], a[176:183], v1
global_store_dword v17, v15, s[78:79] sc1
v_smfmac_f32_16x16x64_bf16 v[116:119], v[48:51], a[136:143], v1
v_smfmac_f32_16x16x64_bf16 v[120:123], v[48:51], a[184:191], v1
s_waitcnt lgkmcnt(5)
v_smfmac_f32_16x16x64_bf16 v[108:111], v[20:23], v[76:83], v1
ds_read_b128 v[76:79], v9 offset:8192
ds_read_b128 v[80:83], v9 offset:9216
v_smfmac_f32_16x16x64_bf16 v[112:115], v[20:23], v[84:91], v1
ds_read_b128 v[84:87], v9 offset:10240
ds_read_b128 v[88:91], v9 offset:11264
s_waitcnt lgkmcnt(8)
v_smfmac_f32_16x16x64_bf16 v[108:111], v[24:27], v[92:99], v1
ds_read_b128 v[92:95], v9 offset:12288
ds_read_b128 v[96:99], v9 offset:13312
v_smfmac_f32_16x16x64_bf16 v[112:115], v[24:27], v[100:107], v1
ds_read_b128 v[100:103], v9 offset:14336
ds_read_b128 v[104:107], v9 offset:15360
s_waitcnt lgkmcnt(11)
v_smfmac_f32_16x16x64_bf16 v[108:111], v[28:31], a[0:7], v1
v_smfmac_f32_16x16x64_bf16 v[112:115], v[28:31], a[48:55], v1
global_load_dwordx4 v[68:71], v6, s[50:51] offset:2048 sc1
s_waitcnt lgkmcnt(10)
v_smfmac_f32_16x16x64_bf16 v[108:111], v[32:35], a[8:15], v1
v_smfmac_f32_16x16x64_bf16 v[112:115], v[32:35], a[56:63], v1
global_load_dwordx4 v[72:75], v6, s[50:51] offset:3072 sc1
s_waitcnt lgkmcnt(9)
v_smfmac_f32_16x16x64_bf16 v[108:111], v[36:39], a[16:23], v1
v_smfmac_f32_16x16x64_bf16 v[112:115], v[36:39], a[64:71], v1
global_load_dword v14, v17, s[74:75] sc1
s_waitcnt lgkmcnt(8)
v_smfmac_f32_16x16x64_bf16 v[108:111], v[40:43], a[24:31], v1
v_smfmac_f32_16x16x64_bf16 v[112:115], v[40:43], a[72:79], v1
s_add_u32 s50, s50, 524288
s_addc_u32 s51, s51, 0
s_waitcnt lgkmcnt(0)
s_waitcnt vmcnt(5)
ds_read_b128 v[52:55], v8 offset:26624
ds_read_b128 v[56:59], v8 offset:26624
v_smfmac_f32_16x16x64_bf16 v[116:119], v[20:23], v[76:83], v1
ds_read_b128 v[76:79], v9 offset:16384
ds_read_b128 v[80:83], v9 offset:17408
v_smfmac_f32_16x16x64_bf16 v[120:123], v[20:23], v[84:91], v1
ds_read_b128 v[84:87], v9 offset:18432
ds_read_b128 v[88:91], v9 offset:19456
v_pk_add_f32 v[108:109], v[108:109], v[110:111]
v_pk_add_f32 v[112:113], v[112:113], v[114:115]
v_cvt_pk_bf16_f32 v124, v108, v109
v_cvt_pk_bf16_f32 v125, v112, v113
v_smfmac_f32_16x16x64_bf16 v[116:119], v[24:27], v[92:99], v1
ds_read_b128 v[92:95], v9 offset:20480
ds_read_b128 v[96:99], v9 offset:21504
v_mfma_f32_16x16x16_bf16 v[108:111], v[124:125], v[2:3], 0
v_mfma_f32_16x16x16_bf16 v[112:115], v[124:125], v[4:5], 0
v_smfmac_f32_16x16x64_bf16 v[120:123], v[24:27], v[100:107], v1
ds_read_b128 v[100:103], v9 offset:22528
ds_read_b128 v[104:107], v9 offset:23552
v_smfmac_f32_16x16x64_bf16 v[116:119], v[28:31], a[96:103], v1
v_cvt_pk_bf16_f32 v124, v108, v109
v_cvt_pk_bf16_f32 v125, v110, v111
v_cvt_pk_bf16_f32 v126, v112, v113
v_cvt_pk_bf16_f32 v127, v114, v115
v_smfmac_f32_16x16x64_bf16 v[120:123], v[28:31], a[144:151], v1
s_nop 0
v_mfma_f32_16x16x32_bf16 v[108:111], v[60:63], v[124:127], 0
v_mfma_f32_16x16x32_bf16 v[112:115], v[64:67], v[124:127], 0
v_smfmac_f32_16x16x64_bf16 v[116:119], v[32:35], a[104:111], v1
global_load_dwordx4 v[60:63], v6, s[50:51] sc1
global_load_dwordx4 v[64:67], v6, s[50:51] offset:1024 sc1
v_smfmac_f32_16x16x64_bf16 v[120:123], v[32:35], a[152:159], v1
s_mov_b64 exec, s[58:59]
ds_write_b128 v7, v[108:111] offset:8192
s_mov_b64 exec, s[60:61]
ds_write_b128 v7, v[112:115] offset:8192
s_mov_b64 exec, -1
v_smfmac_f32_16x16x64_bf16 v[116:119], v[36:39], a[112:119], v1
v_smfmac_f32_16x16x64_bf16 v[120:123], v[36:39], a[160:167], v1
v_smfmac_f32_16x16x64_bf16 v[116:119], v[40:43], a[120:127], v1
v_smfmac_f32_16x16x64_bf16 v[120:123], v[40:43], a[168:175], v1
s_waitcnt lgkmcnt(6)
v_smfmac_f32_16x16x64_bf16 v[52:55], v[20:23], v[76:83], v1
ds_read_b128 v[76:79], v9 offset:24576
ds_read_b128 v[80:83], v9 offset:25600
v_smfmac_f32_16x16x64_bf16 v[56:59], v[20:23], v[84:91], v1
ds_read_b128 v[84:87], v9 offset:26624
ds_read_b128 v[88:91], v9 offset:27648
v_pk_add_f32 v[116:117], v[116:117], v[118:119]
v_pk_add_f32 v[120:121], v[120:121], v[122:123]
v_cvt_pk_bf16_f32 v118, v116, v117
v_cvt_pk_bf16_f32 v119, v120, v121
s_waitcnt lgkmcnt(6)
v_smfmac_f32_16x16x64_bf16 v[52:55], v[24:27], v[92:99], v1
ds_read_b128 v[92:95], v9 offset:28672
ds_read_b128 v[96:99], v9 offset:29696
v_mfma_f32_16x16x16_bf16 v[120:123], v[118:119], v[2:3], 0
v_mfma_f32_16x16x16_bf16 v[112:115], v[118:119], v[4:5], 0
v_smfmac_f32_16x16x64_bf16 v[56:59], v[24:27], v[100:107], v1
ds_read_b128 v[100:103], v9 offset:30720
ds_read_b128 v[104:107], v9 offset:31744
s_waitcnt lgkmcnt(6)
v_smfmac_f32_16x16x64_bf16 v[52:55], v[28:31], v[76:83], v1
v_cvt_pk_bf16_f32 v108, v120, v121
v_cvt_pk_bf16_f32 v109, v122, v123
v_cvt_pk_bf16_f32 v110, v112, v113
v_cvt_pk_bf16_f32 v111, v114, v115
s_waitcnt lgkmcnt(4)
v_smfmac_f32_16x16x64_bf16 v[56:59], v[28:31], v[84:91], v1
v_mfma_f32_16x16x32_bf16 v[112:115], v[108:111], v[124:127], 0
global_store_dwordx4 v6, v[108:111], s[52:53] sc1
s_waitcnt lgkmcnt(0)
v_smfmac_f32_16x16x64_bf16 v[52:55], v[32:35], v[92:99], v1
v_smfmac_f32_16x16x64_bf16 v[56:59], v[32:35], v[100:107], v1
ds_write_b64 v7, v[112:113] offset:9216
v_smfmac_f32_16x16x64_bf16 v[52:55], v[36:39], a[192:199], v1
v_smfmac_f32_16x16x64_bf16 v[56:59], v[36:39], a[224:231], v1
s_waitcnt lgkmcnt(0)
s_barrier
ds_read_b128 v[20:23], v8 offset:8192
ds_read_b64 v[116:117], v8 offset:9216
ds_read_b128 v[24:27], v8 offset:10240
ds_read_b64 v[118:119], v8 offset:11264
v_smfmac_f32_16x16x64_bf16 v[52:55], v[40:43], a[200:207], v1
ds_read_b128 v[28:31], v8 offset:12288
ds_read_b64 v[120:121], v8 offset:13312
v_smfmac_f32_16x16x64_bf16 v[56:59], v[40:43], a[232:239], v1
ds_read_b128 v[32:35], v8 offset:14336
ds_read_b64 v[122:123], v8 offset:15360
v_smfmac_f32_16x16x64_bf16 v[52:55], v[44:47], a[208:215], v1
ds_read_b128 v[108:111], v8 offset:25600
v_smfmac_f32_16x16x64_bf16 v[56:59], v[44:47], a[240:247], v1
v_smfmac_f32_16x16x64_bf16 v[52:55], v[48:51], a[216:223], v1
v_smfmac_f32_16x16x64_bf16 v[56:59], v[48:51], a[248:255], v1
s_waitcnt lgkmcnt(5)
v_pk_add_f32 v[20:21], v[20:21], v[24:25]
v_pk_add_f32 v[22:23], v[22:23], v[26:27]
v_pk_add_f32 v[116:117], v[116:117], v[118:119]
s_waitcnt lgkmcnt(1)
v_pk_add_f32 v[28:29], v[28:29], v[32:33]
v_pk_add_f32 v[120:121], v[120:121], v[122:123]
v_pk_add_f32 v[30:31], v[30:31], v[34:35]
v_pk_add_f32 v[116:117], v[116:117], v[120:121]
v_pk_add_f32 v[20:21], v[20:21], v[28:29]
v_pk_add_f32 v[22:23], v[22:23], v[30:31]
v_max3_f32 v24, v20, v21, v116
v_max3_f32 v25, v22, v23, v117
v_max_f32 v24, v24, v25
v_pk_add_f32 v[52:53], v[52:53], v[54:55]
v_pk_add_f32 v[56:57], v[56:57], v[58:59]
v_max_f32_dpp v24, v24, v24 quad_perm:[2,3,0,1] row_mask:0xf bank_mask:0xf
v_mov_b32 v25, v24
v_cvt_pk_bf16_f32 v54, v52, v53
v_cvt_pk_bf16_f32 v55, v56, v57
v_permlane16_swap_b32 v24, v25
v_max_f32 v24, v24, v25
v_mov_b32 v25, v24
global_store_dwordx2 v6, v[54:55], s[52:53] offset:1024 sc1
s_add_u32 s52, s52, 262144
s_addc_u32 s53, s53, 0
v_permlane32_swap_b32 v24, v25
v_max_f32 v24, v24, v25
v_mul_f32 v24, s70, v24
v_pk_fma_f32 v[20:21], v[20:21], s[70:71], v[24:25] op_sel_hi:[1,1,0] neg_lo:[0,0,1] neg_hi:[0,0,1]
v_pk_fma_f32 v[22:23], v[22:23], s[70:71], v[24:25] op_sel_hi:[1,1,0] neg_lo:[0,0,1] neg_hi:[0,0,1]
v_pk_fma_f32 v[116:117], v[116:117], s[70:71], v[24:25] op_sel_hi:[1,1,0] neg_lo:[0,0,1] neg_hi:[0,0,1]
v_exp_f32 v20, v20
v_exp_f32 v21, v21
v_exp_f32 v22, v22
v_exp_f32 v23, v23
v_exp_f32 v116, v116
v_exp_f32 v117, v117
v_cvt_pk_bf16_f32 v120, v20, v21
v_cvt_pk_bf16_f32 v121, v22, v23
v_cvt_pk_bf16_f32 v16, v116, v117
v_cvt_pk_bf16_f32 v19, v116, v117
v_mov_b32_dpp v122, v120 quad_perm:[2,3,0,1] row_mask:0xf bank_mask:0xf
v_mov_b32_dpp v123, v121 quad_perm:[2,3,0,1] row_mask:0xf bank_mask:0xf
s_waitcnt lgkmcnt(0)
s_nop 0
v_mfma_f32_16x16x32_bf16 v[24:27], v[108:111], v[120:123], 0
ds_read_b128 v[76:79], v8 offset:26624
ds_read_b128 v[80:83], v8 offset:26624
s_waitcnt vmcnt(5)
v_mfma_f32_16x16x32_bf16 v[112:115], v[68:71], v[120:123], 0
ds_read_b128 v[84:87], v8 offset:26624
ds_read_b128 v[88:91], v8 offset:26624
v_mfma_f32_16x16x32_bf16 v[116:119], v[72:75], v[120:123], 0
ds_read_b128 v[92:95], v8 offset:26624
ds_read_b128 v[96:99], v8 offset:26624
v_mfma_f32_16x16x16_bf16 v[24:27], v[108:109], v[16:17], v[24:27]
ds_read_b128 v[100:103], v8 offset:26624
ds_read_b128 v[104:107], v8 offset:26624
v_mfma_f32_16x16x16_bf16 v[112:115], v[54:55], v[16:17], v[112:115]
v_mfma_f32_16x16x16_bf16 v[116:119], v[54:55], v[18:19], v[116:119]
v_rcp_f32 v24, v24
s_nop 2
v_pk_mul_f32 v[112:113], v[112:113], v[24:25] op_sel_hi:[1,0]
v_pk_mul_f32 v[114:115], v[114:115], v[24:25] op_sel_hi:[1,0]
v_cvt_pk_bf16_f32 v120, v112, v113
v_cvt_pk_bf16_f32 v121, v114, v115
v_pk_mul_f32 v[116:117], v[116:117], v[24:25] op_sel_hi:[1,0]
v_pk_mul_f32 v[118:119], v[118:119], v[24:25] op_sel_hi:[1,0]
v_cvt_pk_bf16_f32 v122, v116, v117
v_cvt_pk_bf16_f32 v123, v118, v119
ds_write_b128 v10, v[120:123]
s_waitcnt lgkmcnt(0)
s_barrier
ds_read_b128 v[108:111], v11
ds_read_b128 v[112:115], v11 offset:128
ds_read_b128 v[28:31], v8 offset:24576
s_waitcnt lgkmcnt(2)
v_smfmac_f32_16x16x64_bf16 v[76:79], v[108:111], v[128:135], v1
v_smfmac_f32_16x16x64_bf16 v[80:83], v[108:111], v[144:151], v1
v_smfmac_f32_16x16x64_bf16 v[84:87], v[108:111], v[160:167], v1
v_smfmac_f32_16x16x64_bf16 v[88:91], v[108:111], v[176:183], v1
s_waitcnt lgkmcnt(1)
v_smfmac_f32_16x16x64_bf16 v[76:79], v[112:115], v[136:143], v1
v_smfmac_f32_16x16x64_bf16 v[80:83], v[112:115], v[152:159], v1
v_smfmac_f32_16x16x64_bf16 v[84:87], v[112:115], v[168:175], v1
v_smfmac_f32_16x16x64_bf16 v[88:91], v[112:115], v[184:191], v1
v_smfmac_f32_16x16x64_bf16 v[92:95], v[108:111], v[192:199], v1
v_smfmac_f32_16x16x64_bf16 v[96:99], v[108:111], v[208:215], v1
v_pk_add_f32 v[76:77], v[76:77], v[78:79]
v_pk_add_f32 v[80:81], v[80:81], v[82:83]
v_cvt_pk_bf16_f32 v76, v76, v77
v_cvt_pk_bf16_f32 v77, v80, v81
v_and_b32 v76, 0xfffffffe, v76
global_store_dwordx2 v12, v[76:77], s[56:57]
v_smfmac_f32_16x16x64_bf16 v[92:95], v[112:115], v[200:207], v1
v_smfmac_f32_16x16x64_bf16 v[96:99], v[112:115], v[216:223], v1
v_pk_add_f32 v[84:85], v[84:85], v[86:87]
v_pk_add_f32 v[88:89], v[88:89], v[90:91]
v_cvt_pk_bf16_f32 v84, v84, v85
v_cvt_pk_bf16_f32 v85, v88, v89
v_and_b32 v84, 0xfffffffe, v84
global_store_dwordx2 v12, v[84:85], s[4:5]
v_smfmac_f32_16x16x64_bf16 v[100:103], v[108:111], v[224:231], v1
v_smfmac_f32_16x16x64_bf16 v[104:107], v[108:111], v[240:247], v1
v_smfmac_f32_16x16x64_bf16 v[100:103], v[112:115], v[232:239], v1
v_smfmac_f32_16x16x64_bf16 v[104:107], v[112:115], v[248:255], v1
v_pk_add_f32 v[92:93], v[92:93], v[94:95]
v_pk_add_f32 v[96:97], v[96:97], v[98:99]
v_cvt_pk_bf16_f32 v92, v92, v93
v_cvt_pk_bf16_f32 v93, v96, v97
v_and_b32 v92, 0xfffffffe, v92
global_store_dwordx2 v12, v[92:93], s[6:7]
v_pk_add_f32 v[100:101], v[100:101], v[102:103]
s_nop 0
v_pk_add_f32 v[104:105], v[104:105], v[106:107]
v_cvt_pk_bf16_f32 v100, v100, v101
v_cvt_pk_bf16_f32 v101, v104, v105
v_and_b32 v100, 0xfffffffe, v100
global_store_dwordx2 v12, v[100:101], s[8:9]
v_mov_b64 v[108:109], 0
v_mov_b64 v[110:111], 0
v_mov_b64 v[112:113], 0
v_mov_b64 v[114:115], 0
v_mov_b64 v[116:117], 0
v_mov_b64 v[118:119], 0
v_mov_b64 v[120:121], 0
v_mov_b64 v[122:123], 0
v_xor_b32 v125, 6144, v7
v_xor_b32 v126, 4096, v7
v_xor_b32 v127, 2048, v7
ds_read_b128 v[76:79], v9 offset:0
ds_read_b128 v[80:83], v9 offset:1024
ds_read_b128 v[84:87], v9 offset:2048
ds_read_b128 v[88:91], v9 offset:3072
s_waitcnt lgkmcnt(0)
s_mov_b32 s98, 0
global_load_dwordx4 v[20:23], v0, s[54:55] nt
global_load_dwordx4 v[24:27], v0, s[54:55] offset:1024 nt
s_waitcnt vmcnt(2)
L_r_32:
global_load_dwordx4 v[40:43], v0, s[54:55] nt
global_load_dwordx4 v[44:47], v0, s[54:55] offset:1024 nt
s_waitcnt vmcnt(3)
v_mfma_f32_16x16x32_bf16 v[32:35], v[28:31], v[20:23], 0
v_or_b32 v124, v20, v22
s_waitcnt vmcnt(2)
v_mfma_f32_16x16x32_bf16 v[32:35], v[28:31], v[24:27], v[32:35]
v_or3_b32 v124, v124, v24, v26
v_and_b32 v124, 1, v124
v_cmp_ne_u32 vcc, 0, v124
s_cbranch_vccz L_rd_33
global_load_dwordx4 v[20:23], v0, s[54:55] nt
global_load_dwordx4 v[24:27], v0, s[54:55] offset:1024 nt
s_waitcnt vmcnt(3)
v_mfma_f32_16x16x32_bf16 v[32:35], v[28:31], v[40:43], 0
v_or_b32 v124, v40, v42
s_waitcnt vmcnt(2)
v_mfma_f32_16x16x32_bf16 v[32:35], v[28:31], v[44:47], v[32:35]
v_or3_b32 v124, v124, v44, v46
v_and_b32 v124, 1, v124
v_cmp_ne_u32 vcc, 0, v124
s_cbranch_vccz L_rd_33
s_add_u32 s98, s98, 1
s_cmp_lt_u32 s98, 200000
s_cbranch_scc1 L_r_32
s_mov_b32 s99, 22
s_branch L_fail
L_rd_33:
s_nop 3
v_add_f32_dpp v32, v32, v32 row_ror:4 row_mask:0xf bank_mask:0xf
v_add_f32_dpp v33, v33, v33 row_ror:4 row_mask:0xf bank_mask:0xf
s_nop 0
v_add_f32_dpp v32, v32, v32 row_ror:8 row_mask:0xf bank_mask:0xf
v_add_f32_dpp v33, v33, v33 row_ror:8 row_mask:0xf bank_mask:0xf
v_cvt_pk_bf16_f32 v32, v32, v33
v_min_u32 v32, 0xfffffffe, v32
global_store_dword v13, v32, s[46:47]
ds_read_b128 v[92:95], v9 offset:4096
ds_read_b128 v[96:99], v9 offset:5120
ds_read_b128 v[100:103], v9 offset:6144
ds_read_b128 v[104:107], v9 offset:7168
s_mov_b64 s[72:73], s[44:45]
s_mov_b64 s[44:45], s[46:47]
s_mov_b64 s[46:47], s[48:49]
s_mov_b64 s[48:49], s[72:73]
s_add_u32 s42, s42, 1
s_waitcnt lgkmcnt(0)
s_cmp_eq_u32 s42, 63
s_cbranch_scc1 L_rec_tail
s_mov_b32 s98, 0
global_load_dwordx4 v[44:47], v0, s[44:45] nt
global_load_dwordx4 v[48:51], v0, s[44:45] offset:1024 nt
s_waitcnt vmcnt(2)
L_g_34:
global_load_dwordx4 v[52:55], v0, s[44:45] nt
global_load_dwordx4 v[56:59], v0, s[44:45] offset:1024 nt
s_waitcnt vmcnt(3)
ds_write_b128 v7, v[44:47]
v_max3_u32 v124, v44, v45, v46
s_waitcnt vmcnt(2)
ds_write_b128 v7, v[48:51] offset:1024
v_max3_u32 v124, v124, v47, v48
v_max3_u32 v124, v124, v49, v50
v_max_u32 v124, v124, v51
v_cmp_eq_u32 vcc, -1, v124
s_cbranch_vccz L_gd_35
global_load_dwordx4 v[44:47], v0, s[44:45] nt
global_load_dwordx4 v[48:51], v0, s[44:45] offset:1024 nt
s_waitcnt vmcnt(3)
ds_write_b128 v7, v[52:55]
v_max3_u32 v124, v52, v53, v54
s_waitcnt vmcnt(2)
ds_write_b128 v7, v[56:59] offset:1024
v_max3_u32 v124, v124, v55, v56
v_max3_u32 v124, v124, v57, v58
v_max_u32 v124, v124, v59
v_cmp_eq_u32 vcc, -1, v124
s_cbranch_vccz L_gc_36
s_add_u32 s98, s98, 1
s_cmp_lt_u32 s98, 200000
s_cbranch_scc1 L_g_34
s_mov_b32 s99, 20
s_branch L_fail
L_gc_36:
v_mov_b64 v[44:45], v[52:53]
v_mov_b64 v[46:47], v[54:55]
v_mov_b64 v[48:49], v[56:57]
v_mov_b64 v[50:51], v[58:59]
L_gd_35:
v_smfmac_f32_16x16x64_bf16 v[108:111], v[44:47], a[32:39], v1
v_smfmac_f32_16x16x64_bf16 v[112:115], v[44:47], a[80:87], v1
v_smfmac_f32_16x16x64_bf16 v[108:111], v[48:51], a[40:47], v1
v_smfmac_f32_16x16x64_bf16 v[112:115], v[48:51], a[88:95], v1
s_waitcnt lgkmcnt(0)
s_barrier
ds_read_b128 v[20:23], v125 offset:0
ds_read_b128 v[24:27], v125 offset:1024
ds_read_b128 v[28:31], v126 offset:0
ds_read_b128 v[32:35], v126 offset:1024
ds_read_b128 v[36:39], v127 offset:0
ds_read_b128 v[40:43], v127 offset:1024
v_mov_b32 v124, -1
v_add_u32 v15, 1, v15
v_readfirstlane_b32 s82, v14
s_add_u32 s83, s42, 3
s_lshr_b32 s83, s83, 1
s_cmp_ge_u32 s82, s83
s_cbranch_scc1 L_kd_38
s_mov_b32 s98, 0
L_k_37:
global_load_dword v14, v17, s[74:75] sc1
s_waitcnt vmcnt(0)
v_readfirstlane_b32 s82, v14
s_cmp_ge_u32 s82, s83
s_cbranch_scc1 L_kd_38
s_add_u32 s98, s98, 1
s_cmp_lt_u32 s98, 200000
s_cbranch_scc1 L_k_37
s_mov_b32 s99, 21
s_branch L_fail
L_kd_38:
v_smfmac_f32_16x16x64_bf16 v[116:119], v[44:47], a[128:135], v1
global_store_dword v13, v124, s[48:49]
v_smfmac_f32_16x16x64_bf16 v[120:123], v[44:47], a[176:183], v1
global_store_dword v17, v15, s[78:79] sc1
v_smfmac_f32_16x16x64_bf16 v[116:119], v[48:51], a[136:143], v1
v_smfmac_f32_16x16x64_bf16 v[120:123], v[48:51], a[184:191], v1
s_waitcnt lgkmcnt(5)
v_smfmac_f32_16x16x64_bf16 v[108:111], v[20:23], v[76:83], v1
ds_read_b128 v[76:79], v9 offset:8192
ds_read_b128 v[80:83], v9 offset:9216
v_smfmac_f32_16x16x64_bf16 v[112:115], v[20:23], v[84:91], v1
ds_read_b128 v[84:87], v9 offset:10240
ds_read_b128 v[88:91], v9 offset:11264
s_waitcnt lgkmcnt(8)
v_smfmac_f32_16x16x64_bf16 v[108:111], v[24:27], v[92:99], v1
ds_read_b128 v[92:95], v9 offset:12288
ds_read_b128 v[96:99], v9 offset:13312
v_smfmac_f32_16x16x64_bf16 v[112:115], v[24:27], v[100:107], v1
ds_read_b128 v[100:103], v9 offset:14336
ds_read_b128 v[104:107], v9 offset:15360
s_waitcnt lgkmcnt(11)
v_smfmac_f32_16x16x64_bf16 v[108:111], v[28:31], a[0:7], v1
v_smfmac_f32_16x16x64_bf16 v[112:115], v[28:31], a[48:55], v1
global_load_dwordx4 v[68:71], v6, s[50:51] offset:2048 sc1
s_waitcnt lgkmcnt(10)
v_smfmac_f32_16x16x64_bf16 v[108:111], v[32:35], a[8:15], v1
v_smfmac_f32_16x16x64_bf16 v[112:115], v[32:35], a[56:63], v1
global_load_dwordx4 v[72:75], v6, s[50:51] offset:3072 sc1
s_waitcnt lgkmcnt(9)
v_smfmac_f32_16x16x64_bf16 v[108:111], v[36:39], a[16:23], v1
v_smfmac_f32_16x16x64_bf16 v[112:115], v[36:39], a[64:71], v1
global_load_dword v14, v17, s[76:77] sc1
s_waitcnt lgkmcnt(8)
v_smfmac_f32_16x16x64_bf16 v[108:111], v[40:43], a[24:31], v1
v_smfmac_f32_16x16x64_bf16 v[112:115], v[40:43], a[72:79], v1
s_add_u32 s50, s50, 524288
s_addc_u32 s51, s51, 0
s_waitcnt lgkmcnt(0)
s_waitcnt vmcnt(5)
ds_read_b128 v[52:55], v8 offset:26624
ds_read_b128 v[56:59], v8 offset:26624
v_smfmac_f32_16x16x64_bf16 v[116:119], v[20:23], v[76:83], v1
ds_read_b128 v[76:79], v9 offset:16384
ds_read_b128 v[80:83], v9 offset:17408
v_smfmac_f32_16x16x64_bf16 v[120:123], v[20:23], v[84:91], v1
ds_read_b128 v[84:87], v9 offset:18432
ds_read_b128 v[88:91], v9 offset:19456
v_pk_add_f32 v[108:109], v[108:109], v[110:111]
v_pk_add_f32 v[112:113], v[112:113], v[114:115]
v_cvt_pk_bf16_f32 v124, v108, v109
v_cvt_pk_bf16_f32 v125, v112, v113
v_smfmac_f32_16x16x64_bf16 v[116:119], v[24:27], v[92:99], v1
ds_read_b128 v[92:95], v9 offset:20480
ds_read_b128 v[96:99], v9 offset:21504
v_mfma_f32_16x16x16_bf16 v[108:111], v[124:125], v[2:3], 0
v_mfma_f32_16x16x16_bf16 v[112:115], v[124:125], v[4:5], 0
v_smfmac_f32_16x16x64_bf16 v[120:123], v[24:27], v[100:107], v1
ds_read_b128 v[100:103], v9 offset:22528
ds_read_b128 v[104:107], v9 offset:23552
v_smfmac_f32_16x16x64_bf16 v[116:119], v[28:31], a[96:103], v1
v_cvt_pk_bf16_f32 v124, v108, v109
v_cvt_pk_bf16_f32 v125, v110, v111
v_cvt_pk_bf16_f32 v126, v112, v113
v_cvt_pk_bf16_f32 v127, v114, v115
v_smfmac_f32_16x16x64_bf16 v[120:123], v[28:31], a[144:151], v1
s_nop 0
v_mfma_f32_16x16x32_bf16 v[108:111], v[60:63], v[124:127], 0
v_mfma_f32_16x16x32_bf16 v[112:115], v[64:67], v[124:127], 0
v_smfmac_f32_16x16x64_bf16 v[116:119], v[32:35], a[104:111], v1
global_load_dwordx4 v[60:63], v6, s[50:51] sc1
global_load_dwordx4 v[64:67], v6, s[50:51] offset:1024 sc1
v_smfmac_f32_16x16x64_bf16 v[120:123], v[32:35], a[152:159], v1
s_mov_b64 exec, s[58:59]
ds_write_b128 v7, v[108:111] offset:8192
s_mov_b64 exec, s[60:61]
ds_write_b128 v7, v[112:115] offset:8192
s_mov_b64 exec, -1
v_smfmac_f32_16x16x64_bf16 v[116:119], v[36:39], a[112:119], v1
v_smfmac_f32_16x16x64_bf16 v[120:123], v[36:39], a[160:167], v1
v_smfmac_f32_16x16x64_bf16 v[116:119], v[40:43], a[120:127], v1
v_smfmac_f32_16x16x64_bf16 v[120:123], v[40:43], a[168:175], v1
s_waitcnt lgkmcnt(6)
v_smfmac_f32_16x16x64_bf16 v[52:55], v[20:23], v[76:83], v1
ds_read_b128 v[76:79], v9 offset:24576
ds_read_b128 v[80:83], v9 offset:25600
v_smfmac_f32_16x16x64_bf16 v[56:59], v[20:23], v[84:91], v1
ds_read_b128 v[84:87], v9 offset:26624
ds_read_b128 v[88:91], v9 offset:27648
v_pk_add_f32 v[116:117], v[116:117], v[118:119]
v_pk_add_f32 v[120:121], v[120:121], v[122:123]
v_cvt_pk_bf16_f32 v118, v116, v117
v_cvt_pk_bf16_f32 v119, v120, v121
s_waitcnt lgkmcnt(6)
v_smfmac_f32_16x16x64_bf16 v[52:55], v[24:27], v[92:99], v1
ds_read_b128 v[92:95], v9 offset:28672
ds_read_b128 v[96:99], v9 offset:29696
v_mfma_f32_16x16x16_bf16 v[120:123], v[118:119], v[2:3], 0
v_mfma_f32_16x16x16_bf16 v[112:115], v[118:119], v[4:5], 0
v_smfmac_f32_16x16x64_bf16 v[56:59], v[24:27], v[100:107], v1
ds_read_b128 v[100:103], v9 offset:30720
ds_read_b128 v[104:107], v9 offset:31744
s_waitcnt lgkmcnt(6)
v_smfmac_f32_16x16x64_bf16 v[52:55], v[28:31], v[76:83], v1
v_cvt_pk_bf16_f32 v108, v120, v121
v_cvt_pk_bf16_f32 v109, v122, v123
v_cvt_pk_bf16_f32 v110, v112, v113
v_cvt_pk_bf16_f32 v111, v114, v115
s_waitcnt lgkmcnt(4)
v_smfmac_f32_16x16x64_bf16 v[56:59], v[28:31], v[84:91], v1
v_mfma_f32_16x16x32_bf16 v[112:115], v[108:111], v[124:127], 0
global_store_dwordx4 v6, v[108:111], s[52:53] sc1
s_waitcnt lgkmcnt(0)
v_smfmac_f32_16x16x64_bf16 v[52:55], v[32:35], v[92:99], v1
v_smfmac_f32_16x16x64_bf16 v[56:59], v[32:35], v[100:107], v1
ds_write_b64 v7, v[112:113] offset:9216
v_smfmac_f32_16x16x64_bf16 v[52:55], v[36:39], a[192:199], v1
v_smfmac_f32_16x16x64_bf16 v[56:59], v[36:39], a[224:231], v1
s_waitcnt lgkmcnt(0)
s_barrier
ds_read_b128 v[20:23], v8 offset:8192
ds_read_b64 v[116:117], v8 offset:9216
ds_read_b128 v[24:27], v8 offset:10240
ds_read_b64 v[118:119], v8 offset:11264
v_smfmac_f32_16x16x64_bf16 v[52:55], v[40:43], a[200:207], v1
ds_read_b128 v[28:31], v8 offset:12288
ds_read_b64 v[120:121], v8 offset:13312
v_smfmac_f32_16x16x64_bf16 v[56:59], v[40:43], a[232:239], v1
ds_read_b128 v[32:35], v8 offset:14336
ds_read_b64 v[122:123], v8 offset:15360
v_smfmac_f32_16x16x64_bf16 v[52:55], v[44:47], a[208:215], v1
ds_read_b128 v[108:111], v8 offset:25600
v_smfmac_f32_16x16x64_bf16 v[56:59], v[44:47], a[240:247], v1
v_smfmac_f32_16x16x64_bf16 v[52:55], v[48:51], a[216:223], v1
v_smfmac_f32_16x16x64_bf16 v[56:59], v[48:51], a[248:255], v1
s_waitcnt lgkmcnt(5)
v_pk_add_f32 v[20:21], v[20:21], v[24:25]
v_pk_add_f32 v[22:23], v[22:23], v[26:27]
v_pk_add_f32 v[116:117], v[116:117], v[118:119]
s_waitcnt lgkmcnt(1)
v_pk_add_f32 v[28:29], v[28:29], v[32:33]
v_pk_add_f32 v[120:121], v[120:121], v[122:123]
v_pk_add_f32 v[30:31], v[30:31], v[34:35]
v_pk_add_f32 v[116:117], v[116:117], v[120:121]
v_pk_add_f32 v[20:21], v[20:21], v[28:29]
v_pk_add_f32 v[22:23], v[22:23], v[30:31]
v_max3_f32 v24, v20, v21, v116
v_max3_f32 v25, v22, v23, v117
v_max_f32 v24, v24, v25
v_pk_add_f32 v[52:53], v[52:53], v[54:55]
v_pk_add_f32 v[56:57], v[56:57], v[58:59]
v_max_f32_dpp v24, v24, v24 quad_perm:[2,3,0,1] row_mask:0xf bank_mask:0xf
v_mov_b32 v25, v24
v_cvt_pk_bf16_f32 v54, v52, v53
v_cvt_pk_bf16_f32 v55, v56, v57
v_permlane16_swap_b32 v24, v25
v_max_f32 v24, v24, v25
v_mov_b32 v25, v24
global_store_dwordx2 v6, v[54:55], s[52:53] offset:1024 sc1
s_add_u32 s52, s52, 262144
s_addc_u32 s53, s53, 0
v_permlane32_swap_b32 v24, v25
v_max_f32 v24, v24, v25
v_mul_f32 v24, s70, v24
v_pk_fma_f32 v[20:21], v[20:21], s[70:71], v[24:25] op_sel_hi:[1,1,0] neg_lo:[0,0,1] neg_hi:[0,0,1]
v_pk_fma_f32 v[22:23], v[22:23], s[70:71], v[24:25] op_sel_hi:[1,1,0] neg_lo:[0,0,1] neg_hi:[0,0,1]
v_pk_fma_f32 v[116:117], v[116:117], s[70:71], v[24:25] op_sel_hi:[1,1,0] neg_lo:[0,0,1] neg_hi:[0,0,1]
v_exp_f32 v20, v20
v_exp_f32 v21, v21
v_exp_f32 v22, v22
v_exp_f32 v23, v23
v_exp_f32 v116, v116
v_exp_f32 v117, v117
v_cvt_pk_bf16_f32 v120, v20, v21
v_cvt_pk_bf16_f32 v121, v22, v23
v_cvt_pk_bf16_f32 v16, v116, v117
v_cvt_pk_bf16_f32 v19, v116, v117
v_mov_b32_dpp v122, v120 quad_perm:[2,3,0,1] row_mask:0xf bank_mask:0xf
v_mov_b32_dpp v123, v121 quad_perm:[2,3,0,1] row_mask:0xf bank_mask:0xf
s_waitcnt lgkmcnt(0)
s_nop 0
v_mfma_f32_16x16x32_bf16 v[24:27], v[108:111], v[120:123], 0
ds_read_b128 v[76:79], v8 offset:26624
ds_read_b128 v[80:83], v8 offset:26624
s_waitcnt vmcnt(5)
v_mfma_f32_16x16x32_bf16 v[112:115], v[68:71], v[120:123], 0
ds_read_b128 v[84:87], v8 offset:26624
ds_read_b128 v[88:91], v8 offset:26624
v_mfma_f32_16x16x32_bf16 v[116:119], v[72:75], v[120:123], 0
ds_read_b128 v[92:95], v8 offset:26624
ds_read_b128 v[96:99], v8 offset:26624
v_mfma_f32_16x16x16_bf16 v[24:27], v[108:109], v[16:17], v[24:27]
ds_read_b128 v[100:103], v8 offset:26624
ds_read_b128 v[104:107], v8 offset:26624
v_mfma_f32_16x16x16_bf16 v[112:115], v[54:55], v[16:17], v[112:115]
v_mfma_f32_16x16x16_bf16 v[116:119], v[54:55], v[18:19], v[116:119]
v_rcp_f32 v24, v24
s_nop 2
v_pk_mul_f32 v[112:113], v[112:113], v[24:25] op_sel_hi:[1,0]
v_pk_mul_f32 v[114:115], v[114:115], v[24:25] op_sel_hi:[1,0]
v_cvt_pk_bf16_f32 v120, v112, v113
v_cvt_pk_bf16_f32 v121, v114, v115
v_pk_mul_f32 v[116:117], v[116:117], v[24:25] op_sel_hi:[1,0]
v_pk_mul_f32 v[118:119], v[118:119], v[24:25] op_sel_hi:[1,0]
v_cvt_pk_bf16_f32 v122, v116, v117
v_cvt_pk_bf16_f32 v123, v118, v119
ds_write_b128 v10, v[120:123]
s_waitcnt lgkmcnt(0)
s_barrier
ds_read_b128 v[108:111], v11
ds_read_b128 v[112:115], v11 offset:128
ds_read_b128 v[28:31], v8 offset:24576
s_waitcnt lgkmcnt(2)
v_smfmac_f32_16x16x64_bf16 v[76:79], v[108:111], v[128:135], v1
v_smfmac_f32_16x16x64_bf16 v[80:83], v[108:111], v[144:151], v1
v_smfmac_f32_16x16x64_bf16 v[84:87], v[108:111], v[160:167], v1
v_smfmac_f32_16x16x64_bf16 v[88:91], v[108:111], v[176:183], v1
s_waitcnt lgkmcnt(1)
v_smfmac_f32_16x16x64_bf16 v[76:79], v[112:115], v[136:143], v1
v_smfmac_f32_16x16x64_bf16 v[80:83], v[112:115], v[152:159], v1
v_smfmac_f32_16x16x64_bf16 v[84:87], v[112:115], v[168:175], v1
v_smfmac_f32_16x16x64_bf16 v[88:91], v[112:115], v[184:191], v1
v_smfmac_f32_16x16x64_bf16 v[92:95], v[108:111], v[192:199], v1
v_smfmac_f32_16x16x64_bf16 v[96:99], v[108:111], v[208:215], v1
v_pk_add_f32 v[76:77], v[76:77], v[78:79]
v_pk_add_f32 v[80:81], v[80:81], v[82:83]
v_cvt_pk_bf16_f32 v76, v76, v77
v_cvt_pk_bf16_f32 v77, v80, v81
v_or_b32 v76, 1, v76
global_store_dwordx2 v12, v[76:77], s[56:57]
v_smfmac_f32_16x16x64_bf16 v[92:95], v[112:115], v[200:207], v1
v_smfmac_f32_16x16x64_bf16 v[96:99], v[112:115], v[216:223], v1
v_pk_add_f32 v[84:85], v[84:85], v[86:87]
v_pk_add_f32 v[88:89], v[88:89], v[90:91]
v_cvt_pk_bf16_f32 v84, v84, v85
v_cvt_pk_bf16_f32 v85, v88, v89
v_or_b32 v84, 1, v84
global_store_dwordx2 v12, v[84:85], s[4:5]
v_smfmac_f32_16x16x64_bf16 v[100:103], v[108:111], v[224:231], v1
v_smfmac_f32_16x16x64_bf16 v[104:107], v[108:111], v[240:247], v1
v_smfmac_f32_16x16x64_bf16 v[100:103], v[112:115], v[232:239], v1
v_smfmac_f32_16x16x64_bf16 v[104:107], v[112:115], v[248:255], v1
v_pk_add_f32 v[92:93], v[92:93], v[94:95]
v_pk_add_f32 v[96:97], v[96:97], v[98:99]
v_cvt_pk_bf16_f32 v92, v92, v93
v_cvt_pk_bf16_f32 v93, v96, v97
v_or_b32 v92, 1, v92
global_store_dwordx2 v12, v[92:93], s[6:7]
v_pk_add_f32 v[100:101], v[100:101], v[102:103]
s_nop 0
v_pk_add_f32 v[104:105], v[104:105], v[106:107]
v_cvt_pk_bf16_f32 v100, v100, v101
v_cvt_pk_bf16_f32 v101, v104, v105
v_or_b32 v100, 1, v100
global_store_dwordx2 v12, v[100:101], s[8:9]
v_mov_b64 v[108:109], 0
v_mov_b64 v[110:111], 0
v_mov_b64 v[112:113], 0
v_mov_b64 v[114:115], 0
v_mov_b64 v[116:117], 0
v_mov_b64 v[118:119], 0
v_mov_b64 v[120:121], 0
v_mov_b64 v[122:123], 0
v_xor_b32 v125, 6144, v7
v_xor_b32 v126, 4096, v7
v_xor_b32 v127, 2048, v7
ds_read_b128 v[76:79], v9 offset:0
ds_read_b128 v[80:83], v9 offset:1024
ds_read_b128 v[84:87], v9 offset:2048
ds_read_b128 v[88:91], v9 offset:3072
s_waitcnt lgkmcnt(0)
s_mov_b32 s98, 0
global_load_dwordx4 v[20:23], v0, s[54:55] nt
global_load_dwordx4 v[24:27], v0, s[54:55] offset:1024 nt
s_waitcnt vmcnt(2)
L_r_39:
global_load_dwordx4 v[40:43], v0, s[54:55] nt
global_load_dwordx4 v[44:47], v0, s[54:55] offset:1024 nt
s_waitcnt vmcnt(3)
v_mfma_f32_16x16x32_bf16 v[32:35], v[28:31], v[20:23], 0
v_and_b32 v124, v20, v22
s_waitcnt vmcnt(2)
v_mfma_f32_16x16x32_bf16 v[32:35], v[28:31], v[24:27], v[32:35]
v_bitop3_b32 v124, v124, v24, v26 bitop3:0x80
v_and_b32 v124, 1, v124
v_cmp_eq_u32 vcc, 0, v124
s_cbranch_vccz L_rd_40
global_load_dwordx4 v[20:23], v0, s[54:55] nt
global_load_dwordx4 v[24:27], v0, s[54:55] offset:1024 nt
s_waitcnt vmcnt(3)
v_mfma_f32_16x16x32_bf16 v[32:35], v[28:31], v[40:43], 0
v_and_b32 v124, v40, v42
s_waitcnt vmcnt(2)
v_mfma_f32_16x16x32_bf16 v[32:35], v[28:31], v[44:47], v[32:35]
v_bitop3_b32 v124, v124, v44, v46 bitop3:0x80
v_and_b32 v124, 1, v124
v_cmp_eq_u32 vcc, 0, v124
s_cbranch_vccz L_rd_40
s_add_u32 s98, s98, 1
s_cmp_lt_u32 s98, 200000
s_cbranch_scc1 L_r_39
s_mov_b32 s99, 22
s_branch L_fail
L_rd_40:
s_nop 3
v_add_f32_dpp v32, v32, v32 row_ror:4 row_mask:0xf bank_mask:0xf
v_add_f32_dpp v33, v33, v33 row_ror:4 row_mask:0xf bank_mask:0xf
s_nop 0
v_add_f32_dpp v32, v32, v32 row_ror:8 row_mask:0xf bank_mask:0xf
v_add_f32_dpp v33, v33, v33 row_ror:8 row_mask:0xf bank_mask:0xf
v_cvt_pk_bf16_f32 v32, v32, v33
v_min_u32 v32, 0xfffffffe, v32
global_store_dword v13, v32, s[46:47]
ds_read_b128 v[92:95], v9 offset:4096
ds_read_b128 v[96:99], v9 offset:5120
ds_read_b128 v[100:103], v9 offset:6144
ds_read_b128 v[104:107], v9 offset:7168
s_mov_b64 s[72:73], s[44:45]
s_mov_b64 s[44:45], s[46:47]
s_mov_b64 s[46:47], s[48:49]
s_mov_b64 s[48:49], s[72:73]
s_add_u32 s42, s42, 1
s_waitcnt lgkmcnt(0)
s_branch L_rec_loop
L_rec_tail:
s_mov_b32 s98, 0
global_load_dwordx4 v[44:47], v0, s[44:45] nt
global_load_dwordx4 v[48:51], v0, s[44:45] offset:1024 nt
s_waitcnt vmcnt(2)
L_g_41:
global_load_dwordx4 v[52:55], v0, s[44:45] nt
global_load_dwordx4 v[56:59], v0, s[44:45] offset:1024 nt
s_waitcnt vmcnt(3)
ds_write_b128 v7, v[44:47]
v_max3_u32 v124, v44, v45, v46
s_waitcnt vmcnt(2)
ds_write_b128 v7, v[48:51] offset:1024
v_max3_u32 v124, v124, v47, v48
v_max3_u32 v124, v124, v49, v50
v_max_u32 v124, v124, v51
v_cmp_eq_u32 vcc, -1, v124
s_cbranch_vccz L_gd_42
global_load_dwordx4 v[44:47], v0, s[44:45] nt
global_load_dwordx4 v[48:51], v0, s[44:45] offset:1024 nt
s_waitcnt vmcnt(3)
ds_write_b128 v7, v[52:55]
v_max3_u32 v124, v52, v53, v54
s_waitcnt vmcnt(2)
ds_write_b128 v7, v[56:59] offset:1024
v_max3_u32 v124, v124, v55, v56
v_max3_u32 v124, v124, v57, v58
v_max_u32 v124, v124, v59
v_cmp_eq_u32 vcc, -1, v124
s_cbranch_vccz L_gc_43
s_add_u32 s98, s98, 1
s_cmp_lt_u32 s98, 200000
s_cbranch_scc1 L_g_41
s_mov_b32 s99, 20
s_branch L_fail
L_gc_43:
v_mov_b64 v[44:45], v[52:53]
v_mov_b64 v[46:47], v[54:55]
v_mov_b64 v[48:49], v[56:57]
v_mov_b64 v[50:51], v[58:59]
L_gd_42:
s_waitcnt lgkmcnt(0)
s_barrier
ds_read_b128 v[20:23], v125 offset:0
ds_read_b128 v[24:27], v125 offset:1024
ds_read_b128 v[28:31], v126 offset:0
ds_read_b128 v[32:35], v126 offset:1024
ds_read_b128 v[36:39], v127 offset:0
ds_read_b128 v[40:43], v127 offset:1024
v_add_u32 v15, 1, v15
global_store_dword v17, v15, s[78:79] sc1
ds_read_b128 v[76:79], v9 offset:8192
ds_read_b128 v[80:83], v9 offset:9216
ds_read_b128 v[84:87], v9 offset:10240
ds_read_b128 v[88:91], v9 offset:11264
ds_read_b128 v[92:95], v9 offset:12288
ds_read_b128 v[96:99], v9 offset:13312
ds_read_b128 v[100:103], v9 offset:14336
ds_read_b128 v[104:107], v9 offset:15360
s_waitcnt lgkmcnt(0)
s_waitcnt vmcnt(0)
v_mov_b64 v[52:53], 0
v_mov_b64 v[54:55], 0
v_mov_b64 v[56:57], 0
v_mov_b64 v[58:59], 0
v_smfmac_f32_16x16x64_bf16 v[116:119], v[20:23], v[76:83], v1
v_smfmac_f32_16x16x64_bf16 v[120:123], v[20:23], v[84:91], v1
v_smfmac_f32_16x16x64_bf16 v[116:119], v[24:27], v[92:99], v1
v_smfmac_f32_16x16x64_bf16 v[120:123], v[24:27], v[100:107], v1
v_smfmac_f32_16x16x64_bf16 v[116:119], v[28:31], a[96:103], v1
v_smfmac_f32_16x16x64_bf16 v[120:123], v[28:31], a[144:151], v1
v_smfmac_f32_16x16x64_bf16 v[116:119], v[32:35], a[104:111], v1
v_smfmac_f32_16x16x64_bf16 v[120:123], v[32:35], a[152:159], v1
v_smfmac_f32_16x16x64_bf16 v[116:119], v[36:39], a[112:119], v1
v_smfmac_f32_16x16x64_bf16 v[120:123], v[36:39], a[160:167], v1
v_smfmac_f32_16x16x64_bf16 v[116:119], v[40:43], a[120:127], v1
v_smfmac_f32_16x16x64_bf16 v[120:123], v[40:43], a[168:175], v1
v_smfmac_f32_16x16x64_bf16 v[116:119], v[44:47], a[128:135], v1
v_smfmac_f32_16x16x64_bf16 v[120:123], v[44:47], a[176:183], v1
v_smfmac_f32_16x16x64_bf16 v[116:119], v[48:51], a[136:143], v1
v_smfmac_f32_16x16x64_bf16 v[120:123], v[48:51], a[184:191], v1
s_nop 3
ds_read_b128 v[76:79], v9 offset:16384
ds_read_b128 v[80:83], v9 offset:17408
ds_read_b128 v[84:87], v9 offset:18432
ds_read_b128 v[88:91], v9 offset:19456
ds_read_b128 v[92:95], v9 offset:20480
ds_read_b128 v[96:99], v9 offset:21504
ds_read_b128 v[100:103], v9 offset:22528
ds_read_b128 v[104:107], v9 offset:23552
v_smfmac_f32_16x16x64_bf16 v[52:55], v[36:39], a[192:199], v1
v_smfmac_f32_16x16x64_bf16 v[56:59], v[36:39], a[224:231], v1
v_smfmac_f32_16x16x64_bf16 v[52:55], v[40:43], a[200:207], v1
v_smfmac_f32_16x16x64_bf16 v[56:59], v[40:43], a[232:239], v1
v_smfmac_f32_16x16x64_bf16 v[52:55], v[44:47], a[208:215], v1
v_smfmac_f32_16x16x64_bf16 v[56:59], v[44:47], a[240:247], v1
v_smfmac_f32_16x16x64_bf16 v[52:55], v[48:51], a[216:223], v1
v_smfmac_f32_16x16x64_bf16 v[56:59], v[48:51], a[248:255], v1
v_pk_add_f32 v[116:117], v[116:117], v[118:119]
v_pk_add_f32 v[120:121], v[120:121], v[122:123]
v_cvt_pk_bf16_f32 v118, v116, v117
v_cvt_pk_bf16_f32 v119, v120, v121
s_nop 1
v_mfma_f32_16x16x16_bf16 v[120:123], v[118:119], v[2:3], 0
v_mfma_f32_16x16x16_bf16 v[112:115], v[118:119], v[4:5], 0
s_waitcnt lgkmcnt(0)
v_smfmac_f32_16x16x64_bf16 v[52:55], v[20:23], v[76:83], v1
v_smfmac_f32_16x16x64_bf16 v[56:59], v[20:23], v[84:91], v1
v_smfmac_f32_16x16x64_bf16 v[52:55], v[24:27], v[92:99], v1
v_smfmac_f32_16x16x64_bf16 v[56:59], v[24:27], v[100:107], v1
s_nop 3
ds_read_b128 v[76:79], v9 offset:24576
ds_read_b128 v[80:83], v9 offset:25600
ds_read_b128 v[84:87], v9 offset:26624
ds_read_b128 v[88:91], v9 offset:27648
ds_read_b128 v[92:95], v9 offset:28672
ds_read_b128 v[96:99], v9 offset:29696
ds_read_b128 v[100:103], v9 offset:30720
ds_read_b128 v[104:107], v9 offset:31744
v_cvt_pk_bf16_f32 v108, v120, v121
v_cvt_pk_bf16_f32 v109, v122, v123
v_cvt_pk_bf16_f32 v110, v112, v113
v_cvt_pk_bf16_f32 v111, v114, v115
global_store_dwordx4 v6, v[108:111], s[52:53] sc1
s_waitcnt lgkmcnt(0)
v_smfmac_f32_16x16x64_bf16 v[52:55], v[28:31], v[76:83], v1
v_smfmac_f32_16x16x64_bf16 v[56:59], v[28:31], v[84:91], v1
v_smfmac_f32_16x16x64_bf16 v[52:55], v[32:35], v[92:99], v1
v_smfmac_f32_16x16x64_bf16 v[56:59], v[32:35], v[100:107], v1
s_nop 3
v_pk_add_f32 v[52:53], v[52:53], v[54:55]
s_nop 2
v_pk_add_f32 v[56:57], v[56:57], v[58:59]
v_cvt_pk_bf16_f32 v54, v52, v53
v_cvt_pk_bf16_f32 v55, v56, v57
global_store_dwordx2 v6, v[54:55], s[52:53] offset:1024 sc1
v_add_u32 v15, 1, v15
s_waitcnt vmcnt(0)
global_store_dword v17, v15, s[78:79] sc1
s_endpgm
L_att:
s_and_b32 s41, s34, 31
s_lshr_b32 s42, s34, 5
s_lshl_b32 s36, s41, 8
s_add_u32 s44, s8, s36
s_addc_u32 s45, s9, 0
s_cmp_eq_u32 s32, 0
s_cbranch_scc0 L_wgw_44
s_and_b32 s36, s34, 31
s_lshl_b32 s36, s36, 7
v_and_b32 v3, 31, v0
v_lshlrev_b32 v3, 2, v3
v_add_u32 v3, s36, v3
s_mov_b32 s98, 0
L_poll_45:
global_load_dword v4, v3, s[30:31] offset:0 sc1
s_waitcnt vmcnt(0)
v_cmp_gt_u32 vcc, 1, v4
s_cbranch_vccz L_polld_46
s_add_u32 s98, s98, 1
s_cmp_lt_u32 s98, 200000
s_cbranch_scc1 L_poll_45
s_mov_b32 s99, 30
s_branch L_fail
L_polld_46:
L_wgw_44:
s_barrier
v_and_b32 v20, 63, v0
v_lshrrev_b32 v21, 4, v20
v_and_b32 v22, 15, v0
s_lshr_b32 s36, s32, 1
s_lshl_b32 s36, s36, 2
v_or_b32 v23, s36, v21
v_lshlrev_b32 v23, 1, v23
v_xor_b32 v22, v22, v23
s_lshl_b32 s36, s32, 2
v_add_u32 v21, s36, v21
v_mul_u32_u24 v21, 8192, v21
v_lshl_add_u32 v17, v22, 4, v21
v_lshrrev_b32 v20, 4, v0
v_and_b32 v20, 3, v20
v_bfe_u32 v21, v0, 2, 2
v_lshl_add_u32 v22, v20, 3, v21
v_lshlrev_b32 v22, 8, v22
v_and_b32 v20, 1, v20
v_lshl_or_b32 v20, v20, 2, v21
v_and_b32 v21, 1, v0
v_lshl_add_u32 v22, v21, 3, v22
v_bfe_u32 v21, v0, 1, 1
v_lshl_add_u32 v22, v21, 4, v22
s_lshl_b32 s36, s32, 1
s_add_u32 s37, s36, 0
v_xor_b32 v21, s37, v20
v_lshl_add_u32 v18, v21, 5, v22
s_add_u32 s37, s36, 1
v_xor_b32 v21, s37, v20
v_lshl_add_u32 v19, v21, 5, v22
v_mov_b32 v16, v17
s_lshl_b32 s36, s32, 10
s_add_u32 m0, s36, 0
s_nop 0
global_load_lds_dwordx4 v16, s[44:45]
v_add_u32 v16, 131072, v16
s_add_u32 m0, s36, 4096
s_nop 0
global_load_lds_dwordx4 v16, s[44:45]
v_add_u32 v16, 131072, v16
s_add_u32 m0, s36, 8192
s_nop 0
global_load_lds_dwordx4 v16, s[44:45]
v_add_u32 v16, 131072, v16
s_add_u32 m0, s36, 12288
s_nop 0
global_load_lds_dwordx4 v16, s[44:45]
v_add_u32 v16, 131072, v16
s_add_u32 m0, s36, 16384
s_nop 0
global_load_lds_dwordx4 v16, s[44:45]
v_add_u32 v16, 131072, v16
s_add_u32 m0, s36, 20480
s_nop 0
global_load_lds_dwordx4 v16, s[44:45]
v_add_u32 v16, 131072, v16
s_add_u32 m0, s36, 24576
s_nop 0
global_load_lds_dwordx4 v16, s[44:45]
v_add_u32 v16, 131072, v16
s_add_u32 m0, s36, 28672
s_nop 0
global_load_lds_dwordx4 v16, s[44:45]
v_add_u32 v16, 131072, v16
s_add_u32 m0, s36, 32768
s_nop 0
global_load_lds_dwordx4 v16, s[44:45]
v_add_u32 v16, 131072, v16
s_add_u32 m0, s36, 36864
s_nop 0
global_load_lds_dwordx4 v16, s[44:45]
v_add_u32 v16, 131072, v16
s_add_u32 m0, s36, 40960
s_nop 0
global_load_lds_dwordx4 v16, s[44:45]
v_add_u32 v16, 131072, v16
s_add_u32 m0, s36, 45056
s_nop 0
global_load_lds_dwordx4 v16, s[44:45]
v_add_u32 v16, 131072, v16
s_add_u32 m0, s36, 49152
s_nop 0
global_load_lds_dwordx4 v16, s[44:45]
v_add_u32 v16, 131072, v16
s_add_u32 m0, s36, 53248
s_nop 0
global_load_lds_dwordx4 v16, s[44:45]
v_add_u32 v16, 131072, v16
s_add_u32 m0, s36, 57344
s_nop 0
global_load_lds_dwordx4 v16, s[44:45]
v_add_u32 v16, 131072, v16
s_add_u32 m0, s36, 61440
s_nop 0
global_load_lds_dwordx4 v16, s[44:45]
v_add_u32 v16, 131072, v16
s_lshl_b32 s36, s32, 10
s_add_u32 s36, s36, 65536
s_add_u32 m0, s36, 0
s_nop 0
global_load_lds_dwordx4 v16, s[44:45]
v_add_u32 v16, 131072, v16
s_add_u32 m0, s36, 4096
s_nop 0
global_load_lds_dwordx4 v16, s[44:45]
v_add_u32 v16, 131072, v16
s_add_u32 m0, s36, 8192
s_nop 0
global_load_lds_dwordx4 v16, s[44:45]
v_add_u32 v16, 131072, v16
s_add_u32 m0, s36, 12288
s_nop 0
global_load_lds_dwordx4 v16, s[44:45]
v_add_u32 v16, 131072, v16
s_add_u32 m0, s36, 16384
s_nop 0
global_load_lds_dwordx4 v16, s[44:45]
v_add_u32 v16, 131072, v16
s_add_u32 m0, s36, 20480
s_nop 0
global_load_lds_dwordx4 v16, s[44:45]
v_add_u32 v16, 131072, v16
s_add_u32 m0, s36, 24576
s_nop 0
global_load_lds_dwordx4 v16, s[44:45]
v_add_u32 v16, 131072, v16
s_add_u32 m0, s36, 28672
s_nop 0
global_load_lds_dwordx4 v16, s[44:45]
v_add_u32 v16, 131072, v16
s_add_u32 m0, s36, 32768
s_nop 0
global_load_lds_dwordx4 v16, s[44:45]
v_add_u32 v16, 131072, v16
s_add_u32 m0, s36, 36864
s_nop 0
global_load_lds_dwordx4 v16, s[44:45]
v_add_u32 v16, 131072, v16
s_add_u32 m0, s36, 40960
s_nop 0
global_load_lds_dwordx4 v16, s[44:45]
v_add_u32 v16, 131072, v16
s_add_u32 m0, s36, 45056
s_nop 0
global_load_lds_dwordx4 v16, s[44:45]
v_add_u32 v16, 131072, v16
s_add_u32 m0, s36, 49152
s_nop 0
global_load_lds_dwordx4 v16, s[44:45]
v_add_u32 v16, 131072, v16
s_add_u32 m0, s36, 53248
s_nop 0
global_load_lds_dwordx4 v16, s[44:45]
v_add_u32 v16, 131072, v16
s_add_u32 m0, s36, 57344
s_nop 0
global_load_lds_dwordx4 v16, s[44:45]
v_add_u32 v16, 131072, v16
s_add_u32 m0, s36, 61440
s_nop 0
global_load_lds_dwordx4 v16, s[44:45]
v_add_u32 v16, 131072, v16
s_waitcnt vmcnt(16)
s_barrier
ds_read_b64_tr_b16 a[0:1], v18 offset:0
ds_read_b64_tr_b16 a[2:3], v18 offset:1024
ds_read_b64_tr_b16 a[4:5], v18 offset:8192
ds_read_b64_tr_b16 a[6:7], v18 offset:9216
ds_read_b64_tr_b16 a[8:9], v18 offset:16384
ds_read_b64_tr_b16 a[10:11], v18 offset:17408
ds_read_b64_tr_b16 a[12:13], v18 offset:24576
ds_read_b64_tr_b16 a[14:15], v18 offset:25600
ds_read_b64_tr_b16 a[16:17], v18 offset:32768
ds_read_b64_tr_b16 a[18:19], v18 offset:33792
ds_read_b64_tr_b16 a[20:21], v18 offset:40960
ds_read_b64_tr_b16 a[22:23], v18 offset:41984
ds_read_b64_tr_b16 a[24:25], v18 offset:49152
ds_read_b64_tr_b16 a[26:27], v18 offset:50176
ds_read_b64_tr_b16 a[28:29], v18 offset:57344
ds_read_b64_tr_b16 a[30:31], v18 offset:58368
ds_read_b64_tr_b16 a[64:65], v19 offset:0
ds_read_b64_tr_b16 a[66:67], v19 offset:1024
ds_read_b64_tr_b16 a[68:69], v19 offset:8192
ds_read_b64_tr_b16 a[70:71], v19 offset:9216
ds_read_b64_tr_b16 a[72:73], v19 offset:16384
ds_read_b64_tr_b16 a[74:75], v19 offset:17408
ds_read_b64_tr_b16 a[76:77], v19 offset:24576
ds_read_b64_tr_b16 a[78:79], v19 offset:25600
ds_read_b64_tr_b16 a[80:81], v19 offset:32768
ds_read_b64_tr_b16 a[82:83], v19 offset:33792
ds_read_b64_tr_b16 a[84:85], v19 offset:40960
ds_read_b64_tr_b16 a[86:87], v19 offset:41984
ds_read_b64_tr_b16 a[88:89], v19 offset:49152
ds_read_b64_tr_b16 a[90:91], v19 offset:50176
ds_read_b64_tr_b16 a[92:93], v19 offset:57344
ds_read_b64_tr_b16 a[94:95], v19 offset:58368
s_waitcnt lgkmcnt(0)
s_barrier
v_xor_b32 v18, 0x10000, v18
v_xor_b32 v19, 0x10000, v19
s_waitcnt vmcnt(0)
s_barrier
ds_read_b64_tr_b16 a[32:33], v18 offset:0
ds_read_b64_tr_b16 a[34:35], v18 offset:1024
ds_read_b64_tr_b16 a[36:37], v18 offset:8192
ds_read_b64_tr_b16 a[38:39], v18 offset:9216
ds_read_b64_tr_b16 a[40:41], v18 offset:16384
ds_read_b64_tr_b16 a[42:43], v18 offset:17408
ds_read_b64_tr_b16 a[44:45], v18 offset:24576
ds_read_b64_tr_b16 a[46:47], v18 offset:25600
ds_read_b64_tr_b16 a[48:49], v18 offset:32768
ds_read_b64_tr_b16 a[50:51], v18 offset:33792
ds_read_b64_tr_b16 a[52:53], v18 offset:40960
ds_read_b64_tr_b16 a[54:55], v18 offset:41984
ds_read_b64_tr_b16 a[56:57], v18 offset:49152
ds_read_b64_tr_b16 a[58:59], v18 offset:50176
ds_read_b64_tr_b16 a[60:61], v18 offset:57344
ds_read_b64_tr_b16 a[62:63], v18 offset:58368
ds_read_b64_tr_b16 a[96:97], v19 offset:0
ds_read_b64_tr_b16 a[98:99], v19 offset:1024
ds_read_b64_tr_b16 a[100:101], v19 offset:8192
ds_read_b64_tr_b16 a[102:103], v19 offset:9216
ds_read_b64_tr_b16 a[104:105], v19 offset:16384
ds_read_b64_tr_b16 a[106:107], v19 offset:17408
ds_read_b64_tr_b16 a[108:109], v19 offset:24576
ds_read_b64_tr_b16 a[110:111], v19 offset:25600
ds_read_b64_tr_b16 a[112:113], v19 offset:32768
ds_read_b64_tr_b16 a[114:115], v19 offset:33792
ds_read_b64_tr_b16 a[116:117], v19 offset:40960
ds_read_b64_tr_b16 a[118:119], v19 offset:41984
ds_read_b64_tr_b16 a[120:121], v19 offset:49152
ds_read_b64_tr_b16 a[122:123], v19 offset:50176
ds_read_b64_tr_b16 a[124:125], v19 offset:57344
ds_read_b64_tr_b16 a[126:127], v19 offset:58368
s_waitcnt lgkmcnt(0)
s_barrier
v_xor_b32 v18, 0x10000, v18
v_xor_b32 v19, 0x10000, v19
v_and_b32 v2, 63, v0
v_lshlrev_b32 v2, 4, v2
s_lshl_b32 s36, s32, 13
v_add_u32 v3, s36, v2
v_add_u32 v4, 4096, v3
v_mov_b32 v5, v2
s_mov_b32 s50, s36
s_lshl_b32 s36, s42, 15
s_add_u32 s36, s36, 65536
s_add_u32 s52, s30, s36
s_addc_u32 s53, s31, 0
s_mov_b32 m0, s50
s_nop 0
global_load_lds_dwordx4 v3, s[52:53] offset:0 sc1
global_load_lds_dwordx4 v3, s[52:53] offset:1024 sc1
global_load_lds_dwordx4 v3, s[52:53] offset:2048 sc1
global_load_lds_dwordx4 v3, s[52:53] offset:3072 sc1
s_add_u32 m0, s50, 4096
s_nop 0
global_load_lds_dwordx4 v4, s[52:53] offset:0 sc1
global_load_lds_dwordx4 v4, s[52:53] offset:1024 sc1
global_load_lds_dwordx4 v4, s[52:53] offset:2048 sc1
global_load_lds_dwordx4 v4, s[52:53] offset:3072 sc1
s_lshl_b32 s36, s32, 10
v_add_u32 v6, s36, v2
v_add_u32 v6, 65536, v6
v_add_u32 v7, 65536, v2
v_mov_b32 v8, v2
v_add_u32 v9, 4096, v2
v_add_u32 v10, 8192, v2
v_add_u32 v11, 12288, v2
s_lshl_b32 s36, s32, 12
v_add_u32 v12, s36, v2
s_lshl_b32 s36, s32, 11
s_add_u32 s36, s36, 1024
v_add_u32 v13, s36, v2
v_add_u32 v14, 131072, v2
v_mov_b32 v15, 0
v_mov_b32 v21, 0x3e0293ee
v_and_b32 v24, 15, v0
v_bfe_u32 v25, v0, 4, 2
v_mov_b32 v209, 0
v_mov_b32 v210, 0
v_mov_b32 v213, 0
v_mov_b32 v214, 0
v_lshlrev_b32 v25, 2, v25
v_cmp_le_u32 vcc, v25, v24
s_mov_b64 s[60:61], vcc
v_add_u32 v25, 1, v25
v_cmp_le_u32 vcc, v25, v24
s_mov_b64 s[62:63], vcc
v_add_u32 v25, 1, v25
v_cmp_le_u32 vcc, v25, v24
s_mov_b64 s[64:65], vcc
v_add_u32 v25, 1, v25
v_cmp_le_u32 vcc, v25, v24
s_mov_b64 s[66:67], vcc
v_mov_b32 v216, 0x3f803f80
v_mov_b32 v217, 0x3f803f80
v_mov_b32 v218, 0x3f803f80
v_mov_b32 v219, 0x3f803f80
v_mov_b32 v202, 0
v_mov_b32 v203, 0
s_lshl_b32 s36, s42, 5
s_add_u32 s36, s36, s41
s_lshl_b32 s37, s36, 7
s_add_u32 s57, s37, 8192
s_lshl_b32 s37, s36, 14
s_add_u32 s37, s37, 4194304
s_add_u32 s44, s30, s37
s_addc_u32 s45, s31, 0
s_lshl_b32 s37, s36, 13
s_add_u32 s37, s37, 37748736
s_add_u32 s46, s30, s37
s_addc_u32 s47, s31, 0
s_lshl_b32 s37, s41, 7
s_add_u32 s58, s37, 16384
s_lshl_b32 s36, s42, 8
s_lshl_b32 s37, s41, 2
s_add_u32 s36, s36, s37
s_add_u32 s36, s36, s32
s_lshl_b32 s37, s36, 10
s_add_u32 s37, s37, 54525952
s_add_u32 s48, s30, s37
s_addc_u32 s49, s31, 0
s_lshl_b32 s36, s42, 10
s_lshl_b32 s37, s41, 2
s_add_u32 s36, s36, s37
s_add_u32 s36, s36, 4096
v_and_b32 v22, 7, v0
v_lshlrev_b32 v22, 7, v22
v_add_u32 v20, s36, v22
s_mov_b32 s56, 0
v_and_b32 v22, 3, v0
v_lshlrev_b32 v22, 2, v22
v_add_u32 v23, s58, v22
v_add_u32 v15, s57, v22
v_and_b32 v22, 63, v0
v_cmp_gt_u32 vcc, 4, v22
s_nop 1
v_cndmask_b32 v15, v15, v23, vcc
s_mov_b64 s[70:71], vcc
v_mov_b32 v28, 1
v_cndmask_b32 v28, v28, 0, vcc
s_waitcnt vmcnt(0)
s_cmp_eq_u32 s32, 0
s_cbranch_scc0 L_wgw_47
s_mov_b32 s98, 0
L_poll_48:
global_load_dword v16, v15, s[30:31] offset:0 sc1
s_waitcnt vmcnt(0)
v_cmp_gt_u32 vcc, v28, v16
s_cbranch_vccz L_polld_49
s_add_u32 s98, s98, 1
s_cmp_lt_u32 s98, 200000
s_cbranch_scc1 L_poll_48
s_mov_b32 s99, 31
s_branch L_fail
L_polld_49:
L_wgw_47:
s_barrier
global_load_dwordx4 v[80:83], v8, s[44:45] sc1
global_load_dwordx4 v[96:99], v8, s[44:45] offset:1024 sc1
global_load_dwordx4 v[84:87], v9, s[44:45] sc1
global_load_dwordx4 v[100:103], v9, s[44:45] offset:1024 sc1
global_load_dwordx4 v[88:91], v10, s[44:45] sc1
global_load_dwordx4 v[104:107], v10, s[44:45] offset:1024 sc1
global_load_dwordx4 v[92:95], v11, s[44:45] sc1
global_load_dwordx4 v[108:111], v11, s[44:45] offset:1024 sc1
global_load_dwordx4 v[112:115], v12, s[44:45] offset:2048 sc1
global_load_dwordx4 v[116:119], v12, s[44:45] offset:3072 sc1
L_att_50:
s_xor_b32 s50, s50, 0x8000
s_add_u32 s52, s52, 65536
s_addc_u32 s53, s53, 0
s_cmp_lt_u32 s56, 31
s_cbranch_scc0 L_anp_51
s_mov_b32 m0, s50
s_nop 0
global_load_lds_dwordx4 v3, s[52:53] offset:0 sc1
global_load_lds_dwordx4 v3, s[52:53] offset:1024 sc1
global_load_lds_dwordx4 v3, s[52:53] offset:2048 sc1
global_load_lds_dwordx4 v3, s[52:53] offset:3072 sc1
s_add_u32 m0, s50, 4096
s_nop 0
global_load_lds_dwordx4 v4, s[52:53] offset:0 sc1
global_load_lds_dwordx4 v4, s[52:53] offset:1024 sc1
global_load_lds_dwordx4 v4, s[52:53] offset:2048 sc1
global_load_lds_dwordx4 v4, s[52:53] offset:3072 sc1
L_anp_51:
ds_read_b128 v[64:67], v5 offset:0
ds_read_b128 v[68:71], v5 offset:1024
ds_read_b128 v[72:75], v5 offset:2048
ds_read_b128 v[76:79], v5 offset:3072
s_waitcnt lgkmcnt(3)
v_mfma_f32_16x16x32_bf16 v[32:35], a[0:3], v[64:67], 0
v_mfma_f32_16x16x32_bf16 v[36:39], a[64:67], v[64:67], 0
ds_read_b128 v[64:67], v5 offset:4096
s_waitcnt lgkmcnt(3)
v_mfma_f32_16x16x32_bf16 v[32:35], a[4:7], v[68:71], v[32:35]
v_mfma_f32_16x16x32_bf16 v[36:39], a[68:71], v[68:71], v[36:39]
ds_read_b128 v[68:71], v5 offset:5120
s_waitcnt lgkmcnt(3)
v_mfma_f32_16x16x32_bf16 v[32:35], a[8:11], v[72:75], v[32:35]
v_mfma_f32_16x16x32_bf16 v[36:39], a[72:75], v[72:75], v[36:39]
ds_read_b128 v[72:75], v5 offset:6144
s_waitcnt lgkmcnt(3)
v_mfma_f32_16x16x32_bf16 v[32:35], a[12:15], v[76:79], v[32:35]
v_mfma_f32_16x16x32_bf16 v[36:39], a[76:79], v[76:79], v[36:39]
ds_read_b128 v[76:79], v5 offset:7168
s_waitcnt lgkmcnt(3)
v_mfma_f32_16x16x32_bf16 v[32:35], a[16:19], v[64:67], v[32:35]
v_mfma_f32_16x16x32_bf16 v[36:39], a[80:83], v[64:67], v[36:39]
ds_read_b128 v[64:67], v5 offset:8192
s_waitcnt lgkmcnt(3)
v_mfma_f32_16x16x32_bf16 v[32:35], a[20:23], v[68:71], v[32:35]
v_mfma_f32_16x16x32_bf16 v[36:39], a[84:87], v[68:71], v[36:39]
ds_read_b128 v[68:71], v5 offset:9216
s_waitcnt lgkmcnt(3)
v_mfma_f32_16x16x32_bf16 v[32:35], a[24:27], v[72:75], v[32:35]
v_mfma_f32_16x16x32_bf16 v[36:39], a[88:91], v[72:75], v[36:39]
ds_read_b128 v[72:75], v5 offset:10240
s_waitcnt lgkmcnt(3)
v_mfma_f32_16x16x32_bf16 v[32:35], a[28:31], v[76:79], v[32:35]
v_mfma_f32_16x16x32_bf16 v[36:39], a[92:95], v[76:79], v[36:39]
ds_read_b128 v[76:79], v5 offset:11264
s_waitcnt lgkmcnt(3)
v_mfma_f32_16x16x32_bf16 v[32:35], a[32:35], v[64:67], v[32:35]
v_mfma_f32_16x16x32_bf16 v[36:39], a[96:99], v[64:67], v[36:39]
ds_read_b128 v[64:67], v5 offset:12288
s_waitcnt lgkmcnt(3)
v_mfma_f32_16x16x32_bf16 v[32:35], a[36:39], v[68:71], v[32:35]
v_mfma_f32_16x16x32_bf16 v[36:39], a[100:103], v[68:71], v[36:39]
ds_read_b128 v[68:71], v5 offset:13312
s_waitcnt lgkmcnt(3)
v_mfma_f32_16x16x32_bf16 v[32:35], a[40:43], v[72:75], v[32:35]
v_mfma_f32_16x16x32_bf16 v[36:39], a[104:107], v[72:75], v[36:39]
ds_read_b128 v[72:75], v5 offset:14336
s_waitcnt lgkmcnt(3)
v_mfma_f32_16x16x32_bf16 v[32:35], a[44:47], v[76:79], v[32:35]
v_mfma_f32_16x16x32_bf16 v[36:39], a[108:111], v[76:79], v[36:39]
ds_read_b128 v[76:79], v5 offset:15360
s_waitcnt lgkmcnt(3)
v_mfma_f32_16x16x32_bf16 v[32:35], a[48:51], v[64:67], v[32:35]
v_mfma_f32_16x16x32_bf16 v[36:39], a[112:115], v[64:67], v[36:39]
ds_read_b128 v[64:67], v5 offset:16384
s_waitcnt lgkmcnt(3)
v_mfma_f32_16x16x32_bf16 v[32:35], a[52:55], v[68:71], v[32:35]
v_mfma_f32_16x16x32_bf16 v[36:39], a[116:119], v[68:71], v[36:39]
ds_read_b128 v[68:71], v5 offset:17408
s_waitcnt lgkmcnt(3)
v_mfma_f32_16x16x32_bf16 v[32:35], a[56:59], v[72:75], v[32:35]
v_mfma_f32_16x16x32_bf16 v[36:39], a[120:123], v[72:75], v[36:39]
ds_read_b128 v[72:75], v5 offset:18432
s_waitcnt lgkmcnt(3)
v_mfma_f32_16x16x32_bf16 v[32:35], a[60:63], v[76:79], v[32:35]
v_mfma_f32_16x16x32_bf16 v[36:39], a[124:127], v[76:79], v[36:39]
ds_read_b128 v[76:79], v5 offset:19456
s_waitcnt lgkmcnt(3)
v_mfma_f32_16x16x32_bf16 v[40:43], a[0:3], v[64:67], 0
v_mfma_f32_16x16x32_bf16 v[44:47], a[64:67], v[64:67], 0
ds_read_b128 v[64:67], v5 offset:20480
s_waitcnt lgkmcnt(3)
v_mfma_f32_16x16x32_bf16 v[40:43], a[4:7], v[68:71], v[40:43]
v_mfma_f32_16x16x32_bf16 v[44:47], a[68:71], v[68:71], v[44:47]
ds_read_b128 v[68:71], v5 offset:21504
s_waitcnt lgkmcnt(3)
v_mfma_f32_16x16x32_bf16 v[40:43], a[8:11], v[72:75], v[40:43]
v_mfma_f32_16x16x32_bf16 v[44:47], a[72:75], v[72:75], v[44:47]
ds_read_b128 v[72:75], v5 offset:22528
s_waitcnt lgkmcnt(3)
v_mfma_f32_16x16x32_bf16 v[40:43], a[12:15], v[76:79], v[40:43]
v_mfma_f32_16x16x32_bf16 v[44:47], a[76:79], v[76:79], v[44:47]
ds_read_b128 v[76:79], v5 offset:23552
s_waitcnt lgkmcnt(3)
v_mfma_f32_16x16x32_bf16 v[40:43], a[16:19], v[64:67], v[40:43]
v_mfma_f32_16x16x32_bf16 v[44:47], a[80:83], v[64:67], v[44:47]
ds_read_b128 v[64:67], v5 offset:24576
s_waitcnt lgkmcnt(3)
v_mfma_f32_16x16x32_bf16 v[40:43], a[20:23], v[68:71], v[40:43]
v_mfma_f32_16x16x32_bf16 v[44:47], a[84:87], v[68:71], v[44:47]
ds_read_b128 v[68:71], v5 offset:25600
s_waitcnt lgkmcnt(3)
v_mfma_f32_16x16x32_bf16 v[40:43], a[24:27], v[72:75], v[40:43]
v_mfma_f32_16x16x32_bf16 v[44:47], a[88:91], v[72:75], v[44:47]
ds_read_b128 v[72:75], v5 offset:26624
s_waitcnt lgkmcnt(3)
v_mfma_f32_16x16x32_bf16 v[40:43], a[28:31], v[76:79], v[40:43]
v_mfma_f32_16x16x32_bf16 v[44:47], a[92:95], v[76:79], v[44:47]
ds_read_b128 v[76:79], v5 offset:27648
s_waitcnt lgkmcnt(3)
v_mfma_f32_16x16x32_bf16 v[40:43], a[32:35], v[64:67], v[40:43]
v_mfma_f32_16x16x32_bf16 v[44:47], a[96:99], v[64:67], v[44:47]
ds_read_b128 v[64:67], v5 offset:28672
s_waitcnt lgkmcnt(3)
v_mfma_f32_16x16x32_bf16 v[40:43], a[36:39], v[68:71], v[40:43]
v_mfma_f32_16x16x32_bf16 v[44:47], a[100:103], v[68:71], v[44:47]
ds_read_b128 v[68:71], v5 offset:29696
s_waitcnt lgkmcnt(3)
v_mfma_f32_16x16x32_bf16 v[40:43], a[40:43], v[72:75], v[40:43]
v_mfma_f32_16x16x32_bf16 v[44:47], a[104:107], v[72:75], v[44:47]
ds_read_b128 v[72:75], v5 offset:30720
s_waitcnt lgkmcnt(3)
v_mfma_f32_16x16x32_bf16 v[40:43], a[44:47], v[76:79], v[40:43]
v_mfma_f32_16x16x32_bf16 v[44:47], a[108:111], v[76:79], v[44:47]
ds_read_b128 v[76:79], v5 offset:31744
s_waitcnt lgkmcnt(3)
v_mfma_f32_16x16x32_bf16 v[40:43], a[48:51], v[64:67], v[40:43]
v_mfma_f32_16x16x32_bf16 v[44:47], a[112:115], v[64:67], v[44:47]
s_waitcnt lgkmcnt(2)
v_mfma_f32_16x16x32_bf16 v[40:43], a[52:55], v[68:71], v[40:43]
v_mfma_f32_16x16x32_bf16 v[44:47], a[116:119], v[68:71], v[44:47]
s_waitcnt lgkmcnt(1)
v_mfma_f32_16x16x32_bf16 v[40:43], a[56:59], v[72:75], v[40:43]
v_mfma_f32_16x16x32_bf16 v[44:47], a[120:123], v[72:75], v[44:47]
s_waitcnt lgkmcnt(0)
v_mfma_f32_16x16x32_bf16 v[40:43], a[60:63], v[76:79], v[40:43]
v_mfma_f32_16x16x32_bf16 v[44:47], a[124:127], v[76:79], v[44:47]
v_xor_b32 v5, 0x8000, v5
v_cvt_pk_bf16_f32 v64, v32, v33
v_cvt_pk_bf16_f32 v65, v34, v35
v_cvt_pk_bf16_f32 v66, v36, v37
v_cvt_pk_bf16_f32 v67, v38, v39
ds_write_b128 v6, v[64:67] offset:0
v_cvt_pk_bf16_f32 v68, v40, v41
v_cvt_pk_bf16_f32 v69, v42, v43
v_cvt_pk_bf16_f32 v70, v44, v45
v_cvt_pk_bf16_f32 v71, v46, v47
ds_write_b128 v6, v[68:71] offset:4096
s_waitcnt lgkmcnt(0)
s_barrier
ds_read_b128 v[128:131], v7 offset:0
ds_read_b128 v[132:135], v7 offset:1024
ds_read_b128 v[136:139], v7 offset:2048
ds_read_b128 v[140:143], v7 offset:3072
ds_read_b128 v[144:147], v7 offset:4096
ds_read_b128 v[148:151], v7 offset:5120
ds_read_b128 v[152:155], v7 offset:6144
ds_read_b128 v[156:159], v7 offset:7168
s_cmp_lt_u32 s56, 31
s_cbranch_scc1 L_anp_51_a
s_waitcnt vmcnt(0)
L_anp_51_a:
s_waitcnt vmcnt(8) lgkmcnt(0)
v_mfma_f32_16x16x32_bf16 v[188:191], v[80:83], v[128:131], 0
v_mfma_f32_16x16x32_bf16 v[192:195], v[80:83], v[144:147], 0
v_mfma_f32_16x16x32_bf16 v[196:199], v[96:99], v[144:147], 0
v_mfma_f32_16x16x32_bf16 v[188:191], v[84:87], v[132:135], v[188:191]
v_mfma_f32_16x16x32_bf16 v[192:195], v[84:87], v[148:151], v[192:195]
v_mfma_f32_16x16x32_bf16 v[196:199], v[100:103], v[148:151], v[196:199]
v_mfma_f32_16x16x32_bf16 v[188:191], v[88:91], v[136:139], v[188:191]
v_mfma_f32_16x16x32_bf16 v[192:195], v[88:91], v[152:155], v[192:195]
v_mfma_f32_16x16x32_bf16 v[196:199], v[104:107], v[152:155], v[196:199]
v_mfma_f32_16x16x32_bf16 v[188:191], v[92:95], v[140:143], v[188:191]
v_mfma_f32_16x16x32_bf16 v[192:195], v[92:95], v[156:159], v[192:195]
v_mfma_f32_16x16x32_bf16 v[196:199], v[108:111], v[156:159], v[196:199]
s_lshl_b32 s36, s56, 1
s_add_u32 s36, s36, s42
s_add_u32 s36, s36, 1
s_add_u32 s37, s56, 2
s_min_u32 s37, s37, 32
v_mov_b32 v28, s37
v_mov_b32 v22, s36
v_cndmask_b32 v28, v28, v22, s[70:71]
s_cmp_eq_u32 s32, 0
s_cbranch_scc0 L_wgw_52
s_mov_b32 s98, 0
L_poll_53:
global_load_dword v16, v15, s[30:31] offset:0 sc1
s_waitcnt vmcnt(0)
v_cmp_gt_u32 vcc, v28, v16
s_cbranch_vccz L_polld_54
s_add_u32 s98, s98, 1
s_cmp_lt_u32 s98, 200000
s_cbranch_scc1 L_poll_53
s_mov_b32 s99, 32
s_branch L_fail
L_polld_54:
L_wgw_52:
s_barrier
global_load_dwordx4 v[160:163], v8, s[46:47] sc1
global_load_dwordx4 v[164:167], v8, s[46:47] offset:2048 sc1
global_load_dwordx4 v[168:171], v9, s[46:47] sc1
global_load_dwordx4 v[172:175], v9, s[46:47] offset:2048 sc1
global_load_dwordx2 v[176:177], v13, s[46:47] sc1
v_mov_b32 v22, 0xff7fffff
v_cndmask_b32 v188, v22, v188, s[60:61]
v_cndmask_b32 v196, v22, v196, s[60:61]
v_mov_b32 v22, 0xff7fffff
v_cndmask_b32 v189, v22, v189, s[62:63]
v_cndmask_b32 v197, v22, v197, s[62:63]
v_mov_b32 v22, 0xff7fffff
v_cndmask_b32 v190, v22, v190, s[64:65]
v_cndmask_b32 v198, v22, v198, s[64:65]
v_mov_b32 v22, 0xff7fffff
v_cndmask_b32 v191, v22, v191, s[66:67]
v_cndmask_b32 v199, v22, v199, s[66:67]
v_max3_f32 v24, v188, v189, v190
v_max3_f32 v25, v192, v193, v194
v_max3_f32 v25, v25, v195, v196
v_max3_f32 v25, v25, v197, v198
v_max_f32 v24, v24, v191
v_max_f32 v25, v25, v199
s_waitcnt vmcnt(4)
v_mfma_f32_16x16x32_bf16 v[180:183], v[160:163], v[128:131], 0
v_mfma_f32_16x16x32_bf16 v[184:187], v[160:163], v[144:147], 0
s_waitcnt vmcnt(3)
v_mfma_f32_16x16x32_bf16 v[180:183], v[164:167], v[132:135], v[180:183]
v_mfma_f32_16x16x32_bf16 v[184:187], v[164:167], v[148:151], v[184:187]
s_waitcnt vmcnt(2)
v_mfma_f32_16x16x32_bf16 v[180:183], v[168:171], v[136:139], v[180:183]
v_mfma_f32_16x16x32_bf16 v[184:187], v[168:171], v[152:155], v[184:187]
s_waitcnt vmcnt(1)
v_mfma_f32_16x16x32_bf16 v[180:183], v[172:175], v[140:143], v[180:183]
v_mfma_f32_16x16x32_bf16 v[184:187], v[172:175], v[156:159], v[184:187]
s_nop 3
v_max3_f32 v24, v24, v180, v181
s_nop 2
v_max3_f32 v25, v25, v184, v185
v_mov_b32 v22, v24
v_mov_b32 v23, v25
s_nop 0
v_permlane16_swap_b32 v24, v22
v_permlane16_swap_b32 v25, v23
v_max_f32 v24, v24, v22
v_max_f32 v25, v25, v23
v_mov_b32 v22, v24
v_mov_b32 v23, v25
s_nop 0
v_permlane32_swap_b32 v24, v22
v_permlane32_swap_b32 v25, v23
v_max_f32 v24, v24, v22
v_max_f32 v25, v25, v23
v_mul_f32 v24, v21, v24
v_mul_f32 v25, v21, v25
v_fma_f32 v180, v180, v21, -v24
v_fma_f32 v181, v181, v21, -v24
v_fma_f32 v188, v188, v21, -v24
v_fma_f32 v189, v189, v21, -v24
v_fma_f32 v190, v190, v21, -v24
v_fma_f32 v191, v191, v21, -v24
v_fma_f32 v184, v184, v21, -v25
v_fma_f32 v185, v185, v21, -v25
v_fma_f32 v192, v192, v21, -v25
v_fma_f32 v193, v193, v21, -v25
v_fma_f32 v194, v194, v21, -v25
v_fma_f32 v195, v195, v21, -v25
v_fma_f32 v196, v196, v21, -v25
v_fma_f32 v197, v197, v21, -v25
v_fma_f32 v198, v198, v21, -v25
v_fma_f32 v199, v199, v21, -v25
v_exp_f32 v180, v180
v_exp_f32 v181, v181
v_exp_f32 v188, v188
v_exp_f32 v189, v189
v_exp_f32 v190, v190
v_exp_f32 v191, v191
v_exp_f32 v184, v184
v_exp_f32 v185, v185
v_exp_f32 v192, v192
v_exp_f32 v193, v193
v_exp_f32 v194, v194
v_exp_f32 v195, v195
v_exp_f32 v196, v196
v_exp_f32 v197, v197
v_exp_f32 v198, v198
v_exp_f32 v199, v199
v_cvt_pk_bf16_f32 v200, v188, v189
v_cvt_pk_bf16_f32 v201, v190, v191
v_cvt_pk_bf16_f32 v204, v192, v193
v_cvt_pk_bf16_f32 v205, v194, v195
v_cvt_pk_bf16_f32 v206, v196, v197
v_cvt_pk_bf16_f32 v207, v198, v199
v_cvt_pk_bf16_f32 v208, v180, v181
v_cvt_pk_bf16_f32 v211, v180, v181
v_cvt_pk_bf16_f32 v212, v184, v185
v_cvt_pk_bf16_f32 v215, v184, v185
s_waitcnt vmcnt(0)
v_mfma_f32_16x16x32_bf16 v[220:223], v[216:219], v[200:203], 0
v_mfma_f32_16x16x32_bf16 v[228:231], v[112:115], v[200:203], 0
v_mfma_f32_16x16x32_bf16 v[232:235], v[116:119], v[200:203], 0
v_mfma_f32_16x16x16_bf16 v[220:223], v[216:217], v[208:209], v[220:223]
v_mfma_f32_16x16x16_bf16 v[228:231], v[176:177], v[208:209], v[228:231]
v_mfma_f32_16x16x16_bf16 v[232:235], v[176:177], v[210:211], v[232:235]
v_mfma_f32_16x16x32_bf16 v[224:227], v[216:219], v[204:207], 0
v_mfma_f32_16x16x32_bf16 v[236:239], v[112:115], v[204:207], 0
v_mfma_f32_16x16x32_bf16 v[240:243], v[116:119], v[204:207], 0
v_mfma_f32_16x16x16_bf16 v[224:227], v[216:217], v[212:213], v[224:227]
v_mfma_f32_16x16x16_bf16 v[236:239], v[176:177], v[212:213], v[236:239]
v_mfma_f32_16x16x16_bf16 v[240:243], v[176:177], v[214:215], v[240:243]
v_rcp_f32 v220, v220
s_nop 0
v_pk_mul_f32 v[228:229], v[228:229], v[220:221] op_sel_hi:[1,0]
v_cvt_pk_bf16_f32 v244, v228, v229
v_pk_mul_f32 v[230:231], v[230:231], v[220:221] op_sel_hi:[1,0]
v_cvt_pk_bf16_f32 v245, v230, v231
v_pk_mul_f32 v[232:233], v[232:233], v[220:221] op_sel_hi:[1,0]
v_cvt_pk_bf16_f32 v246, v232, v233
v_pk_mul_f32 v[234:235], v[234:235], v[220:221] op_sel_hi:[1,0]
v_cvt_pk_bf16_f32 v247, v234, v235
v_rcp_f32 v224, v224
s_nop 0
v_pk_mul_f32 v[236:237], v[236:237], v[224:225] op_sel_hi:[1,0]
v_cvt_pk_bf16_f32 v248, v236, v237
v_pk_mul_f32 v[238:239], v[238:239], v[224:225] op_sel_hi:[1,0]
v_cvt_pk_bf16_f32 v249, v238, v239
v_pk_mul_f32 v[240:241], v[240:241], v[224:225] op_sel_hi:[1,0]
v_cvt_pk_bf16_f32 v250, v240, v241
v_pk_mul_f32 v[242:243], v[242:243], v[224:225] op_sel_hi:[1,0]
v_cvt_pk_bf16_f32 v251, v242, v243
global_store_dwordx4 v2, v[244:247], s[48:49] sc1
global_store_dwordx4 v14, v[248:251], s[48:49] sc1
s_add_u32 s44, s44, 1048576
s_addc_u32 s45, s45, 0
s_add_u32 s46, s46, 524288
s_addc_u32 s47, s47, 0
s_add_u32 s48, s48, 524288
s_addc_u32 s49, s49, 0
s_add_u32 s56, s56, 1
s_cmp_lt_u32 s56, 32
s_cbranch_scc0 L_aend_55
global_load_dwordx4 v[80:83], v8, s[44:45] sc1
global_load_dwordx4 v[96:99], v8, s[44:45] offset:1024 sc1
global_load_dwordx4 v[84:87], v9, s[44:45] sc1
global_load_dwordx4 v[100:103], v9, s[44:45] offset:1024 sc1
global_load_dwordx4 v[88:91], v10, s[44:45] sc1
global_load_dwordx4 v[104:107], v10, s[44:45] offset:1024 sc1
global_load_dwordx4 v[92:95], v11, s[44:45] sc1
global_load_dwordx4 v[108:111], v11, s[44:45] offset:1024 sc1
global_load_dwordx4 v[112:115], v12, s[44:45] offset:2048 sc1
global_load_dwordx4 v[116:119], v12, s[44:45] offset:3072 sc1
s_waitcnt vmcnt(10)
s_barrier
s_cmp_eq_u32 s32, 0
s_cbranch_scc0 L_att_50
v_mov_b32 v22, s56
s_mov_b64 exec, 0xff
global_store_dword v20, v22, s[30:31] sc1
s_mov_b64 exec, -1
s_branch L_att_50
L_aend_55:
s_waitcnt vmcnt(0)
s_barrier
s_cmp_eq_u32 s32, 0
s_cbranch_scc0 L_end
v_mov_b32 v22, 32
s_mov_b64 exec, 0xff
global_store_dword v20, v22, s[30:31] sc1
s_endpgm
L_wo:
s_lshr_b32 s41, s34, 4
s_and_b32 s42, s34, 15
v_and_b32 v1, 63, v0
v_lshlrev_b32 v2, 4, v1
s_cmp_eq_u32 s32, 0
s_cbranch_scc0 L_wgw_56
s_lshl_b32 s36, s42, 7
s_add_u32 s36, s36, 8192
v_mov_b32 v3, s36
s_mov_b32 s98, 0
L_poll_57:
global_load_dword v4, v3, s[30:31] offset:0 sc1
s_waitcnt vmcnt(0)
v_cmp_gt_u32 vcc, 1, v4
s_cbranch_vccz L_polld_58
s_add_u32 s98, s98, 1
s_cmp_lt_u32 s98, 200000
s_cbranch_scc1 L_poll_57
s_mov_b32 s99, 42
s_branch L_fail
L_polld_58:
L_wgw_56:
s_barrier
v_lshrrev_b32 v13, 2, v1
v_lshlrev_b32 v13, 10, v13
v_and_b32 v14, 3, v1
v_lshl_add_u32 v13, v14, 4, v13
s_lshl_b32 s36, s42, 6
v_add_u32 v13, s36, v13
s_lshl_b32 s40, s32, 15
v_bfe_u32 v14, v1, 4, 2
v_bfe_u32 v12, v1, 2, 2
v_lshl_add_u32 v12, v14, 2, v12
v_lshlrev_b32 v12, 6, v12
v_and_b32 v14, 3, v1
v_lshl_add_u32 v12, v14, 4, v12
v_add_u32 v12, s40, v12
s_lshl_b32 s36, s32, 20
s_add_u32 s36, s36, 0
v_add_u32 v11, s36, v13
s_add_u32 m0, s40, 0
s_nop 0
global_load_lds_dwordx4 v11, s[14:15]
v_add_u32 v11, 16384, v11
s_add_u32 m0, s40, 1024
s_nop 0
global_load_lds_dwordx4 v11, s[14:15]
v_add_u32 v11, 16384, v11
s_add_u32 m0, s40, 2048
s_nop 0
global_load_lds_dwordx4 v11, s[14:15]
v_add_u32 v11, 16384, v11
s_add_u32 m0, s40, 3072
s_nop 0
global_load_lds_dwordx4 v11, s[14:15]
v_add_u32 v11, 16384, v11
s_add_u32 m0, s40, 4096
s_nop 0
global_load_lds_dwordx4 v11, s[14:15]
v_add_u32 v11, 16384, v11
s_add_u32 m0, s40, 5120
s_nop 0
global_load_lds_dwordx4 v11, s[14:15]
v_add_u32 v11, 16384, v11
s_add_u32 m0, s40, 6144
s_nop 0
global_load_lds_dwordx4 v11, s[14:15]
v_add_u32 v11, 16384, v11
s_add_u32 m0, s40, 7168
s_nop 0
global_load_lds_dwordx4 v11, s[14:15]
v_add_u32 v11, 16384, v11
s_add_u32 m0, s40, 8192
s_nop 0
global_load_lds_dwordx4 v11, s[14:15]
v_add_u32 v11, 16384, v11
s_add_u32 m0, s40, 9216
s_nop 0
global_load_lds_dwordx4 v11, s[14:15]
v_add_u32 v11, 16384, v11
s_add_u32 m0, s40, 10240
s_nop 0
global_load_lds_dwordx4 v11, s[14:15]
v_add_u32 v11, 16384, v11
s_add_u32 m0, s40, 11264
s_nop 0
global_load_lds_dwordx4 v11, s[14:15]
v_add_u32 v11, 16384, v11
s_add_u32 m0, s40, 12288
s_nop 0
global_load_lds_dwordx4 v11, s[14:15]
v_add_u32 v11, 16384, v11
s_add_u32 m0, s40, 13312
s_nop 0
global_load_lds_dwordx4 v11, s[14:15]
v_add_u32 v11, 16384, v11
s_add_u32 m0, s40, 14336
s_nop 0
global_load_lds_dwordx4 v11, s[14:15]
v_add_u32 v11, 16384, v11
s_add_u32 m0, s40, 15360
s_nop 0
global_load_lds_dwordx4 v11, s[14:15]
v_add_u32 v11, 16384, v11
s_add_u32 m0, s40, 16384
s_nop 0
global_load_lds_dwordx4 v11, s[14:15]
v_add_u32 v11, 16384, v11
s_add_u32 m0, s40, 17408
s_nop 0
global_load_lds_dwordx4 v11, s[14:15]
v_add_u32 v11, 16384, v11
s_add_u32 m0, s40, 18432
s_nop 0
global_load_lds_dwordx4 v11, s[14:15]
v_add_u32 v11, 16384, v11
s_add_u32 m0, s40, 19456
s_nop 0
global_load_lds_dwordx4 v11, s[14:15]
v_add_u32 v11, 16384, v11
s_add_u32 m0, s40, 20480
s_nop 0
global_load_lds_dwordx4 v11, s[14:15]
v_add_u32 v11, 16384, v11
s_add_u32 m0, s40, 21504
s_nop 0
global_load_lds_dwordx4 v11, s[14:15]
v_add_u32 v11, 16384, v11
s_add_u32 m0, s40, 22528
s_nop 0
global_load_lds_dwordx4 v11, s[14:15]
v_add_u32 v11, 16384, v11
s_add_u32 m0, s40, 23552
s_nop 0
global_load_lds_dwordx4 v11, s[14:15]
v_add_u32 v11, 16384, v11
s_add_u32 m0, s40, 24576
s_nop 0
global_load_lds_dwordx4 v11, s[14:15]
v_add_u32 v11, 16384, v11
s_add_u32 m0, s40, 25600
s_nop 0
global_load_lds_dwordx4 v11, s[14:15]
v_add_u32 v11, 16384, v11
s_add_u32 m0, s40, 26624
s_nop 0
global_load_lds_dwordx4 v11, s[14:15]
v_add_u32 v11, 16384, v11
s_add_u32 m0, s40, 27648
s_nop 0
global_load_lds_dwordx4 v11, s[14:15]
v_add_u32 v11, 16384, v11
s_add_u32 m0, s40, 28672
s_nop 0
global_load_lds_dwordx4 v11, s[14:15]
v_add_u32 v11, 16384, v11
s_add_u32 m0, s40, 29696
s_nop 0
global_load_lds_dwordx4 v11, s[14:15]
v_add_u32 v11, 16384, v11
s_add_u32 m0, s40, 30720
s_nop 0
global_load_lds_dwordx4 v11, s[14:15]
v_add_u32 v11, 16384, v11
s_add_u32 m0, s40, 31744
s_nop 0
global_load_lds_dwordx4 v11, s[14:15]
s_waitcnt vmcnt(0)
ds_read_b64_tr_b16 a[0:1], v12 offset:0
ds_read_b64_tr_b16 a[2:3], v12 offset:1024
ds_read_b64_tr_b16 a[4:5], v12 offset:8
ds_read_b64_tr_b16 a[6:7], v12 offset:1032
ds_read_b64_tr_b16 a[8:9], v12 offset:2048
ds_read_b64_tr_b16 a[10:11], v12 offset:3072
ds_read_b64_tr_b16 a[12:13], v12 offset:2056
ds_read_b64_tr_b16 a[14:15], v12 offset:3080
ds_read_b64_tr_b16 a[16:17], v12 offset:4096
ds_read_b64_tr_b16 a[18:19], v12 offset:5120
ds_read_b64_tr_b16 a[20:21], v12 offset:4104
ds_read_b64_tr_b16 a[22:23], v12 offset:5128
s_waitcnt lgkmcnt(0)
ds_read_b64_tr_b16 a[24:25], v12 offset:6144
ds_read_b64_tr_b16 a[26:27], v12 offset:7168
ds_read_b64_tr_b16 a[28:29], v12 offset:6152
ds_read_b64_tr_b16 a[30:31], v12 offset:7176
ds_read_b64_tr_b16 a[32:33], v12 offset:8192
ds_read_b64_tr_b16 a[34:35], v12 offset:9216
ds_read_b64_tr_b16 a[36:37], v12 offset:8200
ds_read_b64_tr_b16 a[38:39], v12 offset:9224
ds_read_b64_tr_b16 a[40:41], v12 offset:10240
ds_read_b64_tr_b16 a[42:43], v12 offset:11264
ds_read_b64_tr_b16 a[44:45], v12 offset:10248
ds_read_b64_tr_b16 a[46:47], v12 offset:11272
s_waitcnt lgkmcnt(0)
ds_read_b64_tr_b16 a[48:49], v12 offset:12288
ds_read_b64_tr_b16 a[50:51], v12 offset:13312
ds_read_b64_tr_b16 a[52:53], v12 offset:12296
ds_read_b64_tr_b16 a[54:55], v12 offset:13320
ds_read_b64_tr_b16 a[56:57], v12 offset:14336
ds_read_b64_tr_b16 a[58:59], v12 offset:15360
ds_read_b64_tr_b16 a[60:61], v12 offset:14344
ds_read_b64_tr_b16 a[62:63], v12 offset:15368
ds_read_b64_tr_b16 a[64:65], v12 offset:16384
ds_read_b64_tr_b16 a[66:67], v12 offset:17408
ds_read_b64_tr_b16 a[68:69], v12 offset:16392
ds_read_b64_tr_b16 a[70:71], v12 offset:17416
s_waitcnt lgkmcnt(0)
ds_read_b64_tr_b16 a[72:73], v12 offset:18432
ds_read_b64_tr_b16 a[74:75], v12 offset:19456
ds_read_b64_tr_b16 a[76:77], v12 offset:18440
ds_read_b64_tr_b16 a[78:79], v12 offset:19464
ds_read_b64_tr_b16 a[80:81], v12 offset:20480
ds_read_b64_tr_b16 a[82:83], v12 offset:21504
ds_read_b64_tr_b16 a[84:85], v12 offset:20488
ds_read_b64_tr_b16 a[86:87], v12 offset:21512
ds_read_b64_tr_b16 a[88:89], v12 offset:22528
ds_read_b64_tr_b16 a[90:91], v12 offset:23552
ds_read_b64_tr_b16 a[92:93], v12 offset:22536
ds_read_b64_tr_b16 a[94:95], v12 offset:23560
s_waitcnt lgkmcnt(0)
ds_read_b64_tr_b16 a[96:97], v12 offset:24576
ds_read_b64_tr_b16 a[98:99], v12 offset:25600
ds_read_b64_tr_b16 a[100:101], v12 offset:24584
ds_read_b64_tr_b16 a[102:103], v12 offset:25608
ds_read_b64_tr_b16 a[104:105], v12 offset:26624
ds_read_b64_tr_b16 a[106:107], v12 offset:27648
ds_read_b64_tr_b16 a[108:109], v12 offset:26632
ds_read_b64_tr_b16 a[110:111], v12 offset:27656
ds_read_b64_tr_b16 a[112:113], v12 offset:28672
ds_read_b64_tr_b16 a[114:115], v12 offset:29696
ds_read_b64_tr_b16 a[116:117], v12 offset:28680
ds_read_b64_tr_b16 a[118:119], v12 offset:29704
s_waitcnt lgkmcnt(0)
ds_read_b64_tr_b16 a[120:121], v12 offset:30720
ds_read_b64_tr_b16 a[122:123], v12 offset:31744
ds_read_b64_tr_b16 a[124:125], v12 offset:30728
ds_read_b64_tr_b16 a[126:127], v12 offset:31752
s_waitcnt lgkmcnt(0)
s_lshl_b32 s36, s32, 20
s_add_u32 s36, s36, 524288
v_add_u32 v11, s36, v13
s_add_u32 m0, s40, 0
s_nop 0
global_load_lds_dwordx4 v11, s[14:15]
v_add_u32 v11, 16384, v11
s_add_u32 m0, s40, 1024
s_nop 0
global_load_lds_dwordx4 v11, s[14:15]
v_add_u32 v11, 16384, v11
s_add_u32 m0, s40, 2048
s_nop 0
global_load_lds_dwordx4 v11, s[14:15]
v_add_u32 v11, 16384, v11
s_add_u32 m0, s40, 3072
s_nop 0
global_load_lds_dwordx4 v11, s[14:15]
v_add_u32 v11, 16384, v11
s_add_u32 m0, s40, 4096
s_nop 0
global_load_lds_dwordx4 v11, s[14:15]
v_add_u32 v11, 16384, v11
s_add_u32 m0, s40, 5120
s_nop 0
global_load_lds_dwordx4 v11, s[14:15]
v_add_u32 v11, 16384, v11
s_add_u32 m0, s40, 6144
s_nop 0
global_load_lds_dwordx4 v11, s[14:15]
v_add_u32 v11, 16384, v11
s_add_u32 m0, s40, 7168
s_nop 0
global_load_lds_dwordx4 v11, s[14:15]
v_add_u32 v11, 16384, v11
s_add_u32 m0, s40, 8192
s_nop 0
global_load_lds_dwordx4 v11, s[14:15]
v_add_u32 v11, 16384, v11
s_add_u32 m0, s40, 9216
s_nop 0
global_load_lds_dwordx4 v11, s[14:15]
v_add_u32 v11, 16384, v11
s_add_u32 m0, s40, 10240
s_nop 0
global_load_lds_dwordx4 v11, s[14:15]
v_add_u32 v11, 16384, v11
s_add_u32 m0, s40, 11264
s_nop 0
global_load_lds_dwordx4 v11, s[14:15]
v_add_u32 v11, 16384, v11
s_add_u32 m0, s40, 12288
s_nop 0
global_load_lds_dwordx4 v11, s[14:15]
v_add_u32 v11, 16384, v11
s_add_u32 m0, s40, 13312
s_nop 0
global_load_lds_dwordx4 v11, s[14:15]
v_add_u32 v11, 16384, v11
s_add_u32 m0, s40, 14336
s_nop 0
global_load_lds_dwordx4 v11, s[14:15]
v_add_u32 v11, 16384, v11
s_add_u32 m0, s40, 15360
s_nop 0
global_load_lds_dwordx4 v11, s[14:15]
v_add_u32 v11, 16384, v11
s_add_u32 m0, s40, 16384
s_nop 0
global_load_lds_dwordx4 v11, s[14:15]
v_add_u32 v11, 16384, v11
s_add_u32 m0, s40, 17408
s_nop 0
global_load_lds_dwordx4 v11, s[14:15]
v_add_u32 v11, 16384, v11
s_add_u32 m0, s40, 18432
s_nop 0
global_load_lds_dwordx4 v11, s[14:15]
v_add_u32 v11, 16384, v11
s_add_u32 m0, s40, 19456
s_nop 0
global_load_lds_dwordx4 v11, s[14:15]
v_add_u32 v11, 16384, v11
s_add_u32 m0, s40, 20480
s_nop 0
global_load_lds_dwordx4 v11, s[14:15]
v_add_u32 v11, 16384, v11
s_add_u32 m0, s40, 21504
s_nop 0
global_load_lds_dwordx4 v11, s[14:15]
v_add_u32 v11, 16384, v11
s_add_u32 m0, s40, 22528
s_nop 0
global_load_lds_dwordx4 v11, s[14:15]
v_add_u32 v11, 16384, v11
s_add_u32 m0, s40, 23552
s_nop 0
global_load_lds_dwordx4 v11, s[14:15]
v_add_u32 v11, 16384, v11
s_add_u32 m0, s40, 24576
s_nop 0
global_load_lds_dwordx4 v11, s[14:15]
v_add_u32 v11, 16384, v11
s_add_u32 m0, s40, 25600
s_nop 0
global_load_lds_dwordx4 v11, s[14:15]
v_add_u32 v11, 16384, v11
s_add_u32 m0, s40, 26624
s_nop 0
global_load_lds_dwordx4 v11, s[14:15]
v_add_u32 v11, 16384, v11
s_add_u32 m0, s40, 27648
s_nop 0
global_load_lds_dwordx4 v11, s[14:15]
v_add_u32 v11, 16384, v11
s_add_u32 m0, s40, 28672
s_nop 0
global_load_lds_dwordx4 v11, s[14:15]
v_add_u32 v11, 16384, v11
s_add_u32 m0, s40, 29696
s_nop 0
global_load_lds_dwordx4 v11, s[14:15]
v_add_u32 v11, 16384, v11
s_add_u32 m0, s40, 30720
s_nop 0
global_load_lds_dwordx4 v11, s[14:15]
v_add_u32 v11, 16384, v11
s_add_u32 m0, s40, 31744
s_nop 0
global_load_lds_dwordx4 v11, s[14:15]
s_waitcnt vmcnt(0)
ds_read_b64_tr_b16 a[128:129], v12 offset:0
ds_read_b64_tr_b16 a[130:131], v12 offset:1024
ds_read_b64_tr_b16 a[132:133], v12 offset:8
ds_read_b64_tr_b16 a[134:135], v12 offset:1032
ds_read_b64_tr_b16 a[136:137], v12 offset:2048
ds_read_b64_tr_b16 a[138:139], v12 offset:3072
ds_read_b64_tr_b16 a[140:141], v12 offset:2056
ds_read_b64_tr_b16 a[142:143], v12 offset:3080
ds_read_b64_tr_b16 a[144:145], v12 offset:4096
ds_read_b64_tr_b16 a[146:147], v12 offset:5120
ds_read_b64_tr_b16 a[148:149], v12 offset:4104
ds_read_b64_tr_b16 a[150:151], v12 offset:5128
s_waitcnt lgkmcnt(0)
ds_read_b64_tr_b16 a[152:153], v12 offset:6144
ds_read_b64_tr_b16 a[154:155], v12 offset:7168
ds_read_b64_tr_b16 a[156:157], v12 offset:6152
ds_read_b64_tr_b16 a[158:159], v12 offset:7176
ds_read_b64_tr_b16 a[160:161], v12 offset:8192
ds_read_b64_tr_b16 a[162:163], v12 offset:9216
ds_read_b64_tr_b16 a[164:165], v12 offset:8200
ds_read_b64_tr_b16 a[166:167], v12 offset:9224
ds_read_b64_tr_b16 a[168:169], v12 offset:10240
ds_read_b64_tr_b16 a[170:171], v12 offset:11264
ds_read_b64_tr_b16 a[172:173], v12 offset:10248
ds_read_b64_tr_b16 a[174:175], v12 offset:11272
s_waitcnt lgkmcnt(0)
ds_read_b64_tr_b16 a[176:177], v12 offset:12288
ds_read_b64_tr_b16 a[178:179], v12 offset:13312
ds_read_b64_tr_b16 a[180:181], v12 offset:12296
ds_read_b64_tr_b16 a[182:183], v12 offset:13320
ds_read_b64_tr_b16 a[184:185], v12 offset:14336
ds_read_b64_tr_b16 a[186:187], v12 offset:15360
ds_read_b64_tr_b16 a[188:189], v12 offset:14344
ds_read_b64_tr_b16 a[190:191], v12 offset:15368
ds_read_b64_tr_b16 a[192:193], v12 offset:16384
ds_read_b64_tr_b16 a[194:195], v12 offset:17408
ds_read_b64_tr_b16 a[196:197], v12 offset:16392
ds_read_b64_tr_b16 a[198:199], v12 offset:17416
s_waitcnt lgkmcnt(0)
ds_read_b64_tr_b16 a[200:201], v12 offset:18432
ds_read_b64_tr_b16 a[202:203], v12 offset:19456
ds_read_b64_tr_b16 a[204:205], v12 offset:18440
ds_read_b64_tr_b16 a[206:207], v12 offset:19464
ds_read_b64_tr_b16 a[208:209], v12 offset:20480
ds_read_b64_tr_b16 a[210:211], v12 offset:21504
ds_read_b64_tr_b16 a[212:213], v12 offset:20488
ds_read_b64_tr_b16 a[214:215], v12 offset:21512
ds_read_b64_tr_b16 a[216:217], v12 offset:22528
ds_read_b64_tr_b16 a[218:219], v12 offset:23552
ds_read_b64_tr_b16 a[220:221], v12 offset:22536
ds_read_b64_tr_b16 a[222:223], v12 offset:23560
s_waitcnt lgkmcnt(0)
ds_read_b64_tr_b16 a[224:225], v12 offset:24576
ds_read_b64_tr_b16 a[226:227], v12 offset:25600
ds_read_b64_tr_b16 a[228:229], v12 offset:24584
ds_read_b64_tr_b16 a[230:231], v12 offset:25608
ds_read_b64_tr_b16 a[232:233], v12 offset:26624
ds_read_b64_tr_b16 a[234:235], v12 offset:27648
ds_read_b64_tr_b16 a[236:237], v12 offset:26632
ds_read_b64_tr_b16 a[238:239], v12 offset:27656
ds_read_b64_tr_b16 a[240:241], v12 offset:28672
ds_read_b64_tr_b16 a[242:243], v12 offset:29696
ds_read_b64_tr_b16 a[244:245], v12 offset:28680
ds_read_b64_tr_b16 a[246:247], v12 offset:29704
s_waitcnt lgkmcnt(0)
ds_read_b64_tr_b16 a[248:249], v12 offset:30720
ds_read_b64_tr_b16 a[250:251], v12 offset:31744
ds_read_b64_tr_b16 a[252:253], v12 offset:30728
ds_read_b64_tr_b16 a[254:255], v12 offset:31752
s_waitcnt lgkmcnt(0)
s_mul_i32 s36, s32, 352
v_lshrrev_b32 v11, 2, v1
v_add_u32 v11, s36, v11
v_and_b32 v14, 3, v1
v_lshlrev_b32 v14, 4, v14
s_lshl_b32 s36, s42, 6
v_add_u32 v14, s36, v14
v_min_u32 v13, 1375, v11
v_lshl_add_u32 v13, v13, 10, v14
s_add_u32 m0, s40, 0
s_nop 0
global_load_lds_dwordx4 v13, s[24:25]
v_add_u32 v11, 16, v11
v_min_u32 v13, 1375, v11
v_lshl_add_u32 v13, v13, 10, v14
s_add_u32 m0, s40, 1024
s_nop 0
global_load_lds_dwordx4 v13, s[24:25]
v_add_u32 v11, 16, v11
v_min_u32 v13, 1375, v11
v_lshl_add_u32 v13, v13, 10, v14
s_add_u32 m0, s40, 2048
s_nop 0
global_load_lds_dwordx4 v13, s[24:25]
v_add_u32 v11, 16, v11
v_min_u32 v13, 1375, v11
v_lshl_add_u32 v13, v13, 10, v14
s_add_u32 m0, s40, 3072
s_nop 0
global_load_lds_dwordx4 v13, s[24:25]
v_add_u32 v11, 16, v11
s_nop 0
v_min_u32 v13, 1375, v11
v_lshl_add_u32 v13, v13, 10, v14
s_add_u32 m0, s40, 4096
s_nop 0
global_load_lds_dwordx4 v13, s[24:25]
v_add_u32 v11, 16, v11
v_min_u32 v13, 1375, v11
v_lshl_add_u32 v13, v13, 10, v14
s_add_u32 m0, s40, 5120
s_nop 0
global_load_lds_dwordx4 v13, s[24:25]
v_add_u32 v11, 16, v11
v_min_u32 v13, 1375, v11
v_lshl_add_u32 v13, v13, 10, v14
s_add_u32 m0, s40, 6144
s_nop 0
global_load_lds_dwordx4 v13, s[24:25]
v_add_u32 v11, 16, v11
v_min_u32 v13, 1375, v11
v_lshl_add_u32 v13, v13, 10, v14
s_add_u32 m0, s40, 7168
s_nop 0
global_load_lds_dwordx4 v13, s[24:25]
v_add_u32 v11, 16, v11
s_nop 0
v_min_u32 v13, 1375, v11
v_lshl_add_u32 v13, v13, 10, v14
s_add_u32 m0, s40, 8192
s_nop 0
global_load_lds_dwordx4 v13, s[24:25]
v_add_u32 v11, 16, v11
v_min_u32 v13, 1375, v11
v_lshl_add_u32 v13, v13, 10, v14
s_add_u32 m0, s40, 9216
s_nop 0
global_load_lds_dwordx4 v13, s[24:25]
v_add_u32 v11, 16, v11
v_min_u32 v13, 1375, v11
v_lshl_add_u32 v13, v13, 10, v14
s_add_u32 m0, s40, 10240
s_nop 0
global_load_lds_dwordx4 v13, s[24:25]
v_add_u32 v11, 16, v11
v_min_u32 v13, 1375, v11
v_lshl_add_u32 v13, v13, 10, v14
s_add_u32 m0, s40, 11264
s_nop 0
global_load_lds_dwordx4 v13, s[24:25]
v_add_u32 v11, 16, v11
s_nop 0
v_min_u32 v13, 1375, v11
v_lshl_add_u32 v13, v13, 10, v14
s_add_u32 m0, s40, 12288
s_nop 0
global_load_lds_dwordx4 v13, s[24:25]
v_add_u32 v11, 16, v11
v_min_u32 v13, 1375, v11
v_lshl_add_u32 v13, v13, 10, v14
s_add_u32 m0, s40, 13312
s_nop 0
global_load_lds_dwordx4 v13, s[24:25]
v_add_u32 v11, 16, v11
v_min_u32 v13, 1375, v11
v_lshl_add_u32 v13, v13, 10, v14
s_add_u32 m0, s40, 14336
s_nop 0
global_load_lds_dwordx4 v13, s[24:25]
v_add_u32 v11, 16, v11
v_min_u32 v13, 1375, v11
v_lshl_add_u32 v13, v13, 10, v14
s_add_u32 m0, s40, 15360
s_nop 0
global_load_lds_dwordx4 v13, s[24:25]
v_add_u32 v11, 16, v11
s_nop 0
v_min_u32 v13, 1375, v11
v_lshl_add_u32 v13, v13, 10, v14
s_add_u32 m0, s40, 16384
s_nop 0
global_load_lds_dwordx4 v13, s[24:25]
v_add_u32 v11, 16, v11
v_min_u32 v13, 1375, v11
v_lshl_add_u32 v13, v13, 10, v14
s_add_u32 m0, s40, 17408
s_nop 0
global_load_lds_dwordx4 v13, s[24:25]
v_add_u32 v11, 16, v11
v_min_u32 v13, 1375, v11
v_lshl_add_u32 v13, v13, 10, v14
s_add_u32 m0, s40, 18432
s_nop 0
global_load_lds_dwordx4 v13, s[24:25]
v_add_u32 v11, 16, v11
v_min_u32 v13, 1375, v11
v_lshl_add_u32 v13, v13, 10, v14
s_add_u32 m0, s40, 19456
s_nop 0
global_load_lds_dwordx4 v13, s[24:25]
v_add_u32 v11, 16, v11
s_nop 0
v_min_u32 v13, 1375, v11
v_lshl_add_u32 v13, v13, 10, v14
s_add_u32 m0, s40, 20480
s_nop 0
global_load_lds_dwordx4 v13, s[24:25]
v_add_u32 v11, 16, v11
v_min_u32 v13, 1375, v11
v_lshl_add_u32 v13, v13, 10, v14
s_add_u32 m0, s40, 21504
s_nop 0
global_load_lds_dwordx4 v13, s[24:25]
v_add_u32 v11, 16, v11
s_waitcnt vmcnt(0)
ds_read_b64_tr_b16 v[168:169], v12 offset:0
ds_read_b64_tr_b16 v[170:171], v12 offset:1024
ds_read_b64_tr_b16 v[172:173], v12 offset:8
ds_read_b64_tr_b16 v[174:175], v12 offset:1032
ds_read_b64_tr_b16 v[176:177], v12 offset:2048
ds_read_b64_tr_b16 v[178:179], v12 offset:3072
ds_read_b64_tr_b16 v[180:181], v12 offset:2056
ds_read_b64_tr_b16 v[182:183], v12 offset:3080
ds_read_b64_tr_b16 v[184:185], v12 offset:4096
ds_read_b64_tr_b16 v[186:187], v12 offset:5120
ds_read_b64_tr_b16 v[188:189], v12 offset:4104
ds_read_b64_tr_b16 v[190:191], v12 offset:5128
s_waitcnt lgkmcnt(0)
ds_read_b64_tr_b16 v[192:193], v12 offset:6144
ds_read_b64_tr_b16 v[194:195], v12 offset:7168
ds_read_b64_tr_b16 v[196:197], v12 offset:6152
ds_read_b64_tr_b16 v[198:199], v12 offset:7176
ds_read_b64_tr_b16 v[200:201], v12 offset:8192
ds_read_b64_tr_b16 v[202:203], v12 offset:9216
ds_read_b64_tr_b16 v[204:205], v12 offset:8200
ds_read_b64_tr_b16 v[206:207], v12 offset:9224
ds_read_b64_tr_b16 v[208:209], v12 offset:10240
ds_read_b64_tr_b16 v[210:211], v12 offset:11264
ds_read_b64_tr_b16 v[212:213], v12 offset:10248
ds_read_b64_tr_b16 v[214:215], v12 offset:11272
s_waitcnt lgkmcnt(0)
ds_read_b64_tr_b16 v[216:217], v12 offset:12288
ds_read_b64_tr_b16 v[218:219], v12 offset:13312
ds_read_b64_tr_b16 v[220:221], v12 offset:12296
ds_read_b64_tr_b16 v[222:223], v12 offset:13320
ds_read_b64_tr_b16 v[224:225], v12 offset:14336
ds_read_b64_tr_b16 v[226:227], v12 offset:15360
ds_read_b64_tr_b16 v[228:229], v12 offset:14344
ds_read_b64_tr_b16 v[230:231], v12 offset:15368
ds_read_b64_tr_b16 v[232:233], v12 offset:16384
ds_read_b64_tr_b16 v[234:235], v12 offset:17408
ds_read_b64_tr_b16 v[236:237], v12 offset:16392
ds_read_b64_tr_b16 v[238:239], v12 offset:17416
s_waitcnt lgkmcnt(0)
ds_read_b64_tr_b16 v[240:241], v12 offset:18432
ds_read_b64_tr_b16 v[242:243], v12 offset:19456
ds_read_b64_tr_b16 v[244:245], v12 offset:18440
ds_read_b64_tr_b16 v[246:247], v12 offset:19464
ds_read_b64_tr_b16 v[248:249], v12 offset:20480
ds_read_b64_tr_b16 v[250:251], v12 offset:21504
ds_read_b64_tr_b16 v[252:253], v12 offset:20488
ds_read_b64_tr_b16 v[254:255], v12 offset:21512
s_waitcnt lgkmcnt(0)
s_cmp_eq_u32 s32, 3
s_cbranch_scc0 L_wo_nz
v_mov_b32 v248, 0
v_mov_b32 v249, 0
v_mov_b32 v250, 0
v_mov_b32 v251, 0
v_mov_b32 v252, 0
v_mov_b32 v253, 0
v_mov_b32 v254, 0
v_mov_b32 v255, 0
L_wo_nz:
s_lshl_b32 s36, s41, 17
s_add_u32 s36, s36, s40
s_add_u32 s36, s36, 54525952
s_add_u32 s44, s30, s36
s_addc_u32 s45, s31, 0
s_mul_i32 s36, s41, 44
s_mul_i32 s37, s32, 11
s_add_u32 s36, s36, s37
s_lshl_b32 s36, s36, 10
s_add_u32 s36, s36, 71303168
s_add_u32 s46, s30, s36
s_addc_u32 s47, s31, 0
v_add_u32 v16, 0, v2
v_add_u32 v17, 4096, v2
v_add_u32 v18, 8192, v2
v_add_u32 v19, 12288, v2
v_add_u32 v20, 16384, v2
v_add_u32 v21, 20480, v2
v_add_u32 v22, 24576, v2
v_add_u32 v23, 28672, v2
s_lshl_b32 s36, s41, 4
s_lshl_b32 s37, s32, 2
s_add_u32 s36, s36, s37
v_lshrrev_b32 v11, 4, v1
v_add_u32 v8, s36, v11
v_lshlrev_b32 v8, 10, v8
v_and_b32 v12, 15, v1
v_lshl_add_u32 v8, v12, 2, v8
s_lshl_b32 s36, s42, 6
v_add_u32 v8, s36, v8
s_mov_b64 s[48:49], s[4:5]
s_mov_b64 s[50:51], s[26:27]
v_add_u32 v7, s37, v11
v_mul_u32_u24 v7, 144, v7
v_lshl_add_u32 v7, v12, 3, v7
v_add_u32 v7, 131072, v7
v_mul_u32_u24 v6, 144, v12
v_lshl_add_u32 v6, v11, 5, v6
s_mul_i32 s36, s32, 2304
s_add_u32 s36, s36, 131072
v_add_u32 v6, s36, v6
s_lshr_b32 s37, s41, 1
s_lshl_b32 s36, s37, 10
s_and_b32 s39, s42, 7
s_lshl_b32 s39, s39, 7
s_add_u32 s36, s36, s39
s_add_u32 s36, s36, 4096
v_lshlrev_b32 v11, 3, v1
v_add_u32 v15, s36, v11
s_lshl_b32 s36, s37, 10
s_and_b32 s39, s42, 3
s_lshl_b32 s39, s39, 8
s_add_u32 s36, s36, s39
s_add_u32 s36, s36, 6016
v_add_u32 v11, s36, v11
v_cmp_le_u32 vcc, 16, v1
s_nop 1
v_cndmask_b32 v15, v15, v11, vcc
s_mov_b64 s[60:61], vcc
s_not_b64 s[62:63], vcc
v_cmp_le_u32 vcc, 38, v1
v_mov_b32 v11, 4096
s_nop 0
v_cndmask_b32 v15, v15, v11, vcc
s_andn2_b64 s[60:61], s[60:61], vcc
s_mov_b32 s56, 0
s_cmp_eq_u32 s32, 0
s_cbranch_scc0 L_wgw_59
v_mov_b32 v3, 0
v_mov_b32 v11, 0
v_cndmask_b32 v3, v3, v11, s[62:63]
v_mov_b32 v11, 1
v_cndmask_b32 v3, v3, v11, s[60:61]
s_mov_b32 s98, 0
L_poll_60:
global_load_dwordx2 v[4:5], v15, s[30:31] offset:0 sc1
s_waitcnt vmcnt(0)
v_min_u32 v4, v4, v5
v_cmp_gt_u32 vcc, v3, v4
s_cbranch_vccz L_polld_61
s_add_u32 s98, s98, 1
s_cmp_lt_u32 s98, 200000
s_cbranch_scc1 L_poll_60
s_mov_b32 s99, 40
s_branch L_fail
L_polld_61:
L_wgw_59:
s_barrier
global_load_dwordx4 v[40:43], v16, s[46:47] offset:0 sc1
global_load_dwordx4 v[44:47], v16, s[46:47] offset:1024 sc1
global_load_dwordx4 v[48:51], v16, s[46:47] offset:2048 sc1
global_load_dwordx4 v[52:55], v16, s[46:47] offset:3072 sc1
global_load_dwordx4 v[56:59], v17, s[46:47] offset:0 sc1
global_load_dwordx4 v[60:63], v17, s[46:47] offset:1024 sc1
global_load_dwordx4 v[64:67], v17, s[46:47] offset:2048 sc1
global_load_dwordx4 v[68:71], v17, s[46:47] offset:3072 sc1
global_load_dwordx4 v[72:75], v18, s[46:47] offset:0 sc1
global_load_dwordx4 v[76:79], v18, s[46:47] offset:1024 sc1
global_load_dwordx4 v[80:83], v18, s[46:47] offset:2048 sc1
L_wo_62:
global_load_dword v9, v8, s[48:49]
s_waitcnt vmcnt(11)
v_mfma_f32_16x16x32_bf16 v[32:35], v[168:171], v[40:43], 0
v_mfma_f32_16x16x32_bf16 v[36:39], v[172:175], v[40:43], 0
s_waitcnt vmcnt(10)
v_mfma_f32_16x16x32_bf16 v[32:35], v[176:179], v[44:47], v[32:35]
v_mfma_f32_16x16x32_bf16 v[36:39], v[180:183], v[44:47], v[36:39]
s_waitcnt vmcnt(9)
v_mfma_f32_16x16x32_bf16 v[32:35], v[184:187], v[48:51], v[32:35]
v_mfma_f32_16x16x32_bf16 v[36:39], v[188:191], v[48:51], v[36:39]
s_waitcnt vmcnt(8)
v_mfma_f32_16x16x32_bf16 v[32:35], v[192:195], v[52:55], v[32:35]
v_mfma_f32_16x16x32_bf16 v[36:39], v[196:199], v[52:55], v[36:39]
s_waitcnt vmcnt(7)
v_mfma_f32_16x16x32_bf16 v[32:35], v[200:203], v[56:59], v[32:35]
v_mfma_f32_16x16x32_bf16 v[36:39], v[204:207], v[56:59], v[36:39]
s_waitcnt vmcnt(6)
v_mfma_f32_16x16x32_bf16 v[32:35], v[208:211], v[60:63], v[32:35]
v_mfma_f32_16x16x32_bf16 v[36:39], v[212:215], v[60:63], v[36:39]
s_waitcnt vmcnt(5)
v_mfma_f32_16x16x32_bf16 v[32:35], v[216:219], v[64:67], v[32:35]
v_mfma_f32_16x16x32_bf16 v[36:39], v[220:223], v[64:67], v[36:39]
s_waitcnt vmcnt(4)
v_mfma_f32_16x16x32_bf16 v[32:35], v[224:227], v[68:71], v[32:35]
v_mfma_f32_16x16x32_bf16 v[36:39], v[228:231], v[68:71], v[36:39]
s_waitcnt vmcnt(3)
v_mfma_f32_16x16x32_bf16 v[32:35], v[232:235], v[72:75], v[32:35]
v_mfma_f32_16x16x32_bf16 v[36:39], v[236:239], v[72:75], v[36:39]
s_waitcnt vmcnt(2)
v_mfma_f32_16x16x32_bf16 v[32:35], v[240:243], v[76:79], v[32:35]
v_mfma_f32_16x16x32_bf16 v[36:39], v[244:247], v[76:79], v[36:39]
s_waitcnt vmcnt(1)
v_mfma_f32_16x16x32_bf16 v[32:35], v[248:251], v[80:83], v[32:35]
v_mfma_f32_16x16x32_bf16 v[36:39], v[252:255], v[80:83], v[36:39]
s_add_u32 s36, s56, 1
s_add_u32 s37, s56, 2
s_min_u32 s37, s37, 32
s_cmp_eq_u32 s32, 0
s_cbranch_scc0 L_wgw_64
v_mov_b32 v3, 0
v_mov_b32 v11, s36
v_cndmask_b32 v3, v3, v11, s[62:63]
v_mov_b32 v11, s37
v_cndmask_b32 v3, v3, v11, s[60:61]
s_mov_b32 s98, 0
L_poll_65:
global_load_dwordx2 v[4:5], v15, s[30:31] offset:0 sc1
s_waitcnt vmcnt(0)
v_min_u32 v4, v4, v5
v_cmp_gt_u32 vcc, v3, v4
s_cbranch_vccz L_polld_66
s_add_u32 s98, s98, 1
s_cmp_lt_u32 s98, 200000
s_cbranch_scc1 L_poll_65
s_mov_b32 s99, 41
s_branch L_fail
L_polld_66:
L_wgw_64:
s_barrier
global_load_dwordx4 v[40:43], v16, s[44:45] offset:0 sc1
global_load_dwordx4 v[44:47], v16, s[44:45] offset:1024 sc1
global_load_dwordx4 v[48:51], v16, s[44:45] offset:2048 sc1
global_load_dwordx4 v[52:55], v16, s[44:45] offset:3072 sc1
global_load_dwordx4 v[56:59], v17, s[44:45] offset:0 sc1
global_load_dwordx4 v[60:63], v17, s[44:45] offset:1024 sc1
global_load_dwordx4 v[64:67], v17, s[44:45] offset:2048 sc1
global_load_dwordx4 v[68:71], v17, s[44:45] offset:3072 sc1
global_load_dwordx4 v[72:75], v18, s[44:45] offset:0 sc1
global_load_dwordx4 v[76:79], v18, s[44:45] offset:1024 sc1
global_load_dwordx4 v[80:83], v18, s[44:45] offset:2048 sc1
global_load_dwordx4 v[84:87], v18, s[44:45] offset:3072 sc1
global_load_dwordx4 v[88:91], v19, s[44:45] offset:0 sc1
global_load_dwordx4 v[92:95], v19, s[44:45] offset:1024 sc1
global_load_dwordx4 v[96:99], v19, s[44:45] offset:2048 sc1
global_load_dwordx4 v[100:103], v19, s[44:45] offset:3072 sc1
global_load_dwordx4 v[104:107], v20, s[44:45] offset:0 sc1
global_load_dwordx4 v[108:111], v20, s[44:45] offset:1024 sc1
global_load_dwordx4 v[112:115], v20, s[44:45] offset:2048 sc1
global_load_dwordx4 v[116:119], v20, s[44:45] offset:3072 sc1
global_load_dwordx4 v[120:123], v21, s[44:45] offset:0 sc1
global_load_dwordx4 v[124:127], v21, s[44:45] offset:1024 sc1
global_load_dwordx4 v[128:131], v21, s[44:45] offset:2048 sc1
global_load_dwordx4 v[132:135], v21, s[44:45] offset:3072 sc1
global_load_dwordx4 v[136:139], v22, s[44:45] offset:0 sc1
global_load_dwordx4 v[140:143], v22, s[44:45] offset:1024 sc1
global_load_dwordx4 v[144:147], v22, s[44:45] offset:2048 sc1
global_load_dwordx4 v[148:151], v22, s[44:45] offset:3072 sc1
global_load_dwordx4 v[152:155], v23, s[44:45] offset:0 sc1
global_load_dwordx4 v[156:159], v23, s[44:45] offset:1024 sc1
global_load_dwordx4 v[160:163], v23, s[44:45] offset:2048 sc1
global_load_dwordx4 v[164:167], v23, s[44:45] offset:3072 sc1
s_add_u32 s44, s44, 524288
s_addc_u32 s45, s45, 0
s_add_u32 s46, s46, 180224
s_addc_u32 s47, s47, 0
s_waitcnt vmcnt(31)
v_mfma_f32_16x16x32_bf16 v[32:35], a[0:3], v[40:43], v[32:35]
v_mfma_f32_16x16x32_bf16 v[36:39], a[4:7], v[40:43], v[36:39]
s_waitcnt vmcnt(30)
v_mfma_f32_16x16x32_bf16 v[32:35], a[8:11], v[44:47], v[32:35]
v_mfma_f32_16x16x32_bf16 v[36:39], a[12:15], v[44:47], v[36:39]
s_waitcnt vmcnt(29)
v_mfma_f32_16x16x32_bf16 v[32:35], a[16:19], v[48:51], v[32:35]
v_mfma_f32_16x16x32_bf16 v[36:39], a[20:23], v[48:51], v[36:39]
s_waitcnt vmcnt(28)
v_mfma_f32_16x16x32_bf16 v[32:35], a[24:27], v[52:55], v[32:35]
v_mfma_f32_16x16x32_bf16 v[36:39], a[28:31], v[52:55], v[36:39]
s_waitcnt vmcnt(27)
v_mfma_f32_16x16x32_bf16 v[32:35], a[32:35], v[56:59], v[32:35]
v_mfma_f32_16x16x32_bf16 v[36:39], a[36:39], v[56:59], v[36:39]
s_waitcnt vmcnt(26)
v_mfma_f32_16x16x32_bf16 v[32:35], a[40:43], v[60:63], v[32:35]
v_mfma_f32_16x16x32_bf16 v[36:39], a[44:47], v[60:63], v[36:39]
s_waitcnt vmcnt(25)
v_mfma_f32_16x16x32_bf16 v[32:35], a[48:51], v[64:67], v[32:35]
v_mfma_f32_16x16x32_bf16 v[36:39], a[52:55], v[64:67], v[36:39]
s_waitcnt vmcnt(24)
v_mfma_f32_16x16x32_bf16 v[32:35], a[56:59], v[68:71], v[32:35]
v_mfma_f32_16x16x32_bf16 v[36:39], a[60:63], v[68:71], v[36:39]
s_waitcnt vmcnt(23)
v_mfma_f32_16x16x32_bf16 v[32:35], a[64:67], v[72:75], v[32:35]
v_mfma_f32_16x16x32_bf16 v[36:39], a[68:71], v[72:75], v[36:39]
s_waitcnt vmcnt(22)
v_mfma_f32_16x16x32_bf16 v[32:35], a[72:75], v[76:79], v[32:35]
v_mfma_f32_16x16x32_bf16 v[36:39], a[76:79], v[76:79], v[36:39]
s_waitcnt vmcnt(21)
v_mfma_f32_16x16x32_bf16 v[32:35], a[80:83], v[80:83], v[32:35]
v_mfma_f32_16x16x32_bf16 v[36:39], a[84:87], v[80:83], v[36:39]
s_waitcnt vmcnt(20)
s_cmp_lt_u32 s56, 31
s_cbranch_scc0 L_nh_67
global_load_dwordx4 v[40:43], v16, s[46:47] offset:0 sc1
global_load_dwordx4 v[44:47], v16, s[46:47] offset:1024 sc1
global_load_dwordx4 v[48:51], v16, s[46:47] offset:2048 sc1
global_load_dwordx4 v[52:55], v16, s[46:47] offset:3072 sc1
global_load_dwordx4 v[56:59], v17, s[46:47] offset:0 sc1
global_load_dwordx4 v[60:63], v17, s[46:47] offset:1024 sc1
global_load_dwordx4 v[64:67], v17, s[46:47] offset:2048 sc1
global_load_dwordx4 v[68:71], v17, s[46:47] offset:3072 sc1
global_load_dwordx4 v[72:75], v18, s[46:47] offset:0 sc1
global_load_dwordx4 v[76:79], v18, s[46:47] offset:1024 sc1
global_load_dwordx4 v[80:83], v18, s[46:47] offset:2048 sc1
s_waitcnt vmcnt(31)
v_mfma_f32_16x16x32_bf16 v[32:35], a[88:91], v[84:87], v[32:35]
v_mfma_f32_16x16x32_bf16 v[36:39], a[92:95], v[84:87], v[36:39]
s_waitcnt vmcnt(30)
v_mfma_f32_16x16x32_bf16 v[32:35], a[96:99], v[88:91], v[32:35]
v_mfma_f32_16x16x32_bf16 v[36:39], a[100:103], v[88:91], v[36:39]
s_waitcnt vmcnt(29)
v_mfma_f32_16x16x32_bf16 v[32:35], a[104:107], v[92:95], v[32:35]
v_mfma_f32_16x16x32_bf16 v[36:39], a[108:111], v[92:95], v[36:39]
s_waitcnt vmcnt(28)
v_mfma_f32_16x16x32_bf16 v[32:35], a[112:115], v[96:99], v[32:35]
v_mfma_f32_16x16x32_bf16 v[36:39], a[116:119], v[96:99], v[36:39]
s_waitcnt vmcnt(27)
v_mfma_f32_16x16x32_bf16 v[32:35], a[120:123], v[100:103], v[32:35]
v_mfma_f32_16x16x32_bf16 v[36:39], a[124:127], v[100:103], v[36:39]
s_waitcnt vmcnt(26)
v_mfma_f32_16x16x32_bf16 v[32:35], a[128:131], v[104:107], v[32:35]
v_mfma_f32_16x16x32_bf16 v[36:39], a[132:135], v[104:107], v[36:39]
s_waitcnt vmcnt(25)
v_mfma_f32_16x16x32_bf16 v[32:35], a[136:139], v[108:111], v[32:35]
v_mfma_f32_16x16x32_bf16 v[36:39], a[140:143], v[108:111], v[36:39]
s_waitcnt vmcnt(24)
v_mfma_f32_16x16x32_bf16 v[32:35], a[144:147], v[112:115], v[32:35]
v_mfma_f32_16x16x32_bf16 v[36:39], a[148:151], v[112:115], v[36:39]
s_waitcnt vmcnt(23)
v_mfma_f32_16x16x32_bf16 v[32:35], a[152:155], v[116:119], v[32:35]
v_mfma_f32_16x16x32_bf16 v[36:39], a[156:159], v[116:119], v[36:39]
s_waitcnt vmcnt(22)
v_mfma_f32_16x16x32_bf16 v[32:35], a[160:163], v[120:123], v[32:35]
v_mfma_f32_16x16x32_bf16 v[36:39], a[164:167], v[120:123], v[36:39]
s_waitcnt vmcnt(21)
v_mfma_f32_16x16x32_bf16 v[32:35], a[168:171], v[124:127], v[32:35]
v_mfma_f32_16x16x32_bf16 v[36:39], a[172:175], v[124:127], v[36:39]
s_waitcnt vmcnt(20)
v_mfma_f32_16x16x32_bf16 v[32:35], a[176:179], v[128:131], v[32:35]
v_mfma_f32_16x16x32_bf16 v[36:39], a[180:183], v[128:131], v[36:39]
s_waitcnt vmcnt(19)
v_mfma_f32_16x16x32_bf16 v[32:35], a[184:187], v[132:135], v[32:35]
v_mfma_f32_16x16x32_bf16 v[36:39], a[188:191], v[132:135], v[36:39]
s_waitcnt vmcnt(18)
v_mfma_f32_16x16x32_bf16 v[32:35], a[192:195], v[136:139], v[32:35]
v_mfma_f32_16x16x32_bf16 v[36:39], a[196:199], v[136:139], v[36:39]
s_waitcnt vmcnt(17)
v_mfma_f32_16x16x32_bf16 v[32:35], a[200:203], v[140:143], v[32:35]
v_mfma_f32_16x16x32_bf16 v[36:39], a[204:207], v[140:143], v[36:39]
s_waitcnt vmcnt(16)
v_mfma_f32_16x16x32_bf16 v[32:35], a[208:211], v[144:147], v[32:35]
v_mfma_f32_16x16x32_bf16 v[36:39], a[212:215], v[144:147], v[36:39]
s_waitcnt vmcnt(15)
v_mfma_f32_16x16x32_bf16 v[32:35], a[216:219], v[148:151], v[32:35]
v_mfma_f32_16x16x32_bf16 v[36:39], a[220:223], v[148:151], v[36:39]
s_waitcnt vmcnt(14)
v_mfma_f32_16x16x32_bf16 v[32:35], a[224:227], v[152:155], v[32:35]
v_mfma_f32_16x16x32_bf16 v[36:39], a[228:231], v[152:155], v[36:39]
s_waitcnt vmcnt(13)
v_mfma_f32_16x16x32_bf16 v[32:35], a[232:235], v[156:159], v[32:35]
v_mfma_f32_16x16x32_bf16 v[36:39], a[236:239], v[156:159], v[36:39]
s_waitcnt vmcnt(12)
v_mfma_f32_16x16x32_bf16 v[32:35], a[240:243], v[160:163], v[32:35]
v_mfma_f32_16x16x32_bf16 v[36:39], a[244:247], v[160:163], v[36:39]
s_waitcnt vmcnt(11)
v_mfma_f32_16x16x32_bf16 v[32:35], a[248:251], v[164:167], v[32:35]
v_mfma_f32_16x16x32_bf16 v[36:39], a[252:255], v[164:167], v[36:39]
s_branch L_nh_67_j
L_nh_67:
s_waitcnt vmcnt(20)
v_mfma_f32_16x16x32_bf16 v[32:35], a[88:91], v[84:87], v[32:35]
v_mfma_f32_16x16x32_bf16 v[36:39], a[92:95], v[84:87], v[36:39]
s_waitcnt vmcnt(19)
v_mfma_f32_16x16x32_bf16 v[32:35], a[96:99], v[88:91], v[32:35]
v_mfma_f32_16x16x32_bf16 v[36:39], a[100:103], v[88:91], v[36:39]
s_waitcnt vmcnt(18)
v_mfma_f32_16x16x32_bf16 v[32:35], a[104:107], v[92:95], v[32:35]
v_mfma_f32_16x16x32_bf16 v[36:39], a[108:111], v[92:95], v[36:39]
s_waitcnt vmcnt(17)
v_mfma_f32_16x16x32_bf16 v[32:35], a[112:115], v[96:99], v[32:35]
v_mfma_f32_16x16x32_bf16 v[36:39], a[116:119], v[96:99], v[36:39]
s_waitcnt vmcnt(16)
v_mfma_f32_16x16x32_bf16 v[32:35], a[120:123], v[100:103], v[32:35]
v_mfma_f32_16x16x32_bf16 v[36:39], a[124:127], v[100:103], v[36:39]
s_waitcnt vmcnt(15)
v_mfma_f32_16x16x32_bf16 v[32:35], a[128:131], v[104:107], v[32:35]
v_mfma_f32_16x16x32_bf16 v[36:39], a[132:135], v[104:107], v[36:39]
s_waitcnt vmcnt(14)
v_mfma_f32_16x16x32_bf16 v[32:35], a[136:139], v[108:111], v[32:35]
v_mfma_f32_16x16x32_bf16 v[36:39], a[140:143], v[108:111], v[36:39]
s_waitcnt vmcnt(13)
v_mfma_f32_16x16x32_bf16 v[32:35], a[144:147], v[112:115], v[32:35]
v_mfma_f32_16x16x32_bf16 v[36:39], a[148:151], v[112:115], v[36:39]
s_waitcnt vmcnt(12)
v_mfma_f32_16x16x32_bf16 v[32:35], a[152:155], v[116:119], v[32:35]
v_mfma_f32_16x16x32_bf16 v[36:39], a[156:159], v[116:119], v[36:39]
s_waitcnt vmcnt(11)
v_mfma_f32_16x16x32_bf16 v[32:35], a[160:163], v[120:123], v[32:35]
v_mfma_f32_16x16x32_bf16 v[36:39], a[164:167], v[120:123], v[36:39]
s_waitcnt vmcnt(10)
v_mfma_f32_16x16x32_bf16 v[32:35], a[168:171], v[124:127], v[32:35]
v_mfma_f32_16x16x32_bf16 v[36:39], a[172:175], v[124:127], v[36:39]
s_waitcnt vmcnt(9)
v_mfma_f32_16x16x32_bf16 v[32:35], a[176:179], v[128:131], v[32:35]
v_mfma_f32_16x16x32_bf16 v[36:39], a[180:183], v[128:131], v[36:39]
s_waitcnt vmcnt(8)
v_mfma_f32_16x16x32_bf16 v[32:35], a[184:187], v[132:135], v[32:35]
v_mfma_f32_16x16x32_bf16 v[36:39], a[188:191], v[132:135], v[36:39]
s_waitcnt vmcnt(7)
v_mfma_f32_16x16x32_bf16 v[32:35], a[192:195], v[136:139], v[32:35]
v_mfma_f32_16x16x32_bf16 v[36:39], a[196:199], v[136:139], v[36:39]
s_waitcnt vmcnt(6)
v_mfma_f32_16x16x32_bf16 v[32:35], a[200:203], v[140:143], v[32:35]
v_mfma_f32_16x16x32_bf16 v[36:39], a[204:207], v[140:143], v[36:39]
s_waitcnt vmcnt(5)
v_mfma_f32_16x16x32_bf16 v[32:35], a[208:211], v[144:147], v[32:35]
v_mfma_f32_16x16x32_bf16 v[36:39], a[212:215], v[144:147], v[36:39]
s_waitcnt vmcnt(4)
v_mfma_f32_16x16x32_bf16 v[32:35], a[216:219], v[148:151], v[32:35]
v_mfma_f32_16x16x32_bf16 v[36:39], a[220:223], v[148:151], v[36:39]
s_waitcnt vmcnt(3)
v_mfma_f32_16x16x32_bf16 v[32:35], a[224:227], v[152:155], v[32:35]
v_mfma_f32_16x16x32_bf16 v[36:39], a[228:231], v[152:155], v[36:39]
s_waitcnt vmcnt(2)
v_mfma_f32_16x16x32_bf16 v[32:35], a[232:235], v[156:159], v[32:35]
v_mfma_f32_16x16x32_bf16 v[36:39], a[236:239], v[156:159], v[36:39]
s_waitcnt vmcnt(1)
v_mfma_f32_16x16x32_bf16 v[32:35], a[240:243], v[160:163], v[32:35]
v_mfma_f32_16x16x32_bf16 v[36:39], a[244:247], v[160:163], v[36:39]
s_waitcnt vmcnt(0)
v_mfma_f32_16x16x32_bf16 v[32:35], a[248:251], v[164:167], v[32:35]
v_mfma_f32_16x16x32_bf16 v[36:39], a[252:255], v[164:167], v[36:39]
L_nh_67_j:
s_nop 3
ds_write_b128 v6, v[32:35]
s_nop 2
ds_write_b128 v6, v[36:39] offset:16
s_waitcnt lgkmcnt(0)
s_barrier
ds_read_b64 v[24:25], v7 offset:0
ds_read_b64 v[26:27], v7 offset:2304
ds_read_b64 v[28:29], v7 offset:4608
ds_read_b64 v[30:31], v7 offset:6912
v_lshlrev_b32 v11, 16, v9
v_and_b32 v12, 0xffff0000, v9
s_waitcnt lgkmcnt(0)
s_barrier
v_pk_add_f32 v[24:25], v[24:25], v[26:27]
v_pk_add_f32 v[28:29], v[28:29], v[30:31]
v_pk_add_f32 v[24:25], v[24:25], v[28:29]
v_add_f32 v11, v11, v24
v_add_f32 v12, v12, v25
v_cvt_pk_bf16_f32 v11, v11, v12
global_store_dword v8, v11, s[50:51]
s_add_u32 s48, s48, 65536
s_addc_u32 s49, s49, 0
s_add_u32 s50, s50, 65536
s_addc_u32 s51, s51, 0
s_add_u32 s56, s56, 1
s_cmp_lt_u32 s56, 32
s_cbranch_scc1 L_wo_62
s_waitcnt vmcnt(0)
s_waitcnt vmcnt(0)
s_endpgm
s_endpgm
.section .rodata,"a"
.p2align 6
.amdhsa_kernel parallel_sum__memory_aug_recurrent_mem_tr__glu_gated_bilinear__prompt_kernel
  .amdhsa_next_free_vgpr 512
  .amdhsa_next_free_sgpr 102
  .amdhsa_accum_offset 256
  .amdhsa_group_segment_fixed_size 0
  .amdhsa_kernarg_size 112
  .amdhsa_user_sgpr_count 2
  .amdhsa_user_sgpr_kernarg_segment_ptr 1
  .amdhsa_system_sgpr_workgroup_id_x 1
.end_amdhsa_kernel
```
